```python
import torch

def _softmax(x, axis=-1):
    return torch.softmax(x, dim=axis)
def _gelu(x):
    return torch.nn.functional.gelu(x, approximate="tanh")
def _silu(x):
    return torch.nn.functional.silu(x)
def _sigmoid(x):
    return torch.sigmoid(x)
def _layernorm(x, axis=-1, eps=1e-5):
    m = x.mean(dim=axis, keepdim=True)
    v = x.var(dim=axis, keepdim=True, unbiased=False)
    return (x - m) / torch.sqrt(v + eps)
def _scatter_add(tgt, idx, src, axis=0):
    return tgt.clone().index_add_(axis, idx, src)
def _segment_sum(src, seg, n):
    out = torch.zeros((n,) + src.shape[1:], dtype=src.dtype)
    return out.index_add_(0, seg, src)
def _pad(x, pw):
    flat = tuple(v for pair in reversed(pw) for v in pair)
    return torch.nn.functional.pad(x, flat)

kernel_name = 'gated_mix__softmax_full_mha__moe_arch_mod__prompt'

def setup_inputs():

    _w = (lambda a: (lambda t: t.to(torch.bfloat16) if t.is_floating_point() else t)(torch.as_tensor(a)))
    def _A_setup():
        B, S, D = 1, 2048, 1024
        return {
            "x": _w((lambda *s: torch.randn(*s, dtype=torch.bfloat16) * 0.05)(B, S, D)),
            "wqkv": _w((lambda *s: torch.randn(*s, dtype=torch.bfloat16) * 0.8)(D, 3 * D)),
            "wo": _w((lambda *s: torch.randn(*s, dtype=torch.bfloat16) * 0.1)(D, D)),
        }
    _A_in = _A_setup()

    def _B_setup():
        B, S, D, F, C = 1, 2048, 1024, 3584, 1
        return {
            "x": _w((lambda *s: torch.randn(*s, dtype=torch.bfloat16) * 0.05)(B, S, D)),
            "w_r": _w((lambda *s: torch.randn(*s, dtype=torch.bfloat16) * 3.2)(D)),
            "w_gate": _w((lambda *s: torch.randn(*s, dtype=torch.bfloat16) * 0.2)(D, F)),
            "w_up": _w((lambda *s: torch.randn(*s, dtype=torch.bfloat16) * 0.2)(D, F)),
            "w_down": _w((lambda *s: torch.randn(*s, dtype=torch.bfloat16) * 0.2)(F, D)),
        }
    _B_in = _B_setup()

    return {
        "A_x": _A_in["x"],
        "A_wqkv": _A_in["wqkv"],
        "A_wo": _A_in["wo"],
        "B_x": _B_in["x"],
        "B_w_r": _B_in["w_r"],
        "B_w_gate": _B_in["w_gate"],
        "B_w_up": _B_in["w_up"],
        "B_w_down": _B_in["w_down"],
        "gate_w": _w((lambda *s: torch.randn(*s, dtype=torch.bfloat16) * 0.05)(1024) * 16.0),
    }

def reference(A_x, A_wqkv, A_wo, B_x, B_w_r, B_w_gate, B_w_up, B_w_down, gate_w):
    def _A_ref(x, wqkv, wo):
        B, S, D = x.shape
        H = 32; Dh = D // H
        qkv = (lambda x, *d: x.permute(*d))((x @ wqkv).reshape(B, S, 3, H, Dh), 2, 0, 3, 1, 4)
        q, k, v = qkv[0], qkv[1], qkv[2]
        scale = Dh ** -0.5
        scores = torch.einsum("bhqd,bhkd->bhqk", q, k) * scale
        p = _softmax(scores, axis=-1)
        o = torch.einsum("bhqk,bhkd->bhqd", p, v)
        return (lambda x, *d: x.permute(*d))(o, 0, 2, 1, 3).reshape(B, S, D) @ wo

    def _B_ref(x, w_r, w_gate, w_up, w_down):
        B, S, D = x.shape
        C = 1
        r = x @ w_r
        idx = torch.argsort(-r, axis=-1)[:, :C]
        idx_e = (lambda x, n, axis: torch.repeat_interleave(x, n, dim=axis))(idx.reshape(B, C, 1), D, axis=2)
        x_sel = (lambda x, i, axis: torch.take_along_dim(x, i, dim=axis))(x, idx_e, axis=1)
        g = _silu(x_sel @ w_gate)
        u = x_sel @ w_up
        y = (g * u) @ w_down
        r_sel = _sigmoid((lambda x, i, axis: torch.take_along_dim(x, i, dim=axis))(r, idx, axis=1))
        y = y * r_sel.reshape(B, C, 1)
        b_off = (torch.arange(B) * S).reshape(B, 1)
        flat_idx = (idx + b_off).reshape(B * C)
        zero = (x * 0.0).reshape(B * S, D)
        upd = _scatter_add(zero, flat_idx, y.reshape(B * C, D), axis=0)
        return x + upd.reshape(B, S, D)

    x = A_x
    g = _sigmoid((x * gate_w).sum(-1, keepdims=True))
    a = _A_ref(x, A_wqkv, A_wo)
    b = _B_ref(x, B_w_r, B_w_gate, B_w_up, B_w_down)
    return g * a + (1 - g) * b
```

```asm
; @launch grid=(256,1,1) block=(768,1,1) lds=163840
.amdgcn_target "amdgcn-amd-amdhsa--gfx950"
.text
.globl gated_mix__softmax_full_mha__moe_arch_mod__prompt_kernel
.p2align 8
.type gated_mix__softmax_full_mha__moe_arch_mod__prompt_kernel,@function
gated_mix__softmax_full_mha__moe_arch_mod__prompt_kernel:
L_code0:
    s_cmp_ge_u32 s2, 256
    s_cbranch_scc1 L_end
    s_load_dwordx16 s[16:31], s[0:1], 0
    s_load_dwordx8 s[32:39], s[0:1], 64
    v_lshrrev_b32 v1, 6, v0
    v_and_b32 v0, 63, v0
    v_readfirstlane_b32 s64, v1
    s_and_b32 s3, s2, 7
    s_lshr_b32 s4, s2, 3
    s_and_b32 s5, s3, 1
    s_lshl_b32 s5, s5, 3
    s_and_b32 s6, s4, 7
    s_add_u32 s65, s5, s6
    s_lshr_b32 s5, s3, 1
    s_lshl_b32 s5, s5, 2
    s_lshr_b32 s6, s4, 3
    s_add_u32 s66, s5, s6
    s_cmp_lt_u32 s64, 4
    s_cbranch_scc1 L_groupa
    s_cmp_lt_u32 s64, 8
    s_cbranch_scc1 L_groupb
L_helper:
    s_sub_u32 s67, s64, 8
    s_setprio 3
    v_mov_b32 v166, v0
    v_lshlrev_b32 v165, 4, v0
    v_lshrrev_b32 v1, 3, v0
    v_lshrrev_b32 v2, 4, v0
    v_and_b32 v3, 7, v0
    v_xor_b32 v4, v2, v3
    v_lshlrev_b32 v4, 4, v4
    v_lshl_add_u32 v10, v1, 11, v4
    v_xor_b32 v11, 64, v10
    v_and_b32 v2, 1, v2
    v_lshlrev_b32 v2, 2, v2
    v_xor_b32 v2, v2, v3
    v_lshlrev_b32 v13, 4, v2
    s_movk_i32 s3, 6144
    v_mul_lo_u32 v5, v1, s3
    v_add_u32 v12, v5, v13
    v_mov_b32 v6, v12
    v_bfe_u32 v2, v0, 4, 1
    v_lshlrev_b32 v2, 1, v2
    v_xor_b32 v2, v2, v3
    v_lshl_add_u32 v12, v2, 4, v5
    v_xor_b32 v6, 64, v12
    s_lshl_b32 s74, s65, 18
    s_lshl_b32 s3, s67, 16
    s_add_u32 s74, s74, s3
    s_mul_i32 s75, s67, 98304
    s_lshl_b32 s3, s66, 7
    s_add_u32 s75, s75, s3
    s_lshr_b32 s4, s2, 3
    s_lshr_b32 s5, s4, 3
    s_add_u32 s4, s4, s5
    s_and_b32 s4, s4, 3
    s_mov_b32 s79, s4
    s_mov_b32 s82, 0x65832140
    s_mov_b32 s83, 0xfedba9c7
    s_cmp_eq_u32 s4, 1
    s_cselect_b32 s82, 0x69432501, s82
    s_cselect_b32 s83, 0xfecbad87, s83
    s_cmp_eq_u32 s4, 2
    s_cselect_b32 s82, 0xa5436102, s82
    s_cselect_b32 s83, 0xfdcbe987, s83
    s_cmp_eq_u32 s4, 3
    s_cselect_b32 s82, 0x65472103, s82
    s_cselect_b32 s83, 0xedcfa98b, s83
    s_waitcnt lgkmcnt(0)
    s_mov_b32 s40, s16
    s_and_b32 s41, s17, 0xffff
    s_mov_b32 s42, 4194304
    s_mov_b32 s43, 0x20000
    s_mov_b32 s44, s18
    s_and_b32 s45, s19, 0xffff
    s_mov_b32 s46, 6291456
    s_mov_b32 s47, 0x20000
    s_bfe_u32 s76, s82, 0x40000
    s_lshl_b32 s77, s67, 12
    s_add_u32 s77, s77, 0
    s_lshl_b32 s78, s76, 7
    s_add_u32 s78, s78, s74
    s_mov_b32 m0, s77
    s_add_u32 s77, s77, 1024
    buffer_load_dwordx4 v10, s[40:43], s78 offen  lds
    s_add_u32 s78, s78, 16384
    s_mov_b32 m0, s77
    s_add_u32 s77, s77, 1024
    buffer_load_dwordx4 v11, s[40:43], s78 offen  lds
    s_add_u32 s78, s78, 16384
    s_mov_b32 m0, s77
    s_add_u32 s77, s77, 1024
    buffer_load_dwordx4 v10, s[40:43], s78 offen  lds
    s_add_u32 s78, s78, 16384
    s_mov_b32 m0, s77
    s_add_u32 s77, s77, 1024
    buffer_load_dwordx4 v11, s[40:43], s78 offen  lds
    s_lshl_b32 s77, s67, 11
    s_add_u32 s77, s77, 16384
    s_mul_i32 s78, s76, 393216
    s_add_u32 s78, s78, s75
    s_mov_b32 m0, s77
    s_add_u32 s77, s77, 8192
    buffer_load_dwordx4 v12, s[44:47], s78 offen  lds
    s_add_u32 s78, s78, 2048
    s_mov_b32 m0, s77
    s_add_u32 s77, s77, 8192
    buffer_load_dwordx4 v12, s[44:47], s78 offen  lds
    s_add_u32 s78, s78, 2048
    s_mov_b32 m0, s77
    s_add_u32 s77, s77, 4294951936
    buffer_load_dwordx4 v12, s[44:47], s78 offen  lds
    s_add_u32 s78, s78, 45056
    s_mov_b32 m0, s77
    s_add_u32 s77, s77, 8192
    buffer_load_dwordx4 v6, s[44:47], s78 offen  lds
    s_add_u32 s78, s78, 2048
    s_mov_b32 m0, s77
    s_add_u32 s77, s77, 8192
    buffer_load_dwordx4 v6, s[44:47], s78 offen  lds
    s_add_u32 s78, s78, 2048
    s_mov_b32 m0, s77
    s_add_u32 s77, s77, 4294951936
    buffer_load_dwordx4 v6, s[44:47], s78 offen  lds
    s_bfe_u32 s76, s82, 0x40004
    s_lshl_b32 s77, s67, 12
    s_add_u32 s77, s77, 40960
    s_lshl_b32 s78, s76, 7
    s_add_u32 s78, s78, s74
    s_mov_b32 m0, s77
    s_add_u32 s77, s77, 1024
    buffer_load_dwordx4 v10, s[40:43], s78 offen  lds
    s_add_u32 s78, s78, 16384
    s_mov_b32 m0, s77
    s_add_u32 s77, s77, 1024
    buffer_load_dwordx4 v11, s[40:43], s78 offen  lds
    s_add_u32 s78, s78, 16384
    s_mov_b32 m0, s77
    s_add_u32 s77, s77, 1024
    buffer_load_dwordx4 v10, s[40:43], s78 offen  lds
    s_add_u32 s78, s78, 16384
    s_mov_b32 m0, s77
    s_add_u32 s77, s77, 1024
    buffer_load_dwordx4 v11, s[40:43], s78 offen  lds
    s_lshl_b32 s77, s67, 11
    s_add_u32 s77, s77, 57344
    s_mul_i32 s78, s76, 393216
    s_add_u32 s78, s78, s75
    s_mov_b32 m0, s77
    s_add_u32 s77, s77, 8192
    buffer_load_dwordx4 v12, s[44:47], s78 offen  lds
    s_add_u32 s78, s78, 2048
    s_mov_b32 m0, s77
    s_add_u32 s77, s77, 8192
    buffer_load_dwordx4 v12, s[44:47], s78 offen  lds
    s_add_u32 s78, s78, 2048
    s_mov_b32 m0, s77
    s_add_u32 s77, s77, 4294951936
    buffer_load_dwordx4 v12, s[44:47], s78 offen  lds
    s_add_u32 s78, s78, 45056
    s_mov_b32 m0, s77
    s_add_u32 s77, s77, 8192
    buffer_load_dwordx4 v6, s[44:47], s78 offen  lds
    s_add_u32 s78, s78, 2048
    s_mov_b32 m0, s77
    s_add_u32 s77, s77, 8192
    buffer_load_dwordx4 v6, s[44:47], s78 offen  lds
    s_add_u32 s78, s78, 2048
    s_mov_b32 m0, s77
    s_add_u32 s77, s77, 4294951936
    buffer_load_dwordx4 v6, s[44:47], s78 offen  lds
    s_mov_b32 s48, s38
    s_and_b32 s49, s39, 0xffff
    s_mov_b32 s50, 33554432
    s_mov_b32 s51, 0x20000
    s_mov_b32 s52, s36
    s_and_b32 s53, s37, 0xffff
    s_mov_b32 s54, 256
    s_mov_b32 s55, 0x20000
    s_waitcnt vmcnt(10)
    s_barrier
    s_bfe_u32 s76, s82, 0x40008
    s_lshl_b32 s77, s67, 12
    s_add_u32 s77, s77, 81920
    s_lshl_b32 s78, s76, 7
    s_add_u32 s78, s78, s74
    s_mov_b32 m0, s77
    s_add_u32 s77, s77, 1024
    buffer_load_dwordx4 v10, s[40:43], s78 offen  lds
    s_add_u32 s78, s78, 16384
    s_mov_b32 m0, s77
    s_add_u32 s77, s77, 1024
    buffer_load_dwordx4 v11, s[40:43], s78 offen  lds
    s_add_u32 s78, s78, 16384
    s_mov_b32 m0, s77
    s_add_u32 s77, s77, 1024
    buffer_load_dwordx4 v10, s[40:43], s78 offen  lds
    s_add_u32 s78, s78, 16384
    s_mov_b32 m0, s77
    s_add_u32 s77, s77, 1024
    buffer_load_dwordx4 v11, s[40:43], s78 offen  lds
    s_lshl_b32 s77, s67, 11
    s_add_u32 s77, s77, 98304
    s_mul_i32 s78, s76, 393216
    s_add_u32 s78, s78, s75
    s_mov_b32 m0, s77
    s_add_u32 s77, s77, 8192
    buffer_load_dwordx4 v12, s[44:47], s78 offen  lds
    s_add_u32 s78, s78, 2048
    s_mov_b32 m0, s77
    s_add_u32 s77, s77, 8192
    buffer_load_dwordx4 v12, s[44:47], s78 offen  lds
    s_add_u32 s78, s78, 2048
    s_mov_b32 m0, s77
    s_add_u32 s77, s77, 4294951936
    buffer_load_dwordx4 v12, s[44:47], s78 offen  lds
    s_add_u32 s78, s78, 45056
    s_mov_b32 m0, s77
    s_add_u32 s77, s77, 8192
    buffer_load_dwordx4 v6, s[44:47], s78 offen  lds
    s_add_u32 s78, s78, 2048
    s_mov_b32 m0, s77
    s_add_u32 s77, s77, 8192
    buffer_load_dwordx4 v6, s[44:47], s78 offen  lds
    s_add_u32 s78, s78, 2048
    s_mov_b32 m0, s77
    s_add_u32 s77, s77, 4294951936
    buffer_load_dwordx4 v6, s[44:47], s78 offen  lds
    s_bfe_u32 s76, s82, 0x4000c
    s_lshl_b32 s77, s67, 12
    s_add_u32 s77, s77, 122880
    s_lshl_b32 s78, s76, 7
    s_add_u32 s78, s78, s74
    s_mov_b32 m0, s77
    s_add_u32 s77, s77, 1024
    buffer_load_dwordx4 v10, s[40:43], s78 offen  lds
    s_add_u32 s78, s78, 16384
    s_mov_b32 m0, s77
    s_add_u32 s77, s77, 1024
    buffer_load_dwordx4 v11, s[40:43], s78 offen  lds
    s_add_u32 s78, s78, 16384
    s_mov_b32 m0, s77
    s_add_u32 s77, s77, 1024
    buffer_load_dwordx4 v10, s[40:43], s78 offen  lds
    s_add_u32 s78, s78, 16384
    s_mov_b32 m0, s77
    s_add_u32 s77, s77, 1024
    buffer_load_dwordx4 v11, s[40:43], s78 offen  lds
    s_lshl_b32 s77, s67, 11
    s_add_u32 s77, s77, 139264
    s_mul_i32 s78, s76, 393216
    s_add_u32 s78, s78, s75
    s_mov_b32 m0, s77
    s_add_u32 s77, s77, 8192
    buffer_load_dwordx4 v12, s[44:47], s78 offen  lds
    s_add_u32 s78, s78, 2048
    s_mov_b32 m0, s77
    s_add_u32 s77, s77, 8192
    buffer_load_dwordx4 v12, s[44:47], s78 offen  lds
    s_add_u32 s78, s78, 2048
    s_mov_b32 m0, s77
    s_add_u32 s77, s77, 4294951936
    buffer_load_dwordx4 v12, s[44:47], s78 offen  lds
    s_add_u32 s78, s78, 45056
    s_mov_b32 m0, s77
    s_add_u32 s77, s77, 8192
    buffer_load_dwordx4 v6, s[44:47], s78 offen  lds
    s_add_u32 s78, s78, 2048
    s_mov_b32 m0, s77
    s_add_u32 s77, s77, 8192
    buffer_load_dwordx4 v6, s[44:47], s78 offen  lds
    s_add_u32 s78, s78, 2048
    s_mov_b32 m0, s77
    s_add_u32 s77, s77, 4294951936
    buffer_load_dwordx4 v6, s[44:47], s78 offen  lds
    s_waitcnt vmcnt(20)
    s_barrier
    s_bfe_u32 s76, s82, 0x40010
    s_lshl_b32 s77, s67, 12
    s_add_u32 s77, s77, 0
    s_lshl_b32 s78, s76, 7
    s_add_u32 s78, s78, s74
    s_mov_b32 m0, s77
    s_add_u32 s77, s77, 1024
    buffer_load_dwordx4 v10, s[40:43], s78 offen  lds
    s_add_u32 s78, s78, 16384
    s_mov_b32 m0, s77
    s_add_u32 s77, s77, 1024
    buffer_load_dwordx4 v11, s[40:43], s78 offen  lds
    s_add_u32 s78, s78, 16384
    s_mov_b32 m0, s77
    s_add_u32 s77, s77, 1024
    buffer_load_dwordx4 v10, s[40:43], s78 offen  lds
    s_add_u32 s78, s78, 16384
    s_mov_b32 m0, s77
    s_add_u32 s77, s77, 1024
    buffer_load_dwordx4 v11, s[40:43], s78 offen  lds
    s_lshl_b32 s77, s67, 11
    s_add_u32 s77, s77, 16384
    s_mul_i32 s78, s76, 393216
    s_add_u32 s78, s78, s75
    s_mov_b32 m0, s77
    s_add_u32 s77, s77, 8192
    buffer_load_dwordx4 v12, s[44:47], s78 offen  lds
    s_add_u32 s78, s78, 2048
    s_mov_b32 m0, s77
    s_add_u32 s77, s77, 8192
    buffer_load_dwordx4 v12, s[44:47], s78 offen  lds
    s_add_u32 s78, s78, 2048
    s_mov_b32 m0, s77
    s_add_u32 s77, s77, 4294951936
    buffer_load_dwordx4 v12, s[44:47], s78 offen  lds
    s_add_u32 s78, s78, 45056
    s_mov_b32 m0, s77
    s_add_u32 s77, s77, 8192
    buffer_load_dwordx4 v6, s[44:47], s78 offen  lds
    s_add_u32 s78, s78, 2048
    s_mov_b32 m0, s77
    s_add_u32 s77, s77, 8192
    buffer_load_dwordx4 v6, s[44:47], s78 offen  lds
    s_add_u32 s78, s78, 2048
    s_mov_b32 m0, s77
    s_add_u32 s77, s77, 4294951936
    buffer_load_dwordx4 v6, s[44:47], s78 offen  lds
    s_waitcnt vmcnt(20)
    s_barrier
    s_bfe_u32 s76, s82, 0x40014
    s_lshl_b32 s77, s67, 12
    s_add_u32 s77, s77, 40960
    s_lshl_b32 s78, s76, 7
    s_add_u32 s78, s78, s74
    s_mov_b32 m0, s77
    s_add_u32 s77, s77, 1024
    buffer_load_dwordx4 v10, s[40:43], s78 offen  lds
    s_add_u32 s78, s78, 16384
    s_mov_b32 m0, s77
    s_add_u32 s77, s77, 1024
    buffer_load_dwordx4 v11, s[40:43], s78 offen  lds
    s_add_u32 s78, s78, 16384
    s_mov_b32 m0, s77
    s_add_u32 s77, s77, 1024
    buffer_load_dwordx4 v10, s[40:43], s78 offen  lds
    s_add_u32 s78, s78, 16384
    s_mov_b32 m0, s77
    s_add_u32 s77, s77, 1024
    buffer_load_dwordx4 v11, s[40:43], s78 offen  lds
    s_lshl_b32 s77, s67, 11
    s_add_u32 s77, s77, 57344
    s_mul_i32 s78, s76, 393216
    s_add_u32 s78, s78, s75
    s_mov_b32 m0, s77
    s_add_u32 s77, s77, 8192
    buffer_load_dwordx4 v12, s[44:47], s78 offen  lds
    s_add_u32 s78, s78, 2048
    s_mov_b32 m0, s77
    s_add_u32 s77, s77, 8192
    buffer_load_dwordx4 v12, s[44:47], s78 offen  lds
    s_add_u32 s78, s78, 2048
    s_mov_b32 m0, s77
    s_add_u32 s77, s77, 4294951936
    buffer_load_dwordx4 v12, s[44:47], s78 offen  lds
    s_add_u32 s78, s78, 45056
    s_mov_b32 m0, s77
    s_add_u32 s77, s77, 8192
    buffer_load_dwordx4 v6, s[44:47], s78 offen  lds
    s_add_u32 s78, s78, 2048
    s_mov_b32 m0, s77
    s_add_u32 s77, s77, 8192
    buffer_load_dwordx4 v6, s[44:47], s78 offen  lds
    s_add_u32 s78, s78, 2048
    s_mov_b32 m0, s77
    s_add_u32 s77, s77, 4294951936
    buffer_load_dwordx4 v6, s[44:47], s78 offen  lds
    s_waitcnt vmcnt(20)
    s_barrier
    s_bfe_u32 s76, s82, 0x40018
    s_lshl_b32 s77, s67, 12
    s_add_u32 s77, s77, 81920
    s_lshl_b32 s78, s76, 7
    s_add_u32 s78, s78, s74
    s_mov_b32 m0, s77
    s_add_u32 s77, s77, 1024
    buffer_load_dwordx4 v10, s[40:43], s78 offen  lds
    s_add_u32 s78, s78, 16384
    s_mov_b32 m0, s77
    s_add_u32 s77, s77, 1024
    buffer_load_dwordx4 v11, s[40:43], s78 offen  lds
    s_add_u32 s78, s78, 16384
    s_mov_b32 m0, s77
    s_add_u32 s77, s77, 1024
    buffer_load_dwordx4 v10, s[40:43], s78 offen  lds
    s_add_u32 s78, s78, 16384
    s_mov_b32 m0, s77
    s_add_u32 s77, s77, 1024
    buffer_load_dwordx4 v11, s[40:43], s78 offen  lds
    s_lshl_b32 s77, s67, 11
    s_add_u32 s77, s77, 98304
    s_mul_i32 s78, s76, 393216
    s_add_u32 s78, s78, s75
    s_mov_b32 m0, s77
    s_add_u32 s77, s77, 8192
    buffer_load_dwordx4 v12, s[44:47], s78 offen  lds
    s_add_u32 s78, s78, 2048
    s_mov_b32 m0, s77
    s_add_u32 s77, s77, 8192
    buffer_load_dwordx4 v12, s[44:47], s78 offen  lds
    s_add_u32 s78, s78, 2048
    s_mov_b32 m0, s77
    s_add_u32 s77, s77, 4294951936
    buffer_load_dwordx4 v12, s[44:47], s78 offen  lds
    s_add_u32 s78, s78, 45056
    s_mov_b32 m0, s77
    s_add_u32 s77, s77, 8192
    buffer_load_dwordx4 v6, s[44:47], s78 offen  lds
    s_add_u32 s78, s78, 2048
    s_mov_b32 m0, s77
    s_add_u32 s77, s77, 8192
    buffer_load_dwordx4 v6, s[44:47], s78 offen  lds
    s_add_u32 s78, s78, 2048
    s_mov_b32 m0, s77
    s_add_u32 s77, s77, 4294951936
    buffer_load_dwordx4 v6, s[44:47], s78 offen  lds
    s_waitcnt vmcnt(20)
    s_barrier
    s_bfe_u32 s76, s82, 0x4001c
    s_lshl_b32 s77, s67, 12
    s_add_u32 s77, s77, 122880
    s_lshl_b32 s78, s76, 7
    s_add_u32 s78, s78, s74
    s_mov_b32 m0, s77
    s_add_u32 s77, s77, 1024
    buffer_load_dwordx4 v10, s[40:43], s78 offen  lds
    s_add_u32 s78, s78, 16384
    s_mov_b32 m0, s77
    s_add_u32 s77, s77, 1024
    buffer_load_dwordx4 v11, s[40:43], s78 offen  lds
    s_add_u32 s78, s78, 16384
    s_mov_b32 m0, s77
    s_add_u32 s77, s77, 1024
    buffer_load_dwordx4 v10, s[40:43], s78 offen  lds
    s_add_u32 s78, s78, 16384
    s_mov_b32 m0, s77
    s_add_u32 s77, s77, 1024
    buffer_load_dwordx4 v11, s[40:43], s78 offen  lds
    s_lshl_b32 s77, s67, 11
    s_add_u32 s77, s77, 139264
    s_mul_i32 s78, s76, 393216
    s_add_u32 s78, s78, s75
    s_mov_b32 m0, s77
    s_add_u32 s77, s77, 8192
    buffer_load_dwordx4 v12, s[44:47], s78 offen  lds
    s_add_u32 s78, s78, 2048
    s_mov_b32 m0, s77
    s_add_u32 s77, s77, 8192
    buffer_load_dwordx4 v12, s[44:47], s78 offen  lds
    s_add_u32 s78, s78, 2048
    s_mov_b32 m0, s77
    s_add_u32 s77, s77, 4294951936
    buffer_load_dwordx4 v12, s[44:47], s78 offen  lds
    s_add_u32 s78, s78, 45056
    s_mov_b32 m0, s77
    s_add_u32 s77, s77, 8192
    buffer_load_dwordx4 v6, s[44:47], s78 offen  lds
    s_add_u32 s78, s78, 2048
    s_mov_b32 m0, s77
    s_add_u32 s77, s77, 8192
    buffer_load_dwordx4 v6, s[44:47], s78 offen  lds
    s_add_u32 s78, s78, 2048
    s_mov_b32 m0, s77
    s_add_u32 s77, s77, 4294951936
    buffer_load_dwordx4 v6, s[44:47], s78 offen  lds
    s_waitcnt vmcnt(20)
    s_barrier
    s_bfe_u32 s76, s83, 0x40000
    s_lshl_b32 s77, s67, 12
    s_add_u32 s77, s77, 0
    s_lshl_b32 s78, s76, 7
    s_add_u32 s78, s78, s74
    s_mov_b32 m0, s77
    s_add_u32 s77, s77, 1024
    buffer_load_dwordx4 v10, s[40:43], s78 offen  lds
    s_add_u32 s78, s78, 16384
    s_mov_b32 m0, s77
    s_add_u32 s77, s77, 1024
    buffer_load_dwordx4 v11, s[40:43], s78 offen  lds
    s_add_u32 s78, s78, 16384
    s_mov_b32 m0, s77
    s_add_u32 s77, s77, 1024
    buffer_load_dwordx4 v10, s[40:43], s78 offen  lds
    s_add_u32 s78, s78, 16384
    s_mov_b32 m0, s77
    s_add_u32 s77, s77, 1024
    buffer_load_dwordx4 v11, s[40:43], s78 offen  lds
    s_lshl_b32 s77, s67, 11
    s_add_u32 s77, s77, 16384
    s_mul_i32 s78, s76, 393216
    s_add_u32 s78, s78, s75
    s_mov_b32 m0, s77
    s_add_u32 s77, s77, 8192
    buffer_load_dwordx4 v12, s[44:47], s78 offen  lds
    s_add_u32 s78, s78, 2048
    s_mov_b32 m0, s77
    s_add_u32 s77, s77, 8192
    buffer_load_dwordx4 v12, s[44:47], s78 offen  lds
    s_add_u32 s78, s78, 2048
    s_mov_b32 m0, s77
    s_add_u32 s77, s77, 4294951936
    buffer_load_dwordx4 v12, s[44:47], s78 offen  lds
    s_add_u32 s78, s78, 45056
    s_mov_b32 m0, s77
    s_add_u32 s77, s77, 8192
    buffer_load_dwordx4 v6, s[44:47], s78 offen  lds
    s_add_u32 s78, s78, 2048
    s_mov_b32 m0, s77
    s_add_u32 s77, s77, 8192
    buffer_load_dwordx4 v6, s[44:47], s78 offen  lds
    s_add_u32 s78, s78, 2048
    s_mov_b32 m0, s77
    s_add_u32 s77, s77, 4294951936
    buffer_load_dwordx4 v6, s[44:47], s78 offen  lds
    s_waitcnt vmcnt(20)
    s_barrier
    s_bfe_u32 s76, s83, 0x40004
    s_lshl_b32 s77, s67, 12
    s_add_u32 s77, s77, 40960
    s_lshl_b32 s78, s76, 7
    s_add_u32 s78, s78, s74
    s_mov_b32 m0, s77
    s_add_u32 s77, s77, 1024
    buffer_load_dwordx4 v10, s[40:43], s78 offen  lds
    s_add_u32 s78, s78, 16384
    s_mov_b32 m0, s77
    s_add_u32 s77, s77, 1024
    buffer_load_dwordx4 v11, s[40:43], s78 offen  lds
    s_add_u32 s78, s78, 16384
    s_mov_b32 m0, s77
    s_add_u32 s77, s77, 1024
    buffer_load_dwordx4 v10, s[40:43], s78 offen  lds
    s_add_u32 s78, s78, 16384
    s_mov_b32 m0, s77
    s_add_u32 s77, s77, 1024
    buffer_load_dwordx4 v11, s[40:43], s78 offen  lds
    s_lshl_b32 s77, s67, 11
    s_add_u32 s77, s77, 57344
    s_mul_i32 s78, s76, 393216
    s_add_u32 s78, s78, s75
    s_mov_b32 m0, s77
    s_add_u32 s77, s77, 8192
    buffer_load_dwordx4 v12, s[44:47], s78 offen  lds
    s_add_u32 s78, s78, 2048
    s_mov_b32 m0, s77
    s_add_u32 s77, s77, 8192
    buffer_load_dwordx4 v12, s[44:47], s78 offen  lds
    s_add_u32 s78, s78, 2048
    s_mov_b32 m0, s77
    s_add_u32 s77, s77, 4294951936
    buffer_load_dwordx4 v12, s[44:47], s78 offen  lds
    s_add_u32 s78, s78, 45056
    s_mov_b32 m0, s77
    s_add_u32 s77, s77, 8192
    buffer_load_dwordx4 v6, s[44:47], s78 offen  lds
    s_add_u32 s78, s78, 2048
    s_mov_b32 m0, s77
    s_add_u32 s77, s77, 8192
    buffer_load_dwordx4 v6, s[44:47], s78 offen  lds
    s_add_u32 s78, s78, 2048
    s_mov_b32 m0, s77
    s_add_u32 s77, s77, 4294951936
    buffer_load_dwordx4 v6, s[44:47], s78 offen  lds
    s_waitcnt vmcnt(20)
    s_barrier
    s_bfe_u32 s76, s83, 0x40008
    s_lshl_b32 s77, s67, 12
    s_add_u32 s77, s77, 81920
    s_lshl_b32 s78, s76, 7
    s_add_u32 s78, s78, s74
    s_mov_b32 m0, s77
    s_add_u32 s77, s77, 1024
    buffer_load_dwordx4 v10, s[40:43], s78 offen  lds
    s_add_u32 s78, s78, 16384
    s_mov_b32 m0, s77
    s_add_u32 s77, s77, 1024
    buffer_load_dwordx4 v11, s[40:43], s78 offen  lds
    s_add_u32 s78, s78, 16384
    s_mov_b32 m0, s77
    s_add_u32 s77, s77, 1024
    buffer_load_dwordx4 v10, s[40:43], s78 offen  lds
    s_add_u32 s78, s78, 16384
    s_mov_b32 m0, s77
    s_add_u32 s77, s77, 1024
    buffer_load_dwordx4 v11, s[40:43], s78 offen  lds
    s_lshl_b32 s77, s67, 11
    s_add_u32 s77, s77, 98304
    s_mul_i32 s78, s76, 393216
    s_add_u32 s78, s78, s75
    s_mov_b32 m0, s77
    s_add_u32 s77, s77, 8192
    buffer_load_dwordx4 v12, s[44:47], s78 offen  lds
    s_add_u32 s78, s78, 2048
    s_mov_b32 m0, s77
    s_add_u32 s77, s77, 8192
    buffer_load_dwordx4 v12, s[44:47], s78 offen  lds
    s_add_u32 s78, s78, 2048
    s_mov_b32 m0, s77
    s_add_u32 s77, s77, 4294951936
    buffer_load_dwordx4 v12, s[44:47], s78 offen  lds
    s_add_u32 s78, s78, 45056
    s_mov_b32 m0, s77
    s_add_u32 s77, s77, 8192
    buffer_load_dwordx4 v6, s[44:47], s78 offen  lds
    s_add_u32 s78, s78, 2048
    s_mov_b32 m0, s77
    s_add_u32 s77, s77, 8192
    buffer_load_dwordx4 v6, s[44:47], s78 offen  lds
    s_add_u32 s78, s78, 2048
    s_mov_b32 m0, s77
    s_add_u32 s77, s77, 4294951936
    buffer_load_dwordx4 v6, s[44:47], s78 offen  lds
    s_waitcnt vmcnt(20)
    s_barrier
    s_bfe_u32 s76, s83, 0x4000c
    s_lshl_b32 s77, s67, 12
    s_add_u32 s77, s77, 122880
    s_lshl_b32 s78, s76, 7
    s_add_u32 s78, s78, s74
    s_mov_b32 m0, s77
    s_add_u32 s77, s77, 1024
    buffer_load_dwordx4 v10, s[40:43], s78 offen  lds
    s_add_u32 s78, s78, 16384
    s_mov_b32 m0, s77
    s_add_u32 s77, s77, 1024
    buffer_load_dwordx4 v11, s[40:43], s78 offen  lds
    s_add_u32 s78, s78, 16384
    s_mov_b32 m0, s77
    s_add_u32 s77, s77, 1024
    buffer_load_dwordx4 v10, s[40:43], s78 offen  lds
    s_add_u32 s78, s78, 16384
    s_mov_b32 m0, s77
    s_add_u32 s77, s77, 1024
    buffer_load_dwordx4 v11, s[40:43], s78 offen  lds
    s_lshl_b32 s77, s67, 11
    s_add_u32 s77, s77, 139264
    s_mul_i32 s78, s76, 393216
    s_add_u32 s78, s78, s75
    s_mov_b32 m0, s77
    s_add_u32 s77, s77, 8192
    buffer_load_dwordx4 v12, s[44:47], s78 offen  lds
    s_add_u32 s78, s78, 2048
    s_mov_b32 m0, s77
    s_add_u32 s77, s77, 8192
    buffer_load_dwordx4 v12, s[44:47], s78 offen  lds
    s_add_u32 s78, s78, 2048
    s_mov_b32 m0, s77
    s_add_u32 s77, s77, 4294951936
    buffer_load_dwordx4 v12, s[44:47], s78 offen  lds
    s_add_u32 s78, s78, 45056
    s_mov_b32 m0, s77
    s_add_u32 s77, s77, 8192
    buffer_load_dwordx4 v6, s[44:47], s78 offen  lds
    s_add_u32 s78, s78, 2048
    s_mov_b32 m0, s77
    s_add_u32 s77, s77, 8192
    buffer_load_dwordx4 v6, s[44:47], s78 offen  lds
    s_add_u32 s78, s78, 2048
    s_mov_b32 m0, s77
    s_add_u32 s77, s77, 4294951936
    buffer_load_dwordx4 v6, s[44:47], s78 offen  lds
    s_waitcnt vmcnt(20)
    s_barrier
    s_bfe_u32 s76, s83, 0x40010
    s_lshl_b32 s77, s67, 12
    s_add_u32 s77, s77, 0
    s_lshl_b32 s78, s76, 7
    s_add_u32 s78, s78, s74
    s_mov_b32 m0, s77
    s_add_u32 s77, s77, 1024
    buffer_load_dwordx4 v10, s[40:43], s78 offen  lds
    s_add_u32 s78, s78, 16384
    s_mov_b32 m0, s77
    s_add_u32 s77, s77, 1024
    buffer_load_dwordx4 v11, s[40:43], s78 offen  lds
    s_add_u32 s78, s78, 16384
    s_mov_b32 m0, s77
    s_add_u32 s77, s77, 1024
    buffer_load_dwordx4 v10, s[40:43], s78 offen  lds
    s_add_u32 s78, s78, 16384
    s_mov_b32 m0, s77
    s_add_u32 s77, s77, 1024
    buffer_load_dwordx4 v11, s[40:43], s78 offen  lds
    s_lshl_b32 s77, s67, 11
    s_add_u32 s77, s77, 16384
    s_mul_i32 s78, s76, 393216
    s_add_u32 s78, s78, s75
    s_mov_b32 m0, s77
    s_add_u32 s77, s77, 8192
    buffer_load_dwordx4 v12, s[44:47], s78 offen  lds
    s_add_u32 s78, s78, 2048
    s_mov_b32 m0, s77
    s_add_u32 s77, s77, 8192
    buffer_load_dwordx4 v12, s[44:47], s78 offen  lds
    s_add_u32 s78, s78, 2048
    s_mov_b32 m0, s77
    s_add_u32 s77, s77, 4294951936
    buffer_load_dwordx4 v12, s[44:47], s78 offen  lds
    s_add_u32 s78, s78, 45056
    s_mov_b32 m0, s77
    s_add_u32 s77, s77, 8192
    buffer_load_dwordx4 v6, s[44:47], s78 offen  lds
    s_add_u32 s78, s78, 2048
    s_mov_b32 m0, s77
    s_add_u32 s77, s77, 8192
    buffer_load_dwordx4 v6, s[44:47], s78 offen  lds
    s_add_u32 s78, s78, 2048
    s_mov_b32 m0, s77
    s_add_u32 s77, s77, 4294951936
    buffer_load_dwordx4 v6, s[44:47], s78 offen  lds
    s_waitcnt vmcnt(20)
    s_barrier
    s_bfe_u32 s76, s83, 0x40014
    s_lshl_b32 s77, s67, 12
    s_add_u32 s77, s77, 40960
    s_lshl_b32 s78, s76, 7
    s_add_u32 s78, s78, s74
    s_mov_b32 m0, s77
    s_add_u32 s77, s77, 1024
    buffer_load_dwordx4 v10, s[40:43], s78 offen  lds
    s_add_u32 s78, s78, 16384
    s_mov_b32 m0, s77
    s_add_u32 s77, s77, 1024
    buffer_load_dwordx4 v11, s[40:43], s78 offen  lds
    s_add_u32 s78, s78, 16384
    s_mov_b32 m0, s77
    s_add_u32 s77, s77, 1024
    buffer_load_dwordx4 v10, s[40:43], s78 offen  lds
    s_add_u32 s78, s78, 16384
    s_mov_b32 m0, s77
    s_add_u32 s77, s77, 1024
    buffer_load_dwordx4 v11, s[40:43], s78 offen  lds
    s_lshl_b32 s77, s67, 11
    s_add_u32 s77, s77, 57344
    s_mul_i32 s78, s76, 393216
    s_add_u32 s78, s78, s75
    s_mov_b32 m0, s77
    s_add_u32 s77, s77, 8192
    buffer_load_dwordx4 v12, s[44:47], s78 offen  lds
    s_add_u32 s78, s78, 2048
    s_mov_b32 m0, s77
    s_add_u32 s77, s77, 8192
    buffer_load_dwordx4 v12, s[44:47], s78 offen  lds
    s_add_u32 s78, s78, 2048
    s_mov_b32 m0, s77
    s_add_u32 s77, s77, 4294951936
    buffer_load_dwordx4 v12, s[44:47], s78 offen  lds
    s_add_u32 s78, s78, 45056
    s_mov_b32 m0, s77
    s_add_u32 s77, s77, 8192
    buffer_load_dwordx4 v6, s[44:47], s78 offen  lds
    s_add_u32 s78, s78, 2048
    s_mov_b32 m0, s77
    s_add_u32 s77, s77, 8192
    buffer_load_dwordx4 v6, s[44:47], s78 offen  lds
    s_add_u32 s78, s78, 2048
    s_mov_b32 m0, s77
    s_add_u32 s77, s77, 4294951936
    buffer_load_dwordx4 v6, s[44:47], s78 offen  lds
    s_waitcnt vmcnt(20)
    s_barrier
    s_bfe_u32 s76, s83, 0x40018
    s_lshl_b32 s77, s67, 12
    s_add_u32 s77, s77, 81920
    s_lshl_b32 s78, s76, 7
    s_add_u32 s78, s78, s74
    s_mov_b32 m0, s77
    s_add_u32 s77, s77, 1024
    buffer_load_dwordx4 v10, s[40:43], s78 offen  lds
    s_add_u32 s78, s78, 16384
    s_mov_b32 m0, s77
    s_add_u32 s77, s77, 1024
    buffer_load_dwordx4 v11, s[40:43], s78 offen  lds
    s_add_u32 s78, s78, 16384
    s_mov_b32 m0, s77
    s_add_u32 s77, s77, 1024
    buffer_load_dwordx4 v10, s[40:43], s78 offen  lds
    s_add_u32 s78, s78, 16384
    s_mov_b32 m0, s77
    s_add_u32 s77, s77, 1024
    buffer_load_dwordx4 v11, s[40:43], s78 offen  lds
    s_lshl_b32 s77, s67, 11
    s_add_u32 s77, s77, 98304
    s_mul_i32 s78, s76, 393216
    s_add_u32 s78, s78, s75
    s_mov_b32 m0, s77
    s_add_u32 s77, s77, 8192
    buffer_load_dwordx4 v12, s[44:47], s78 offen  lds
    s_add_u32 s78, s78, 2048
    s_mov_b32 m0, s77
    s_add_u32 s77, s77, 8192
    buffer_load_dwordx4 v12, s[44:47], s78 offen  lds
    s_add_u32 s78, s78, 2048
    s_mov_b32 m0, s77
    s_add_u32 s77, s77, 4294951936
    buffer_load_dwordx4 v12, s[44:47], s78 offen  lds
    s_add_u32 s78, s78, 45056
    s_mov_b32 m0, s77
    s_add_u32 s77, s77, 8192
    buffer_load_dwordx4 v6, s[44:47], s78 offen  lds
    s_add_u32 s78, s78, 2048
    s_mov_b32 m0, s77
    s_add_u32 s77, s77, 8192
    buffer_load_dwordx4 v6, s[44:47], s78 offen  lds
    s_add_u32 s78, s78, 2048
    s_mov_b32 m0, s77
    s_add_u32 s77, s77, 4294951936
    buffer_load_dwordx4 v6, s[44:47], s78 offen  lds
    s_waitcnt vmcnt(20)
    s_barrier
    s_bfe_u32 s76, s83, 0x4001c
    s_lshl_b32 s77, s67, 12
    s_add_u32 s77, s77, 122880
    s_lshl_b32 s78, s76, 7
    s_add_u32 s78, s78, s74
    s_mov_b32 m0, s77
    s_add_u32 s77, s77, 1024
    buffer_load_dwordx4 v10, s[40:43], s78 offen  lds
    s_add_u32 s78, s78, 16384
    s_mov_b32 m0, s77
    s_add_u32 s77, s77, 1024
    buffer_load_dwordx4 v11, s[40:43], s78 offen  lds
    s_add_u32 s78, s78, 16384
    s_mov_b32 m0, s77
    s_add_u32 s77, s77, 1024
    buffer_load_dwordx4 v10, s[40:43], s78 offen  lds
    s_add_u32 s78, s78, 16384
    s_mov_b32 m0, s77
    s_add_u32 s77, s77, 1024
    buffer_load_dwordx4 v11, s[40:43], s78 offen  lds
    s_lshl_b32 s77, s67, 11
    s_add_u32 s77, s77, 139264
    s_mul_i32 s78, s76, 393216
    s_add_u32 s78, s78, s75
    s_mov_b32 m0, s77
    s_add_u32 s77, s77, 8192
    buffer_load_dwordx4 v12, s[44:47], s78 offen  lds
    s_add_u32 s78, s78, 2048
    s_mov_b32 m0, s77
    s_add_u32 s77, s77, 8192
    buffer_load_dwordx4 v12, s[44:47], s78 offen  lds
    s_add_u32 s78, s78, 2048
    s_mov_b32 m0, s77
    s_add_u32 s77, s77, 4294951936
    buffer_load_dwordx4 v12, s[44:47], s78 offen  lds
    s_add_u32 s78, s78, 45056
    s_mov_b32 m0, s77
    s_add_u32 s77, s77, 8192
    buffer_load_dwordx4 v6, s[44:47], s78 offen  lds
    s_add_u32 s78, s78, 2048
    s_mov_b32 m0, s77
    s_add_u32 s77, s77, 8192
    buffer_load_dwordx4 v6, s[44:47], s78 offen  lds
    s_add_u32 s78, s78, 2048
    s_mov_b32 m0, s77
    s_add_u32 s77, s77, 4294951936
    buffer_load_dwordx4 v6, s[44:47], s78 offen  lds
    v_mov_b32 v27, 0
    s_cmp_eq_u32 s67, 0
    s_cselect_b32 s5, 0, 0x7f000000
    s_mov_b64 exec, 1
    buffer_load_dword v26, v27, s[52:55], s5 offen sc1
    s_mov_b64 exec, -1
    s_lshl_b32 s3, s66, 4
    s_and_b32 s4, s65, 8
    s_add_u32 s3, s3, s4
    s_lshl_b32 s3, s3, 7
    s_add_u32 s3, s3, 12984320
    s_or_b32 s3, s3, s5
    v_and_b32 v9, 7, v166
    v_lshlrev_b32 v9, 7, v9
    buffer_load_dword v8, v9, s[48:51], s3 offen
    s_lshl_b32 s3, s66, 17
    s_lshl_b32 s4, s65, 13
    s_add_u32 s3, s3, s4
    s_add_u32 s3, s3, 29360128
    s_lshl_b32 s4, s67, 11
    s_add_u32 s3, s3, s4
    v_lshlrev_b32 v9, 7, v166
    s_mov_b64 exec, 0xffff
    buffer_load_dword v8, v9, s[48:51], s3 offen
    s_mov_b64 exec, -1
    s_lshl_b32 s3, s66, 19
    s_lshl_b32 s4, s65, 15
    s_add_u32 s3, s3, s4
    s_mul_i32 s4, s67, 8192
    s_add_u32 s3, s3, s4
    s_add_u32 s3, s3, 20971520
    v_lshlrev_b32 v9, 7, v166
    buffer_load_dword v8, v9, s[48:51], s3 offen
    s_mov_b64 exec, -1
    s_waitcnt vmcnt(24)
    s_barrier
    s_waitcnt vmcnt(14)
    s_barrier
    s_waitcnt vmcnt(4)
    s_barrier
    s_cmp_lg_u32 s67, 0
    s_cbranch_scc1 L_only_1
    s_waitcnt vmcnt(3)
    v_readfirstlane_b32 s3, v26
    s_nop 1
    s_cmp_lg_u32 s3, 0
    s_cbranch_scc1 L_tagok_2
    s_mov_b32 s96, 65536
    s_mov_b32 s97, 0
    s_mov_b64 exec, 0x1
L_poll_3:
    buffer_load_dword v26, v27, s[52:55], 0 offen offset:0 sc1
    s_waitcnt vmcnt(0)
    v_cmp_eq_u32 vcc, s97, v26
    s_sub_u32 s96, s96, 1
    s_cmp_eq_u32 s96, 0
    s_cbranch_scc1 L_polld_4
    s_nop 2
    s_cbranch_vccz L_polld_4
    s_sleep 1
    s_branch L_poll_3
L_polld_4:
    s_mov_b64 exec, -1
L_tagok_2:
    v_mov_b32 v14, 98304
    s_mov_b64 exec, 1
    ds_write_b32 v14, v26
    s_mov_b64 exec, -1
    s_waitcnt lgkmcnt(0)
L_only_1:
    s_barrier
    s_cmp_lg_u32 s67, 0
    s_cbranch_scc1 L_only_5
    v_add_u32 v14, 155648, v165
    v_mov_b32 v20, 0
    v_mov_b32 v21, 0
    v_mov_b32 v22, 0
    v_mov_b32 v23, 0
    ds_write_b128 v14, v[20:23]
    ds_write_b128 v14, v[20:23] offset:1024
    ds_write_b128 v14, v[20:23] offset:2048
    v_mov_b32 v15, 155692
    s_mov_b64 exec, 1
    ds_write_b32 v15, v26
    s_mov_b64 exec, -1
    s_waitcnt lgkmcnt(0)
L_only_5:
    s_barrier
    v_mov_b32 v14, 155692
    ds_read_b32 v14, v14
    s_getreg_b32 s73, hwreg(HW_REG_XCC_ID, 0, 4)
    s_waitcnt lgkmcnt(0)
    v_readfirstlane_b32 s15, v14
    s_nop 1
    s_or_b32 s73, s73, s15
    s_lshl_b32 s74, s66, 19
    s_cmp_eq_u32 s67, 1
    s_cbranch_scc1 L_h2_1
    s_cmp_eq_u32 s67, 2
    s_cbranch_scc1 L_h2_2
    s_cmp_eq_u32 s67, 3
    s_cbranch_scc1 L_h2_3
    v_min_u32 v36, 7, v166
    v_lshlrev_b32 v36, 8, v36
    v_add_u32 v36, 155904, v36
    v_mov_b32 v37, 155904
    v_mov_b32 v38, 155680
    v_lshrrev_b32 v17, 3, v166
    v_xor_b32 v17, s65, v17
    s_lshl_b32 s5, s66, 4
    v_add_u32 v17, s5, v17
    s_and_b32 s4, s65, 1
    s_lshl_b32 s6, s4, 2
    s_add_u32 s6, s6, 12984320
    v_and_b32 v18, 1, v166
    v_lshlrev_b32 v18, 3, v18
    v_lshl_add_u32 v20, v17, 7, v18
    v_add_u32 v20, s6, v20
    v_lshlrev_b32 v17, 2, v17
    v_add_u32 v17, 12976128, v17
    v_and_b32 v19, 4, v166
    v_cmp_eq_u32 vcc, 0, v19
    v_mov_b32 v19, s15
    v_mov_b32 v16, s73
    v_cndmask_b32 v21, v17, v20, vcc
    v_cndmask_b32 v22, v19, v16, vcc
    s_mov_b64 s[78:79], 0
    s_mov_b32 s80, 0
    s_lshl_b32 s4, s4, 14
    s_add_u32 s74, s74, s4
    s_mov_b32 s81, 0
    v_lshlrev_b32 v39, 2, v166
    v_add_u32 v23, 16, v20
    v_and_b32 v19, 4, v166
    v_cmp_eq_u32 vcc, 0, v19
    s_nop 1
    v_cndmask_b32 v23, v21, v23, vcc
    s_mov_b32 s96, 65536
    s_mov_b64 exec, 0x300
L_poll_6:
    buffer_load_dword v16, v23, s[48:51], 0 offen sc1
    s_waitcnt vmcnt(0)
    v_cmp_eq_u32 vcc, v22, v16
    s_sub_u32 s96, s96, 1
    s_nop 3
    s_cmp_ge_u32 vcc_lo, 0x300
    s_cbranch_scc1 L_polld_7
    s_cmp_eq_u32 s96, 0
    s_cbranch_scc1 L_polld_7
    s_cmp_lt_u32 s96, 65524
    s_cselect_b32 exec_lo, 0x1300, exec_lo
    s_branch L_poll_6
L_polld_7:
    s_mov_b64 exec, -1
    s_and_b32 s3, vcc_lo, 0x300
    s_cmp_eq_u32 s3, 0x300
    s_mov_b32 s6, 31457280
    s_cselect_b32 s6, 29360128, s6
    s_lshl_b32 s3, s66, 4
    s_xor_b32 s4, s65, 1
    s_add_u32 s3, s3, s4
    s_lshl_b32 s3, s3, 13
    s_add_u32 s77, s3, s6
    s_mov_b32 s76, 147456
    s_mov_b32 m0, s76
    s_add_u32 s76, s76, 4096
    buffer_load_dwordx4 v165, s[48:51], s77 offen offset:0 sc1 lds
    buffer_load_dwordx4 v165, s[48:51], s77 offen offset:1024 sc1 lds
    buffer_load_dwordx4 v165, s[48:51], s77 offen offset:2048 sc1 lds
    buffer_load_dwordx4 v165, s[48:51], s77 offen offset:3072 sc1 lds
    s_add_u32 s77, s77, 4096
    s_mov_b32 m0, s76
    s_add_u32 s76, s76, 4096
    buffer_load_dwordx4 v165, s[48:51], s77 offen offset:0 sc1 lds
    buffer_load_dwordx4 v165, s[48:51], s77 offen offset:1024 sc1 lds
    buffer_load_dwordx4 v165, s[48:51], s77 offen offset:2048 sc1 lds
    buffer_load_dwordx4 v165, s[48:51], s77 offen offset:3072 sc1 lds
    s_add_u32 s77, s77, 4096
    v_mov_b32 v14, 155688
    v_mov_b32 v15, 1
    s_waitcnt vmcnt(0)
    ds_write_b32 v14, v15
    s_bitcmp1_b64 s[78:79], 8
    s_cbranch_scc1 L_polld_9
    s_mov_b32 s96, 65536
    s_mov_b32 exec_lo, 0x03030300
    s_mov_b32 exec_hi, 0x03030303
L_poll_8:
    buffer_load_dword v16, v21, s[48:51], 0 offen sc1
    s_waitcnt vmcnt(0)
    v_cmp_eq_u32 vcc, v22, v16
    s_sub_u32 s96, s96, 1
    s_nop 2
    s_lshr_b64 s[4:5], vcc, 1
    s_and_b64 s[78:79], s[4:5], vcc
    s_bitcmp1_b64 s[78:79], 8
    s_cbranch_scc1 L_polld_9
    s_bitcmp1_b64 vcc, 12
    s_cbranch_scc1 L_polld_9
    s_cmp_eq_u32 s96, 0
    s_cbranch_scc1 L_polld_9
    s_cmp_lt_u32 s96, 65528
    s_cselect_b32 exec_lo, 0x13131300, exec_lo
    s_cselect_b32 exec_hi, 0x13131313, exec_hi
    s_sleep 1
    s_branch L_poll_8
L_polld_9:
    s_mov_b64 exec, -1
    s_xor_b32 s77, s65, 1
    s_bitcmp1_b64 s[78:79], 8
    s_cselect_b32 s6, 20971520, 0
    s_lshl_b32 s77, s77, 15
    s_add_u32 s77, s77, s74
    s_add_u32 s77, s77, s6
    s_mov_b32 s76, 16384
    s_mov_b32 m0, s76
    s_add_u32 s76, s76, 4096
    buffer_load_dwordx4 v165, s[48:51], s77 offen offset:0 sc1 lds
    buffer_load_dwordx4 v165, s[48:51], s77 offen offset:1024 sc1 lds
    buffer_load_dwordx4 v165, s[48:51], s77 offen offset:2048 sc1 lds
    buffer_load_dwordx4 v165, s[48:51], s77 offen offset:3072 sc1 lds
    s_add_u32 s77, s77, 4096
    s_mov_b32 m0, s76
    s_add_u32 s76, s76, 4096
    buffer_load_dwordx4 v165, s[48:51], s77 offen offset:0 sc1 lds
    buffer_load_dwordx4 v165, s[48:51], s77 offen offset:1024 sc1 lds
    buffer_load_dwordx4 v165, s[48:51], s77 offen offset:2048 sc1 lds
    buffer_load_dwordx4 v165, s[48:51], s77 offen offset:3072 sc1 lds
    s_add_u32 s77, s77, 4096
    s_mov_b32 m0, s76
    s_add_u32 s76, s76, 4096
    buffer_load_dwordx4 v165, s[48:51], s77 offen offset:0 sc1 lds
    buffer_load_dwordx4 v165, s[48:51], s77 offen offset:1024 sc1 lds
    buffer_load_dwordx4 v165, s[48:51], s77 offen offset:2048 sc1 lds
    buffer_load_dwordx4 v165, s[48:51], s77 offen offset:3072 sc1 lds
    s_add_u32 s77, s77, 4096
    s_mov_b32 m0, s76
    s_add_u32 s76, s76, 4096
    buffer_load_dwordx4 v165, s[48:51], s77 offen offset:0 sc1 lds
    buffer_load_dwordx4 v165, s[48:51], s77 offen offset:1024 sc1 lds
    buffer_load_dwordx4 v165, s[48:51], s77 offen offset:2048 sc1 lds
    buffer_load_dwordx4 v165, s[48:51], s77 offen offset:3072 sc1 lds
    s_add_u32 s77, s77, 4096
    s_waitcnt vmcnt(0)
    v_mov_b32 v15, 1
    ds_write_b32 v38, v15
    s_bitcmp1_b64 s[78:79], 16
    s_cbranch_scc1 L_polld_11
    s_waitcnt vmcnt(0)
    v_mov_b32 v15, 1
    ds_write_b32 v38, v15
    s_mov_b32 s96, 65536
    s_mov_b32 exec_lo, 0x03030300
    s_mov_b32 exec_hi, 0x03030303
L_poll_10:
    buffer_load_dword v16, v21, s[48:51], 0 offen sc1
    s_waitcnt vmcnt(0)
    v_cmp_eq_u32 vcc, v22, v16
    s_sub_u32 s96, s96, 1
    s_nop 2
    s_lshr_b64 s[4:5], vcc, 1
    s_and_b64 s[78:79], s[4:5], vcc
    s_bitcmp1_b64 s[78:79], 16
    s_cbranch_scc1 L_polld_11
    s_bitcmp1_b64 vcc, 20
    s_cbranch_scc1 L_polld_11
    s_cmp_eq_u32 s96, 0
    s_cbranch_scc1 L_polld_11
    s_cmp_lt_u32 s96, 65528
    s_cselect_b32 exec_lo, 0x13131300, exec_lo
    s_cselect_b32 exec_hi, 0x13131313, exec_hi
    s_sleep 1
    s_branch L_poll_10
L_polld_11:
    s_mov_b64 exec, -1
    s_xor_b32 s77, s65, 2
    s_bitcmp1_b64 s[78:79], 16
    s_cselect_b32 s6, 20971520, 0
    s_lshl_b32 s77, s77, 15
    s_add_u32 s77, s77, s74
    s_add_u32 s77, s77, s6
    s_mov_b32 s76, 32768
    s_mov_b32 m0, s76
    s_add_u32 s76, s76, 4096
    buffer_load_dwordx4 v165, s[48:51], s77 offen offset:0 sc1 lds
    buffer_load_dwordx4 v165, s[48:51], s77 offen offset:1024 sc1 lds
    buffer_load_dwordx4 v165, s[48:51], s77 offen offset:2048 sc1 lds
    buffer_load_dwordx4 v165, s[48:51], s77 offen offset:3072 sc1 lds
    s_add_u32 s77, s77, 4096
    s_mov_b32 m0, s76
    s_add_u32 s76, s76, 4096
    buffer_load_dwordx4 v165, s[48:51], s77 offen offset:0 sc1 lds
    buffer_load_dwordx4 v165, s[48:51], s77 offen offset:1024 sc1 lds
    buffer_load_dwordx4 v165, s[48:51], s77 offen offset:2048 sc1 lds
    buffer_load_dwordx4 v165, s[48:51], s77 offen offset:3072 sc1 lds
    s_add_u32 s77, s77, 4096
    s_mov_b32 m0, s76
    s_add_u32 s76, s76, 4096
    buffer_load_dwordx4 v165, s[48:51], s77 offen offset:0 sc1 lds
    buffer_load_dwordx4 v165, s[48:51], s77 offen offset:1024 sc1 lds
    buffer_load_dwordx4 v165, s[48:51], s77 offen offset:2048 sc1 lds
    buffer_load_dwordx4 v165, s[48:51], s77 offen offset:3072 sc1 lds
    s_add_u32 s77, s77, 4096
    s_mov_b32 m0, s76
    s_add_u32 s76, s76, 4096
    buffer_load_dwordx4 v165, s[48:51], s77 offen offset:0 sc1 lds
    buffer_load_dwordx4 v165, s[48:51], s77 offen offset:1024 sc1 lds
    buffer_load_dwordx4 v165, s[48:51], s77 offen offset:2048 sc1 lds
    buffer_load_dwordx4 v165, s[48:51], s77 offen offset:3072 sc1 lds
    s_add_u32 s77, s77, 4096
    s_waitcnt vmcnt(16)
    v_mov_b32 v15, 1
    ds_write_b32 v38, v15
    s_bitcmp1_b64 s[78:79], 24
    s_cbranch_scc1 L_polld_13
    s_waitcnt vmcnt(0)
    v_mov_b32 v15, 2
    ds_write_b32 v38, v15
    s_mov_b32 s96, 65536
    s_mov_b32 exec_lo, 0x03030300
    s_mov_b32 exec_hi, 0x03030303
L_poll_12:
    buffer_load_dword v16, v21, s[48:51], 0 offen sc1
    s_waitcnt vmcnt(0)
    v_cmp_eq_u32 vcc, v22, v16
    s_sub_u32 s96, s96, 1
    s_nop 2
    s_lshr_b64 s[4:5], vcc, 1
    s_and_b64 s[78:79], s[4:5], vcc
    s_bitcmp1_b64 s[78:79], 24
    s_cbranch_scc1 L_polld_13
    s_bitcmp1_b64 vcc, 28
    s_cbranch_scc1 L_polld_13
    s_cmp_eq_u32 s96, 0
    s_cbranch_scc1 L_polld_13
    s_cmp_lt_u32 s96, 65528
    s_cselect_b32 exec_lo, 0x13131300, exec_lo
    s_cselect_b32 exec_hi, 0x13131313, exec_hi
    s_sleep 1
    s_branch L_poll_12
L_polld_13:
    s_mov_b64 exec, -1
    s_xor_b32 s77, s65, 3
    s_bitcmp1_b64 s[78:79], 24
    s_cselect_b32 s6, 20971520, 0
    s_lshl_b32 s77, s77, 15
    s_add_u32 s77, s77, s74
    s_add_u32 s77, s77, s6
    s_mov_b32 s76, 49152
    s_mov_b32 m0, s76
    s_add_u32 s76, s76, 4096
    buffer_load_dwordx4 v165, s[48:51], s77 offen offset:0 sc1 lds
    buffer_load_dwordx4 v165, s[48:51], s77 offen offset:1024 sc1 lds
    buffer_load_dwordx4 v165, s[48:51], s77 offen offset:2048 sc1 lds
    buffer_load_dwordx4 v165, s[48:51], s77 offen offset:3072 sc1 lds
    s_add_u32 s77, s77, 4096
    s_mov_b32 m0, s76
    s_add_u32 s76, s76, 4096
    buffer_load_dwordx4 v165, s[48:51], s77 offen offset:0 sc1 lds
    buffer_load_dwordx4 v165, s[48:51], s77 offen offset:1024 sc1 lds
    buffer_load_dwordx4 v165, s[48:51], s77 offen offset:2048 sc1 lds
    buffer_load_dwordx4 v165, s[48:51], s77 offen offset:3072 sc1 lds
    s_add_u32 s77, s77, 4096
    s_mov_b32 m0, s76
    s_add_u32 s76, s76, 4096
    buffer_load_dwordx4 v165, s[48:51], s77 offen offset:0 sc1 lds
    buffer_load_dwordx4 v165, s[48:51], s77 offen offset:1024 sc1 lds
    buffer_load_dwordx4 v165, s[48:51], s77 offen offset:2048 sc1 lds
    buffer_load_dwordx4 v165, s[48:51], s77 offen offset:3072 sc1 lds
    s_add_u32 s77, s77, 4096
    s_mov_b32 m0, s76
    s_add_u32 s76, s76, 4096
    buffer_load_dwordx4 v165, s[48:51], s77 offen offset:0 sc1 lds
    buffer_load_dwordx4 v165, s[48:51], s77 offen offset:1024 sc1 lds
    buffer_load_dwordx4 v165, s[48:51], s77 offen offset:2048 sc1 lds
    buffer_load_dwordx4 v165, s[48:51], s77 offen offset:3072 sc1 lds
    s_add_u32 s77, s77, 4096
    s_waitcnt vmcnt(16)
    v_mov_b32 v15, 2
    ds_write_b32 v38, v15
    s_bitcmp1_b64 s[78:79], 32
    s_cbranch_scc1 L_polld_15
    s_waitcnt vmcnt(0)
    v_mov_b32 v15, 3
    ds_write_b32 v38, v15
    s_mov_b32 s96, 65536
    s_mov_b32 exec_lo, 0x03030300
    s_mov_b32 exec_hi, 0x03030303
L_poll_14:
    buffer_load_dword v16, v21, s[48:51], 0 offen sc1
    s_waitcnt vmcnt(0)
    v_cmp_eq_u32 vcc, v22, v16
    s_sub_u32 s96, s96, 1
    s_nop 2
    s_lshr_b64 s[4:5], vcc, 1
    s_and_b64 s[78:79], s[4:5], vcc
    s_bitcmp1_b64 s[78:79], 32
    s_cbranch_scc1 L_polld_15
    s_bitcmp1_b64 vcc, 36
    s_cbranch_scc1 L_polld_15
    s_cmp_eq_u32 s96, 0
    s_cbranch_scc1 L_polld_15
    s_cmp_lt_u32 s96, 65528
    s_cselect_b32 exec_lo, 0x13131300, exec_lo
    s_cselect_b32 exec_hi, 0x13131313, exec_hi
    s_sleep 1
    s_branch L_poll_14
L_polld_15:
    s_mov_b64 exec, -1
    s_xor_b32 s77, s65, 4
    s_bitcmp1_b64 s[78:79], 32
    s_cselect_b32 s6, 20971520, 0
    s_lshl_b32 s77, s77, 15
    s_add_u32 s77, s77, s74
    s_add_u32 s77, s77, s6
    s_mov_b32 s76, 65536
    s_mov_b32 m0, s76
    s_add_u32 s76, s76, 4096
    buffer_load_dwordx4 v165, s[48:51], s77 offen offset:0 sc1 lds
    buffer_load_dwordx4 v165, s[48:51], s77 offen offset:1024 sc1 lds
    buffer_load_dwordx4 v165, s[48:51], s77 offen offset:2048 sc1 lds
    buffer_load_dwordx4 v165, s[48:51], s77 offen offset:3072 sc1 lds
    s_add_u32 s77, s77, 4096
    s_mov_b32 m0, s76
    s_add_u32 s76, s76, 4096
    buffer_load_dwordx4 v165, s[48:51], s77 offen offset:0 sc1 lds
    buffer_load_dwordx4 v165, s[48:51], s77 offen offset:1024 sc1 lds
    buffer_load_dwordx4 v165, s[48:51], s77 offen offset:2048 sc1 lds
    buffer_load_dwordx4 v165, s[48:51], s77 offen offset:3072 sc1 lds
    s_add_u32 s77, s77, 4096
    s_mov_b32 m0, s76
    s_add_u32 s76, s76, 4096
    buffer_load_dwordx4 v165, s[48:51], s77 offen offset:0 sc1 lds
    buffer_load_dwordx4 v165, s[48:51], s77 offen offset:1024 sc1 lds
    buffer_load_dwordx4 v165, s[48:51], s77 offen offset:2048 sc1 lds
    buffer_load_dwordx4 v165, s[48:51], s77 offen offset:3072 sc1 lds
    s_add_u32 s77, s77, 4096
    s_mov_b32 m0, s76
    s_add_u32 s76, s76, 4096
    buffer_load_dwordx4 v165, s[48:51], s77 offen offset:0 sc1 lds
    buffer_load_dwordx4 v165, s[48:51], s77 offen offset:1024 sc1 lds
    buffer_load_dwordx4 v165, s[48:51], s77 offen offset:2048 sc1 lds
    buffer_load_dwordx4 v165, s[48:51], s77 offen offset:3072 sc1 lds
    s_add_u32 s77, s77, 4096
    s_waitcnt vmcnt(16)
    v_mov_b32 v15, 3
    ds_write_b32 v38, v15
    s_bitcmp1_b64 s[78:79], 40
    s_cbranch_scc1 L_polld_17
    s_waitcnt vmcnt(0)
    v_mov_b32 v15, 4
    ds_write_b32 v38, v15
    s_mov_b32 s96, 65536
    s_mov_b32 exec_lo, 0x03030300
    s_mov_b32 exec_hi, 0x03030303
L_poll_16:
    buffer_load_dword v16, v21, s[48:51], 0 offen sc1
    s_waitcnt vmcnt(0)
    v_cmp_eq_u32 vcc, v22, v16
    s_sub_u32 s96, s96, 1
    s_nop 2
    s_lshr_b64 s[4:5], vcc, 1
    s_and_b64 s[78:79], s[4:5], vcc
    s_bitcmp1_b64 s[78:79], 40
    s_cbranch_scc1 L_polld_17
    s_bitcmp1_b64 vcc, 44
    s_cbranch_scc1 L_polld_17
    s_cmp_eq_u32 s96, 0
    s_cbranch_scc1 L_polld_17
    s_cmp_lt_u32 s96, 65528
    s_cselect_b32 exec_lo, 0x13131300, exec_lo
    s_cselect_b32 exec_hi, 0x13131313, exec_hi
    s_sleep 1
    s_branch L_poll_16
L_polld_17:
    s_mov_b64 exec, -1
    s_xor_b32 s77, s65, 5
    s_bitcmp1_b64 s[78:79], 40
    s_cselect_b32 s6, 20971520, 0
    s_lshl_b32 s77, s77, 15
    s_add_u32 s77, s77, s74
    s_add_u32 s77, s77, s6
    s_mov_b32 s76, 81920
    s_mov_b32 m0, s76
    s_add_u32 s76, s76, 4096
    buffer_load_dwordx4 v165, s[48:51], s77 offen offset:0 sc1 lds
    buffer_load_dwordx4 v165, s[48:51], s77 offen offset:1024 sc1 lds
    buffer_load_dwordx4 v165, s[48:51], s77 offen offset:2048 sc1 lds
    buffer_load_dwordx4 v165, s[48:51], s77 offen offset:3072 sc1 lds
    s_add_u32 s77, s77, 4096
    s_mov_b32 m0, s76
    s_add_u32 s76, s76, 4096
    buffer_load_dwordx4 v165, s[48:51], s77 offen offset:0 sc1 lds
    buffer_load_dwordx4 v165, s[48:51], s77 offen offset:1024 sc1 lds
    buffer_load_dwordx4 v165, s[48:51], s77 offen offset:2048 sc1 lds
    buffer_load_dwordx4 v165, s[48:51], s77 offen offset:3072 sc1 lds
    s_add_u32 s77, s77, 4096
    s_mov_b32 m0, s76
    s_add_u32 s76, s76, 4096
    buffer_load_dwordx4 v165, s[48:51], s77 offen offset:0 sc1 lds
    buffer_load_dwordx4 v165, s[48:51], s77 offen offset:1024 sc1 lds
    buffer_load_dwordx4 v165, s[48:51], s77 offen offset:2048 sc1 lds
    buffer_load_dwordx4 v165, s[48:51], s77 offen offset:3072 sc1 lds
    s_add_u32 s77, s77, 4096
    s_mov_b32 m0, s76
    s_add_u32 s76, s76, 4096
    buffer_load_dwordx4 v165, s[48:51], s77 offen offset:0 sc1 lds
    buffer_load_dwordx4 v165, s[48:51], s77 offen offset:1024 sc1 lds
    buffer_load_dwordx4 v165, s[48:51], s77 offen offset:2048 sc1 lds
    buffer_load_dwordx4 v165, s[48:51], s77 offen offset:3072 sc1 lds
    s_add_u32 s77, s77, 4096
    s_waitcnt vmcnt(16)
    v_mov_b32 v15, 4
    ds_write_b32 v38, v15
    s_bitcmp1_b64 s[78:79], 48
    s_cbranch_scc1 L_polld_19
    s_waitcnt vmcnt(0)
    v_mov_b32 v15, 5
    ds_write_b32 v38, v15
    s_mov_b32 s96, 65536
    s_mov_b32 exec_lo, 0x03030300
    s_mov_b32 exec_hi, 0x03030303
L_poll_18:
    buffer_load_dword v16, v21, s[48:51], 0 offen sc1
    s_waitcnt vmcnt(0)
    v_cmp_eq_u32 vcc, v22, v16
    s_sub_u32 s96, s96, 1
    s_nop 2
    s_lshr_b64 s[4:5], vcc, 1
    s_and_b64 s[78:79], s[4:5], vcc
    s_bitcmp1_b64 s[78:79], 48
    s_cbranch_scc1 L_polld_19
    s_bitcmp1_b64 vcc, 52
    s_cbranch_scc1 L_polld_19
    s_cmp_eq_u32 s96, 0
    s_cbranch_scc1 L_polld_19
    s_cmp_lt_u32 s96, 65528
    s_cselect_b32 exec_lo, 0x13131300, exec_lo
    s_cselect_b32 exec_hi, 0x13131313, exec_hi
    s_sleep 1
    s_branch L_poll_18
L_polld_19:
    s_mov_b64 exec, -1
    s_xor_b32 s77, s65, 6
    s_bitcmp1_b64 s[78:79], 48
    s_cselect_b32 s6, 20971520, 0
    s_lshl_b32 s77, s77, 15
    s_add_u32 s77, s77, s74
    s_add_u32 s77, s77, s6
    s_mov_b32 s76, 98304
    s_mov_b32 m0, s76
    s_add_u32 s76, s76, 4096
    buffer_load_dwordx4 v165, s[48:51], s77 offen offset:0 sc1 lds
    buffer_load_dwordx4 v165, s[48:51], s77 offen offset:1024 sc1 lds
    buffer_load_dwordx4 v165, s[48:51], s77 offen offset:2048 sc1 lds
    buffer_load_dwordx4 v165, s[48:51], s77 offen offset:3072 sc1 lds
    s_add_u32 s77, s77, 4096
    s_mov_b32 m0, s76
    s_add_u32 s76, s76, 4096
    buffer_load_dwordx4 v165, s[48:51], s77 offen offset:0 sc1 lds
    buffer_load_dwordx4 v165, s[48:51], s77 offen offset:1024 sc1 lds
    buffer_load_dwordx4 v165, s[48:51], s77 offen offset:2048 sc1 lds
    buffer_load_dwordx4 v165, s[48:51], s77 offen offset:3072 sc1 lds
    s_add_u32 s77, s77, 4096
    s_mov_b32 m0, s76
    s_add_u32 s76, s76, 4096
    buffer_load_dwordx4 v165, s[48:51], s77 offen offset:0 sc1 lds
    buffer_load_dwordx4 v165, s[48:51], s77 offen offset:1024 sc1 lds
    buffer_load_dwordx4 v165, s[48:51], s77 offen offset:2048 sc1 lds
    buffer_load_dwordx4 v165, s[48:51], s77 offen offset:3072 sc1 lds
    s_add_u32 s77, s77, 4096
    s_mov_b32 m0, s76
    s_add_u32 s76, s76, 4096
    buffer_load_dwordx4 v165, s[48:51], s77 offen offset:0 sc1 lds
    buffer_load_dwordx4 v165, s[48:51], s77 offen offset:1024 sc1 lds
    buffer_load_dwordx4 v165, s[48:51], s77 offen offset:2048 sc1 lds
    buffer_load_dwordx4 v165, s[48:51], s77 offen offset:3072 sc1 lds
    s_add_u32 s77, s77, 4096
    s_waitcnt vmcnt(16)
    v_mov_b32 v15, 5
    ds_write_b32 v38, v15
    s_bitcmp1_b64 s[78:79], 56
    s_cbranch_scc1 L_polld_21
    s_waitcnt vmcnt(0)
    v_mov_b32 v15, 6
    ds_write_b32 v38, v15
    s_mov_b32 s96, 65536
    s_mov_b32 exec_lo, 0x03030300
    s_mov_b32 exec_hi, 0x03030303
L_poll_20:
    buffer_load_dword v16, v21, s[48:51], 0 offen sc1
    s_waitcnt vmcnt(0)
    v_cmp_eq_u32 vcc, v22, v16
    s_sub_u32 s96, s96, 1
    s_nop 2
    s_lshr_b64 s[4:5], vcc, 1
    s_and_b64 s[78:79], s[4:5], vcc
    s_bitcmp1_b64 s[78:79], 56
    s_cbranch_scc1 L_polld_21
    s_bitcmp1_b64 vcc, 60
    s_cbranch_scc1 L_polld_21
    s_cmp_eq_u32 s96, 0
    s_cbranch_scc1 L_polld_21
    s_cmp_lt_u32 s96, 65528
    s_cselect_b32 exec_lo, 0x13131300, exec_lo
    s_cselect_b32 exec_hi, 0x13131313, exec_hi
    s_sleep 1
    s_branch L_poll_20
L_polld_21:
    s_mov_b64 exec, -1
    v_mov_b32 v14, 155664
    s_mov_b32 s96, 1048576
L_spin_22:
    ds_read_b32 v16, v14
    s_waitcnt lgkmcnt(0)
    v_cmp_gt_u32 vcc, 1, v16
    s_sub_u32 s96, s96, 1
    s_cmp_eq_u32 s96, 0
    s_cbranch_scc1 L_spind_23
    s_nop 2
    s_cbranch_vccz L_spind_23
    s_sleep 2
    s_branch L_spin_22
L_spind_23:
    s_xor_b32 s77, s65, 7
    s_bitcmp1_b64 s[78:79], 56
    s_cselect_b32 s6, 20971520, 0
    s_lshl_b32 s77, s77, 15
    s_add_u32 s77, s77, s74
    s_add_u32 s77, s77, s6
    s_mov_b32 s76, 114688
    s_mov_b32 m0, s76
    s_add_u32 s76, s76, 4096
    buffer_load_dwordx4 v165, s[48:51], s77 offen offset:0 sc1 lds
    buffer_load_dwordx4 v165, s[48:51], s77 offen offset:1024 sc1 lds
    buffer_load_dwordx4 v165, s[48:51], s77 offen offset:2048 sc1 lds
    buffer_load_dwordx4 v165, s[48:51], s77 offen offset:3072 sc1 lds
    s_add_u32 s77, s77, 4096
    s_mov_b32 m0, s76
    s_add_u32 s76, s76, 4096
    buffer_load_dwordx4 v165, s[48:51], s77 offen offset:0 sc1 lds
    buffer_load_dwordx4 v165, s[48:51], s77 offen offset:1024 sc1 lds
    buffer_load_dwordx4 v165, s[48:51], s77 offen offset:2048 sc1 lds
    buffer_load_dwordx4 v165, s[48:51], s77 offen offset:3072 sc1 lds
    s_add_u32 s77, s77, 4096
    s_mov_b32 m0, s76
    s_add_u32 s76, s76, 4096
    buffer_load_dwordx4 v165, s[48:51], s77 offen offset:0 sc1 lds
    buffer_load_dwordx4 v165, s[48:51], s77 offen offset:1024 sc1 lds
    buffer_load_dwordx4 v165, s[48:51], s77 offen offset:2048 sc1 lds
    buffer_load_dwordx4 v165, s[48:51], s77 offen offset:3072 sc1 lds
    s_add_u32 s77, s77, 4096
    s_mov_b32 m0, s76
    s_add_u32 s76, s76, 4096
    buffer_load_dwordx4 v165, s[48:51], s77 offen offset:0 sc1 lds
    buffer_load_dwordx4 v165, s[48:51], s77 offen offset:1024 sc1 lds
    buffer_load_dwordx4 v165, s[48:51], s77 offen offset:2048 sc1 lds
    buffer_load_dwordx4 v165, s[48:51], s77 offen offset:3072 sc1 lds
    s_add_u32 s77, s77, 4096
    s_waitcnt vmcnt(16)
    v_mov_b32 v15, 6
    ds_write_b32 v38, v15
    ds_read_b32 v16, v36
    s_waitcnt lgkmcnt(0)
    v_cmp_gt_u32 vcc, 3, v16
    s_nop 4
    s_cbranch_vccz L_free_24
    s_waitcnt vmcnt(0)
    v_mov_b32 v15, 7
    ds_write_b32 v38, v15
    s_mov_b32 s96, 1048576
L_spin_25:
    ds_read_b32 v16, v36
    s_waitcnt lgkmcnt(0)
    v_cmp_gt_u32 vcc, 3, v16
    s_sub_u32 s96, s96, 1
    s_cmp_eq_u32 s96, 0
    s_cbranch_scc1 L_spind_26
    s_nop 2
    s_cbranch_vccz L_spind_26
    s_sleep 4
    s_branch L_spin_25
L_spind_26:
L_free_24:
    s_andn2_b32 s3, s80, s81
    s_cbranch_scc1 L_polld_28
    s_waitcnt vmcnt(0)
    v_mov_b32 v15, 7
    ds_write_b32 v38, v15
    s_lshl_b32 s5, s66, 4
    s_and_b32 s4, s65, 8
    s_xor_b32 s4, s4, 8
    s_add_u32 s5, s5, s4
    s_lshl_b32 s5, s5, 2
    s_add_u32 s5, s5, 12976128
    s_mov_b32 s96, 65536
    s_mov_b64 exec, 0xff
L_poll_27:
    buffer_load_dword v16, v39, s[48:51], s5 offen sc1
    s_waitcnt vmcnt(0)
    v_cmp_eq_u32 vcc, s15, v16
    s_sub_u32 s96, s96, 1
    s_cmp_eq_u32 s96, 0
    s_cselect_b32 s3, 0xff, 0
    s_nop 1
    s_or_b32 s80, vcc_lo, s3
    s_andn2_b32 s3, s80, s81
    s_cbranch_scc1 L_polld_28
    s_sleep 10
    s_branch L_poll_27
L_polld_28:
    s_mov_b64 exec, -1
    s_and_b32 s5, s65, 6
    s_lshl_b32 s4, s3, 8
    s_or_b32 s3, s3, s4
    s_lshr_b32 s3, s3, s5
    s_ff1_i32_b32 s3, s3
    s_add_u32 s3, s3, s5
    s_and_b32 s3, s3, 7
    s_bitset1_b32 s81, s3
    s_and_b32 s4, s65, 8
    s_xor_b32 s4, s4, 8
    s_or_b32 s77, s3, s4
    s_mov_b32 s6, 0
    s_lshl_b32 s77, s77, 15
    s_add_u32 s77, s77, s74
    s_add_u32 s77, s77, s6
    s_mov_b32 s76, 0
    s_mov_b32 m0, s76
    s_add_u32 s76, s76, 4096
    buffer_load_dwordx4 v165, s[48:51], s77 offen offset:0 sc1 lds
    buffer_load_dwordx4 v165, s[48:51], s77 offen offset:1024 sc1 lds
    buffer_load_dwordx4 v165, s[48:51], s77 offen offset:2048 sc1 lds
    buffer_load_dwordx4 v165, s[48:51], s77 offen offset:3072 sc1 lds
    s_add_u32 s77, s77, 4096
    s_mov_b32 m0, s76
    s_add_u32 s76, s76, 4096
    buffer_load_dwordx4 v165, s[48:51], s77 offen offset:0 sc1 lds
    buffer_load_dwordx4 v165, s[48:51], s77 offen offset:1024 sc1 lds
    buffer_load_dwordx4 v165, s[48:51], s77 offen offset:2048 sc1 lds
    buffer_load_dwordx4 v165, s[48:51], s77 offen offset:3072 sc1 lds
    s_add_u32 s77, s77, 4096
    s_mov_b32 m0, s76
    s_add_u32 s76, s76, 4096
    buffer_load_dwordx4 v165, s[48:51], s77 offen offset:0 sc1 lds
    buffer_load_dwordx4 v165, s[48:51], s77 offen offset:1024 sc1 lds
    buffer_load_dwordx4 v165, s[48:51], s77 offen offset:2048 sc1 lds
    buffer_load_dwordx4 v165, s[48:51], s77 offen offset:3072 sc1 lds
    s_add_u32 s77, s77, 4096
    s_mov_b32 m0, s76
    s_add_u32 s76, s76, 4096
    buffer_load_dwordx4 v165, s[48:51], s77 offen offset:0 sc1 lds
    buffer_load_dwordx4 v165, s[48:51], s77 offen offset:1024 sc1 lds
    buffer_load_dwordx4 v165, s[48:51], s77 offen offset:2048 sc1 lds
    buffer_load_dwordx4 v165, s[48:51], s77 offen offset:3072 sc1 lds
    s_add_u32 s77, s77, 4096
    s_waitcnt vmcnt(16)
    v_mov_b32 v15, 7
    ds_write_b32 v38, v15
    ds_read_b32 v16, v36
    s_waitcnt lgkmcnt(0)
    v_cmp_gt_u32 vcc, 3, v16
    s_nop 4
    s_cbranch_vccz L_free_29
    s_waitcnt vmcnt(0)
    v_mov_b32 v15, 8
    ds_write_b32 v38, v15
    s_mov_b32 s96, 1048576
L_spin_30:
    ds_read_b32 v16, v36
    s_waitcnt lgkmcnt(0)
    v_cmp_gt_u32 vcc, 3, v16
    s_sub_u32 s96, s96, 1
    s_cmp_eq_u32 s96, 0
    s_cbranch_scc1 L_spind_31
    s_nop 2
    s_cbranch_vccz L_spind_31
    s_sleep 4
    s_branch L_spin_30
L_spind_31:
L_free_29:
    s_andn2_b32 s3, s80, s81
    s_cbranch_scc1 L_polld_33
    s_waitcnt vmcnt(0)
    v_mov_b32 v15, 8
    ds_write_b32 v38, v15
    s_lshl_b32 s5, s66, 4
    s_and_b32 s4, s65, 8
    s_xor_b32 s4, s4, 8
    s_add_u32 s5, s5, s4
    s_lshl_b32 s5, s5, 2
    s_add_u32 s5, s5, 12976128
    s_mov_b32 s96, 65536
    s_mov_b64 exec, 0xff
L_poll_32:
    buffer_load_dword v16, v39, s[48:51], s5 offen sc1
    s_waitcnt vmcnt(0)
    v_cmp_eq_u32 vcc, s15, v16
    s_sub_u32 s96, s96, 1
    s_cmp_eq_u32 s96, 0
    s_cselect_b32 s3, 0xff, 0
    s_nop 1
    s_or_b32 s80, vcc_lo, s3
    s_andn2_b32 s3, s80, s81
    s_cbranch_scc1 L_polld_33
    s_sleep 10
    s_branch L_poll_32
L_polld_33:
    s_mov_b64 exec, -1
    s_and_b32 s5, s65, 6
    s_lshl_b32 s4, s3, 8
    s_or_b32 s3, s3, s4
    s_lshr_b32 s3, s3, s5
    s_ff1_i32_b32 s3, s3
    s_add_u32 s3, s3, s5
    s_and_b32 s3, s3, 7
    s_bitset1_b32 s81, s3
    s_and_b32 s4, s65, 8
    s_xor_b32 s4, s4, 8
    s_or_b32 s77, s3, s4
    s_mov_b32 s6, 0
    s_lshl_b32 s77, s77, 15
    s_add_u32 s77, s77, s74
    s_add_u32 s77, s77, s6
    s_mov_b32 s76, 16384
    s_mov_b32 m0, s76
    s_add_u32 s76, s76, 4096
    buffer_load_dwordx4 v165, s[48:51], s77 offen offset:0 sc1 lds
    buffer_load_dwordx4 v165, s[48:51], s77 offen offset:1024 sc1 lds
    buffer_load_dwordx4 v165, s[48:51], s77 offen offset:2048 sc1 lds
    buffer_load_dwordx4 v165, s[48:51], s77 offen offset:3072 sc1 lds
    s_add_u32 s77, s77, 4096
    s_mov_b32 m0, s76
    s_add_u32 s76, s76, 4096
    buffer_load_dwordx4 v165, s[48:51], s77 offen offset:0 sc1 lds
    buffer_load_dwordx4 v165, s[48:51], s77 offen offset:1024 sc1 lds
    buffer_load_dwordx4 v165, s[48:51], s77 offen offset:2048 sc1 lds
    buffer_load_dwordx4 v165, s[48:51], s77 offen offset:3072 sc1 lds
    s_add_u32 s77, s77, 4096
    s_mov_b32 m0, s76
    s_add_u32 s76, s76, 4096
    buffer_load_dwordx4 v165, s[48:51], s77 offen offset:0 sc1 lds
    buffer_load_dwordx4 v165, s[48:51], s77 offen offset:1024 sc1 lds
    buffer_load_dwordx4 v165, s[48:51], s77 offen offset:2048 sc1 lds
    buffer_load_dwordx4 v165, s[48:51], s77 offen offset:3072 sc1 lds
    s_add_u32 s77, s77, 4096
    s_mov_b32 m0, s76
    s_add_u32 s76, s76, 4096
    buffer_load_dwordx4 v165, s[48:51], s77 offen offset:0 sc1 lds
    buffer_load_dwordx4 v165, s[48:51], s77 offen offset:1024 sc1 lds
    buffer_load_dwordx4 v165, s[48:51], s77 offen offset:2048 sc1 lds
    buffer_load_dwordx4 v165, s[48:51], s77 offen offset:3072 sc1 lds
    s_add_u32 s77, s77, 4096
    s_waitcnt vmcnt(16)
    v_mov_b32 v15, 8
    ds_write_b32 v38, v15
    ds_read_b32 v16, v36
    s_waitcnt lgkmcnt(0)
    v_cmp_gt_u32 vcc, 3, v16
    s_nop 4
    s_cbranch_vccz L_free_34
    s_waitcnt vmcnt(0)
    v_mov_b32 v15, 9
    ds_write_b32 v38, v15
    s_mov_b32 s96, 1048576
L_spin_35:
    ds_read_b32 v16, v36
    s_waitcnt lgkmcnt(0)
    v_cmp_gt_u32 vcc, 3, v16
    s_sub_u32 s96, s96, 1
    s_cmp_eq_u32 s96, 0
    s_cbranch_scc1 L_spind_36
    s_nop 2
    s_cbranch_vccz L_spind_36
    s_sleep 4
    s_branch L_spin_35
L_spind_36:
L_free_34:
    s_andn2_b32 s3, s80, s81
    s_cbranch_scc1 L_polld_38
    s_waitcnt vmcnt(0)
    v_mov_b32 v15, 9
    ds_write_b32 v38, v15
    s_lshl_b32 s5, s66, 4
    s_and_b32 s4, s65, 8
    s_xor_b32 s4, s4, 8
    s_add_u32 s5, s5, s4
    s_lshl_b32 s5, s5, 2
    s_add_u32 s5, s5, 12976128
    s_mov_b32 s96, 65536
    s_mov_b64 exec, 0xff
L_poll_37:
    buffer_load_dword v16, v39, s[48:51], s5 offen sc1
    s_waitcnt vmcnt(0)
    v_cmp_eq_u32 vcc, s15, v16
    s_sub_u32 s96, s96, 1
    s_cmp_eq_u32 s96, 0
    s_cselect_b32 s3, 0xff, 0
    s_nop 1
    s_or_b32 s80, vcc_lo, s3
    s_andn2_b32 s3, s80, s81
    s_cbranch_scc1 L_polld_38
    s_sleep 10
    s_branch L_poll_37
L_polld_38:
    s_mov_b64 exec, -1
    s_and_b32 s5, s65, 6
    s_lshl_b32 s4, s3, 8
    s_or_b32 s3, s3, s4
    s_lshr_b32 s3, s3, s5
    s_ff1_i32_b32 s3, s3
    s_add_u32 s3, s3, s5
    s_and_b32 s3, s3, 7
    s_bitset1_b32 s81, s3
    s_and_b32 s4, s65, 8
    s_xor_b32 s4, s4, 8
    s_or_b32 s77, s3, s4
    s_mov_b32 s6, 0
    s_lshl_b32 s77, s77, 15
    s_add_u32 s77, s77, s74
    s_add_u32 s77, s77, s6
    s_mov_b32 s76, 32768
    s_mov_b32 m0, s76
    s_add_u32 s76, s76, 4096
    buffer_load_dwordx4 v165, s[48:51], s77 offen offset:0 sc1 lds
    buffer_load_dwordx4 v165, s[48:51], s77 offen offset:1024 sc1 lds
    buffer_load_dwordx4 v165, s[48:51], s77 offen offset:2048 sc1 lds
    buffer_load_dwordx4 v165, s[48:51], s77 offen offset:3072 sc1 lds
    s_add_u32 s77, s77, 4096
    s_mov_b32 m0, s76
    s_add_u32 s76, s76, 4096
    buffer_load_dwordx4 v165, s[48:51], s77 offen offset:0 sc1 lds
    buffer_load_dwordx4 v165, s[48:51], s77 offen offset:1024 sc1 lds
    buffer_load_dwordx4 v165, s[48:51], s77 offen offset:2048 sc1 lds
    buffer_load_dwordx4 v165, s[48:51], s77 offen offset:3072 sc1 lds
    s_add_u32 s77, s77, 4096
    s_mov_b32 m0, s76
    s_add_u32 s76, s76, 4096
    buffer_load_dwordx4 v165, s[48:51], s77 offen offset:0 sc1 lds
    buffer_load_dwordx4 v165, s[48:51], s77 offen offset:1024 sc1 lds
    buffer_load_dwordx4 v165, s[48:51], s77 offen offset:2048 sc1 lds
    buffer_load_dwordx4 v165, s[48:51], s77 offen offset:3072 sc1 lds
    s_add_u32 s77, s77, 4096
    s_mov_b32 m0, s76
    s_add_u32 s76, s76, 4096
    buffer_load_dwordx4 v165, s[48:51], s77 offen offset:0 sc1 lds
    buffer_load_dwordx4 v165, s[48:51], s77 offen offset:1024 sc1 lds
    buffer_load_dwordx4 v165, s[48:51], s77 offen offset:2048 sc1 lds
    buffer_load_dwordx4 v165, s[48:51], s77 offen offset:3072 sc1 lds
    s_add_u32 s77, s77, 4096
    s_waitcnt vmcnt(16)
    v_mov_b32 v15, 9
    ds_write_b32 v38, v15
    v_mov_b32 v14, 155668
    s_mov_b32 s96, 1048576
L_spin_39:
    ds_read_b32 v16, v14
    s_waitcnt lgkmcnt(0)
    v_cmp_gt_u32 vcc, 1, v16
    s_sub_u32 s96, s96, 1
    s_cmp_eq_u32 s96, 0
    s_cbranch_scc1 L_spind_40
    s_nop 2
    s_cbranch_vccz L_spind_40
    s_sleep 4
    s_branch L_spin_39
L_spind_40:
    ds_read_b32 v16, v36
    s_waitcnt lgkmcnt(0)
    v_cmp_gt_u32 vcc, 4, v16
    s_nop 4
    s_cbranch_vccz L_free_41
    s_waitcnt vmcnt(0)
    v_mov_b32 v15, 10
    ds_write_b32 v38, v15
    s_mov_b32 s96, 1048576
L_spin_42:
    ds_read_b32 v16, v36
    s_waitcnt lgkmcnt(0)
    v_cmp_gt_u32 vcc, 4, v16
    s_sub_u32 s96, s96, 1
    s_cmp_eq_u32 s96, 0
    s_cbranch_scc1 L_spind_43
    s_nop 2
    s_cbranch_vccz L_spind_43
    s_sleep 4
    s_branch L_spin_42
L_spind_43:
L_free_41:
    s_andn2_b32 s3, s80, s81
    s_cbranch_scc1 L_polld_45
    s_waitcnt vmcnt(0)
    v_mov_b32 v15, 10
    ds_write_b32 v38, v15
    s_lshl_b32 s5, s66, 4
    s_and_b32 s4, s65, 8
    s_xor_b32 s4, s4, 8
    s_add_u32 s5, s5, s4
    s_lshl_b32 s5, s5, 2
    s_add_u32 s5, s5, 12976128
    s_mov_b32 s96, 65536
    s_mov_b64 exec, 0xff
L_poll_44:
    buffer_load_dword v16, v39, s[48:51], s5 offen sc1
    s_waitcnt vmcnt(0)
    v_cmp_eq_u32 vcc, s15, v16
    s_sub_u32 s96, s96, 1
    s_cmp_eq_u32 s96, 0
    s_cselect_b32 s3, 0xff, 0
    s_nop 1
    s_or_b32 s80, vcc_lo, s3
    s_andn2_b32 s3, s80, s81
    s_cbranch_scc1 L_polld_45
    s_sleep 10
    s_branch L_poll_44
L_polld_45:
    s_mov_b64 exec, -1
    s_and_b32 s5, s65, 6
    s_lshl_b32 s4, s3, 8
    s_or_b32 s3, s3, s4
    s_lshr_b32 s3, s3, s5
    s_ff1_i32_b32 s3, s3
    s_add_u32 s3, s3, s5
    s_and_b32 s3, s3, 7
    s_bitset1_b32 s81, s3
    s_and_b32 s4, s65, 8
    s_xor_b32 s4, s4, 8
    s_or_b32 s77, s3, s4
    s_mov_b32 s6, 0
    s_lshl_b32 s77, s77, 15
    s_add_u32 s77, s77, s74
    s_add_u32 s77, s77, s6
    s_mov_b32 s76, 49152
    s_mov_b32 m0, s76
    s_add_u32 s76, s76, 4096
    buffer_load_dwordx4 v165, s[48:51], s77 offen offset:0 sc1 lds
    buffer_load_dwordx4 v165, s[48:51], s77 offen offset:1024 sc1 lds
    buffer_load_dwordx4 v165, s[48:51], s77 offen offset:2048 sc1 lds
    buffer_load_dwordx4 v165, s[48:51], s77 offen offset:3072 sc1 lds
    s_add_u32 s77, s77, 4096
    s_mov_b32 m0, s76
    s_add_u32 s76, s76, 4096
    buffer_load_dwordx4 v165, s[48:51], s77 offen offset:0 sc1 lds
    buffer_load_dwordx4 v165, s[48:51], s77 offen offset:1024 sc1 lds
    buffer_load_dwordx4 v165, s[48:51], s77 offen offset:2048 sc1 lds
    buffer_load_dwordx4 v165, s[48:51], s77 offen offset:3072 sc1 lds
    s_add_u32 s77, s77, 4096
    s_mov_b32 m0, s76
    s_add_u32 s76, s76, 4096
    buffer_load_dwordx4 v165, s[48:51], s77 offen offset:0 sc1 lds
    buffer_load_dwordx4 v165, s[48:51], s77 offen offset:1024 sc1 lds
    buffer_load_dwordx4 v165, s[48:51], s77 offen offset:2048 sc1 lds
    buffer_load_dwordx4 v165, s[48:51], s77 offen offset:3072 sc1 lds
    s_add_u32 s77, s77, 4096
    s_mov_b32 m0, s76
    s_add_u32 s76, s76, 4096
    buffer_load_dwordx4 v165, s[48:51], s77 offen offset:0 sc1 lds
    buffer_load_dwordx4 v165, s[48:51], s77 offen offset:1024 sc1 lds
    buffer_load_dwordx4 v165, s[48:51], s77 offen offset:2048 sc1 lds
    buffer_load_dwordx4 v165, s[48:51], s77 offen offset:3072 sc1 lds
    s_add_u32 s77, s77, 4096
    s_waitcnt vmcnt(16)
    v_mov_b32 v15, 10
    ds_write_b32 v38, v15
    ds_read_b32 v16, v36
    s_waitcnt lgkmcnt(0)
    v_cmp_gt_u32 vcc, 5, v16
    s_nop 4
    s_cbranch_vccz L_free_46
    s_waitcnt vmcnt(0)
    v_mov_b32 v15, 11
    ds_write_b32 v38, v15
    s_mov_b32 s96, 1048576
L_spin_47:
    ds_read_b32 v16, v36
    s_waitcnt lgkmcnt(0)
    v_cmp_gt_u32 vcc, 5, v16
    s_sub_u32 s96, s96, 1
    s_cmp_eq_u32 s96, 0
    s_cbranch_scc1 L_spind_48
    s_nop 2
    s_cbranch_vccz L_spind_48
    s_sleep 4
    s_branch L_spin_47
L_spind_48:
L_free_46:
    s_andn2_b32 s3, s80, s81
    s_cbranch_scc1 L_polld_50
    s_waitcnt vmcnt(0)
    v_mov_b32 v15, 11
    ds_write_b32 v38, v15
    s_lshl_b32 s5, s66, 4
    s_and_b32 s4, s65, 8
    s_xor_b32 s4, s4, 8
    s_add_u32 s5, s5, s4
    s_lshl_b32 s5, s5, 2
    s_add_u32 s5, s5, 12976128
    s_mov_b32 s96, 65536
    s_mov_b64 exec, 0xff
L_poll_49:
    buffer_load_dword v16, v39, s[48:51], s5 offen sc1
    s_waitcnt vmcnt(0)
    v_cmp_eq_u32 vcc, s15, v16
    s_sub_u32 s96, s96, 1
    s_cmp_eq_u32 s96, 0
    s_cselect_b32 s3, 0xff, 0
    s_nop 1
    s_or_b32 s80, vcc_lo, s3
    s_andn2_b32 s3, s80, s81
    s_cbranch_scc1 L_polld_50
    s_sleep 10
    s_branch L_poll_49
L_polld_50:
    s_mov_b64 exec, -1
    s_and_b32 s5, s65, 6
    s_lshl_b32 s4, s3, 8
    s_or_b32 s3, s3, s4
    s_lshr_b32 s3, s3, s5
    s_ff1_i32_b32 s3, s3
    s_add_u32 s3, s3, s5
    s_and_b32 s3, s3, 7
    s_bitset1_b32 s81, s3
    s_and_b32 s4, s65, 8
    s_xor_b32 s4, s4, 8
    s_or_b32 s77, s3, s4
    s_mov_b32 s6, 0
    s_lshl_b32 s77, s77, 15
    s_add_u32 s77, s77, s74
    s_add_u32 s77, s77, s6
    s_mov_b32 s76, 65536
    s_mov_b32 m0, s76
    s_add_u32 s76, s76, 4096
    buffer_load_dwordx4 v165, s[48:51], s77 offen offset:0 sc1 lds
    buffer_load_dwordx4 v165, s[48:51], s77 offen offset:1024 sc1 lds
    buffer_load_dwordx4 v165, s[48:51], s77 offen offset:2048 sc1 lds
    buffer_load_dwordx4 v165, s[48:51], s77 offen offset:3072 sc1 lds
    s_add_u32 s77, s77, 4096
    s_mov_b32 m0, s76
    s_add_u32 s76, s76, 4096
    buffer_load_dwordx4 v165, s[48:51], s77 offen offset:0 sc1 lds
    buffer_load_dwordx4 v165, s[48:51], s77 offen offset:1024 sc1 lds
    buffer_load_dwordx4 v165, s[48:51], s77 offen offset:2048 sc1 lds
    buffer_load_dwordx4 v165, s[48:51], s77 offen offset:3072 sc1 lds
    s_add_u32 s77, s77, 4096
    s_mov_b32 m0, s76
    s_add_u32 s76, s76, 4096
    buffer_load_dwordx4 v165, s[48:51], s77 offen offset:0 sc1 lds
    buffer_load_dwordx4 v165, s[48:51], s77 offen offset:1024 sc1 lds
    buffer_load_dwordx4 v165, s[48:51], s77 offen offset:2048 sc1 lds
    buffer_load_dwordx4 v165, s[48:51], s77 offen offset:3072 sc1 lds
    s_add_u32 s77, s77, 4096
    s_mov_b32 m0, s76
    s_add_u32 s76, s76, 4096
    buffer_load_dwordx4 v165, s[48:51], s77 offen offset:0 sc1 lds
    buffer_load_dwordx4 v165, s[48:51], s77 offen offset:1024 sc1 lds
    buffer_load_dwordx4 v165, s[48:51], s77 offen offset:2048 sc1 lds
    buffer_load_dwordx4 v165, s[48:51], s77 offen offset:3072 sc1 lds
    s_add_u32 s77, s77, 4096
    s_waitcnt vmcnt(16)
    v_mov_b32 v15, 11
    ds_write_b32 v38, v15
    ds_read_b32 v16, v36
    s_waitcnt lgkmcnt(0)
    v_cmp_gt_u32 vcc, 6, v16
    s_nop 4
    s_cbranch_vccz L_free_51
    s_waitcnt vmcnt(0)
    v_mov_b32 v15, 12
    ds_write_b32 v38, v15
    s_mov_b32 s96, 1048576
L_spin_52:
    ds_read_b32 v16, v36
    s_waitcnt lgkmcnt(0)
    v_cmp_gt_u32 vcc, 6, v16
    s_sub_u32 s96, s96, 1
    s_cmp_eq_u32 s96, 0
    s_cbranch_scc1 L_spind_53
    s_nop 2
    s_cbranch_vccz L_spind_53
    s_sleep 4
    s_branch L_spin_52
L_spind_53:
L_free_51:
    s_andn2_b32 s3, s80, s81
    s_cbranch_scc1 L_polld_55
    s_waitcnt vmcnt(0)
    v_mov_b32 v15, 12
    ds_write_b32 v38, v15
    s_lshl_b32 s5, s66, 4
    s_and_b32 s4, s65, 8
    s_xor_b32 s4, s4, 8
    s_add_u32 s5, s5, s4
    s_lshl_b32 s5, s5, 2
    s_add_u32 s5, s5, 12976128
    s_mov_b32 s96, 65536
    s_mov_b64 exec, 0xff
L_poll_54:
    buffer_load_dword v16, v39, s[48:51], s5 offen sc1
    s_waitcnt vmcnt(0)
    v_cmp_eq_u32 vcc, s15, v16
    s_sub_u32 s96, s96, 1
    s_cmp_eq_u32 s96, 0
    s_cselect_b32 s3, 0xff, 0
    s_nop 1
    s_or_b32 s80, vcc_lo, s3
    s_andn2_b32 s3, s80, s81
    s_cbranch_scc1 L_polld_55
    s_sleep 10
    s_branch L_poll_54
L_polld_55:
    s_mov_b64 exec, -1
    s_and_b32 s5, s65, 6
    s_lshl_b32 s4, s3, 8
    s_or_b32 s3, s3, s4
    s_lshr_b32 s3, s3, s5
    s_ff1_i32_b32 s3, s3
    s_add_u32 s3, s3, s5
    s_and_b32 s3, s3, 7
    s_bitset1_b32 s81, s3
    s_and_b32 s4, s65, 8
    s_xor_b32 s4, s4, 8
    s_or_b32 s77, s3, s4
    s_mov_b32 s6, 0
    s_lshl_b32 s77, s77, 15
    s_add_u32 s77, s77, s74
    s_add_u32 s77, s77, s6
    s_mov_b32 s76, 81920
    s_mov_b32 m0, s76
    s_add_u32 s76, s76, 4096
    buffer_load_dwordx4 v165, s[48:51], s77 offen offset:0 sc1 lds
    buffer_load_dwordx4 v165, s[48:51], s77 offen offset:1024 sc1 lds
    buffer_load_dwordx4 v165, s[48:51], s77 offen offset:2048 sc1 lds
    buffer_load_dwordx4 v165, s[48:51], s77 offen offset:3072 sc1 lds
    s_add_u32 s77, s77, 4096
    s_mov_b32 m0, s76
    s_add_u32 s76, s76, 4096
    buffer_load_dwordx4 v165, s[48:51], s77 offen offset:0 sc1 lds
    buffer_load_dwordx4 v165, s[48:51], s77 offen offset:1024 sc1 lds
    buffer_load_dwordx4 v165, s[48:51], s77 offen offset:2048 sc1 lds
    buffer_load_dwordx4 v165, s[48:51], s77 offen offset:3072 sc1 lds
    s_add_u32 s77, s77, 4096
    s_mov_b32 m0, s76
    s_add_u32 s76, s76, 4096
    buffer_load_dwordx4 v165, s[48:51], s77 offen offset:0 sc1 lds
    buffer_load_dwordx4 v165, s[48:51], s77 offen offset:1024 sc1 lds
    buffer_load_dwordx4 v165, s[48:51], s77 offen offset:2048 sc1 lds
    buffer_load_dwordx4 v165, s[48:51], s77 offen offset:3072 sc1 lds
    s_add_u32 s77, s77, 4096
    s_mov_b32 m0, s76
    s_add_u32 s76, s76, 4096
    buffer_load_dwordx4 v165, s[48:51], s77 offen offset:0 sc1 lds
    buffer_load_dwordx4 v165, s[48:51], s77 offen offset:1024 sc1 lds
    buffer_load_dwordx4 v165, s[48:51], s77 offen offset:2048 sc1 lds
    buffer_load_dwordx4 v165, s[48:51], s77 offen offset:3072 sc1 lds
    s_add_u32 s77, s77, 4096
    s_waitcnt vmcnt(16)
    v_mov_b32 v15, 12
    ds_write_b32 v38, v15
    ds_read_b32 v16, v36
    s_waitcnt lgkmcnt(0)
    v_cmp_gt_u32 vcc, 7, v16
    s_nop 4
    s_cbranch_vccz L_free_56
    s_waitcnt vmcnt(0)
    v_mov_b32 v15, 13
    ds_write_b32 v38, v15
    s_mov_b32 s96, 1048576
L_spin_57:
    ds_read_b32 v16, v36
    s_waitcnt lgkmcnt(0)
    v_cmp_gt_u32 vcc, 7, v16
    s_sub_u32 s96, s96, 1
    s_cmp_eq_u32 s96, 0
    s_cbranch_scc1 L_spind_58
    s_nop 2
    s_cbranch_vccz L_spind_58
    s_sleep 4
    s_branch L_spin_57
L_spind_58:
L_free_56:
    s_andn2_b32 s3, s80, s81
    s_cbranch_scc1 L_polld_60
    s_waitcnt vmcnt(0)
    v_mov_b32 v15, 13
    ds_write_b32 v38, v15
    s_lshl_b32 s5, s66, 4
    s_and_b32 s4, s65, 8
    s_xor_b32 s4, s4, 8
    s_add_u32 s5, s5, s4
    s_lshl_b32 s5, s5, 2
    s_add_u32 s5, s5, 12976128
    s_mov_b32 s96, 65536
    s_mov_b64 exec, 0xff
L_poll_59:
    buffer_load_dword v16, v39, s[48:51], s5 offen sc1
    s_waitcnt vmcnt(0)
    v_cmp_eq_u32 vcc, s15, v16
    s_sub_u32 s96, s96, 1
    s_cmp_eq_u32 s96, 0
    s_cselect_b32 s3, 0xff, 0
    s_nop 1
    s_or_b32 s80, vcc_lo, s3
    s_andn2_b32 s3, s80, s81
    s_cbranch_scc1 L_polld_60
    s_sleep 10
    s_branch L_poll_59
L_polld_60:
    s_mov_b64 exec, -1
    s_and_b32 s5, s65, 6
    s_lshl_b32 s4, s3, 8
    s_or_b32 s3, s3, s4
    s_lshr_b32 s3, s3, s5
    s_ff1_i32_b32 s3, s3
    s_add_u32 s3, s3, s5
    s_and_b32 s3, s3, 7
    s_bitset1_b32 s81, s3
    s_and_b32 s4, s65, 8
    s_xor_b32 s4, s4, 8
    s_or_b32 s77, s3, s4
    s_mov_b32 s6, 0
    s_lshl_b32 s77, s77, 15
    s_add_u32 s77, s77, s74
    s_add_u32 s77, s77, s6
    s_mov_b32 s76, 98304
    s_mov_b32 m0, s76
    s_add_u32 s76, s76, 4096
    buffer_load_dwordx4 v165, s[48:51], s77 offen offset:0 sc1 lds
    buffer_load_dwordx4 v165, s[48:51], s77 offen offset:1024 sc1 lds
    buffer_load_dwordx4 v165, s[48:51], s77 offen offset:2048 sc1 lds
    buffer_load_dwordx4 v165, s[48:51], s77 offen offset:3072 sc1 lds
    s_add_u32 s77, s77, 4096
    s_mov_b32 m0, s76
    s_add_u32 s76, s76, 4096
    buffer_load_dwordx4 v165, s[48:51], s77 offen offset:0 sc1 lds
    buffer_load_dwordx4 v165, s[48:51], s77 offen offset:1024 sc1 lds
    buffer_load_dwordx4 v165, s[48:51], s77 offen offset:2048 sc1 lds
    buffer_load_dwordx4 v165, s[48:51], s77 offen offset:3072 sc1 lds
    s_add_u32 s77, s77, 4096
    s_mov_b32 m0, s76
    s_add_u32 s76, s76, 4096
    buffer_load_dwordx4 v165, s[48:51], s77 offen offset:0 sc1 lds
    buffer_load_dwordx4 v165, s[48:51], s77 offen offset:1024 sc1 lds
    buffer_load_dwordx4 v165, s[48:51], s77 offen offset:2048 sc1 lds
    buffer_load_dwordx4 v165, s[48:51], s77 offen offset:3072 sc1 lds
    s_add_u32 s77, s77, 4096
    s_mov_b32 m0, s76
    s_add_u32 s76, s76, 4096
    buffer_load_dwordx4 v165, s[48:51], s77 offen offset:0 sc1 lds
    buffer_load_dwordx4 v165, s[48:51], s77 offen offset:1024 sc1 lds
    buffer_load_dwordx4 v165, s[48:51], s77 offen offset:2048 sc1 lds
    buffer_load_dwordx4 v165, s[48:51], s77 offen offset:3072 sc1 lds
    s_add_u32 s77, s77, 4096
    s_waitcnt vmcnt(16)
    v_mov_b32 v15, 13
    ds_write_b32 v38, v15
    ds_read_b32 v16, v36
    s_waitcnt lgkmcnt(0)
    v_cmp_gt_u32 vcc, 8, v16
    s_nop 4
    s_cbranch_vccz L_free_61
    s_waitcnt vmcnt(0)
    v_mov_b32 v15, 14
    ds_write_b32 v38, v15
    s_mov_b32 s96, 1048576
L_spin_62:
    ds_read_b32 v16, v36
    s_waitcnt lgkmcnt(0)
    v_cmp_gt_u32 vcc, 8, v16
    s_sub_u32 s96, s96, 1
    s_cmp_eq_u32 s96, 0
    s_cbranch_scc1 L_spind_63
    s_nop 2
    s_cbranch_vccz L_spind_63
    s_sleep 4
    s_branch L_spin_62
L_spind_63:
L_free_61:
    s_andn2_b32 s3, s80, s81
    s_cbranch_scc1 L_polld_65
    s_waitcnt vmcnt(0)
    v_mov_b32 v15, 14
    ds_write_b32 v38, v15
    s_lshl_b32 s5, s66, 4
    s_and_b32 s4, s65, 8
    s_xor_b32 s4, s4, 8
    s_add_u32 s5, s5, s4
    s_lshl_b32 s5, s5, 2
    s_add_u32 s5, s5, 12976128
    s_mov_b32 s96, 65536
    s_mov_b64 exec, 0xff
L_poll_64:
    buffer_load_dword v16, v39, s[48:51], s5 offen sc1
    s_waitcnt vmcnt(0)
    v_cmp_eq_u32 vcc, s15, v16
    s_sub_u32 s96, s96, 1
    s_cmp_eq_u32 s96, 0
    s_cselect_b32 s3, 0xff, 0
    s_nop 1
    s_or_b32 s80, vcc_lo, s3
    s_andn2_b32 s3, s80, s81
    s_cbranch_scc1 L_polld_65
    s_sleep 10
    s_branch L_poll_64
L_polld_65:
    s_mov_b64 exec, -1
    s_and_b32 s5, s65, 6
    s_lshl_b32 s4, s3, 8
    s_or_b32 s3, s3, s4
    s_lshr_b32 s3, s3, s5
    s_ff1_i32_b32 s3, s3
    s_add_u32 s3, s3, s5
    s_and_b32 s3, s3, 7
    s_bitset1_b32 s81, s3
    s_and_b32 s4, s65, 8
    s_xor_b32 s4, s4, 8
    s_or_b32 s77, s3, s4
    s_mov_b32 s6, 0
    s_lshl_b32 s77, s77, 15
    s_add_u32 s77, s77, s74
    s_add_u32 s77, s77, s6
    s_mov_b32 s76, 114688
    s_mov_b32 m0, s76
    s_add_u32 s76, s76, 4096
    buffer_load_dwordx4 v165, s[48:51], s77 offen offset:0 sc1 lds
    buffer_load_dwordx4 v165, s[48:51], s77 offen offset:1024 sc1 lds
    buffer_load_dwordx4 v165, s[48:51], s77 offen offset:2048 sc1 lds
    buffer_load_dwordx4 v165, s[48:51], s77 offen offset:3072 sc1 lds
    s_add_u32 s77, s77, 4096
    s_mov_b32 m0, s76
    s_add_u32 s76, s76, 4096
    buffer_load_dwordx4 v165, s[48:51], s77 offen offset:0 sc1 lds
    buffer_load_dwordx4 v165, s[48:51], s77 offen offset:1024 sc1 lds
    buffer_load_dwordx4 v165, s[48:51], s77 offen offset:2048 sc1 lds
    buffer_load_dwordx4 v165, s[48:51], s77 offen offset:3072 sc1 lds
    s_add_u32 s77, s77, 4096
    s_mov_b32 m0, s76
    s_add_u32 s76, s76, 4096
    buffer_load_dwordx4 v165, s[48:51], s77 offen offset:0 sc1 lds
    buffer_load_dwordx4 v165, s[48:51], s77 offen offset:1024 sc1 lds
    buffer_load_dwordx4 v165, s[48:51], s77 offen offset:2048 sc1 lds
    buffer_load_dwordx4 v165, s[48:51], s77 offen offset:3072 sc1 lds
    s_add_u32 s77, s77, 4096
    s_mov_b32 m0, s76
    s_add_u32 s76, s76, 4096
    buffer_load_dwordx4 v165, s[48:51], s77 offen offset:0 sc1 lds
    buffer_load_dwordx4 v165, s[48:51], s77 offen offset:1024 sc1 lds
    buffer_load_dwordx4 v165, s[48:51], s77 offen offset:2048 sc1 lds
    buffer_load_dwordx4 v165, s[48:51], s77 offen offset:3072 sc1 lds
    s_add_u32 s77, s77, 4096
    s_waitcnt vmcnt(16)
    v_mov_b32 v15, 14
    ds_write_b32 v38, v15
    s_mov_b32 s56, s20
    s_and_b32 s57, s21, 0xffff
    s_mov_b32 s58, 2097152
    s_mov_b32 s59, 0x20000
    v_lshrrev_b32 v19, 3, v166
    v_lshl_add_u32 v19, v19, 11, v13
    s_waitcnt vmcnt(0)
    v_mov_b32 v15, 16
    ds_write_b32 v38, v15
    s_mov_b32 s96, 1048576
L_spin_66:
    ds_read_b32 v16, v36
    s_waitcnt lgkmcnt(0)
    v_cmp_gt_u32 vcc, 10, v16
    s_sub_u32 s96, s96, 1
    s_cmp_eq_u32 s96, 0
    s_cbranch_scc1 L_spind_67
    s_nop 2
    s_cbranch_vccz L_spind_67
    s_sleep 4
    s_branch L_spin_66
L_spind_67:
    s_lshr_b32 s3, s2, 3
    s_and_b32 s3, s3, 15
    s_lshl_b32 s3, s3, 7
    s_add_u32 s77, s3, 0
    s_mov_b32 m0, 0
    s_nop 0
    buffer_load_dwordx4 v19, s[56:59], s77 offen lds
    s_mov_b32 m0, 1024
    s_add_u32 s77, s77, 16384
    buffer_load_dwordx4 v19, s[56:59], s77 offen lds
    s_mov_b32 m0, 2048
    s_add_u32 s77, s77, 16384
    buffer_load_dwordx4 v19, s[56:59], s77 offen lds
    s_mov_b32 m0, 3072
    s_add_u32 s77, s77, 16384
    buffer_load_dwordx4 v19, s[56:59], s77 offen lds
    s_mov_b32 m0, 4096
    s_add_u32 s77, s77, 16384
    buffer_load_dwordx4 v19, s[56:59], s77 offen lds
    s_mov_b32 m0, 5120
    s_add_u32 s77, s77, 16384
    buffer_load_dwordx4 v19, s[56:59], s77 offen lds
    s_mov_b32 m0, 6144
    s_add_u32 s77, s77, 16384
    buffer_load_dwordx4 v19, s[56:59], s77 offen lds
    s_mov_b32 m0, 7168
    s_add_u32 s77, s77, 16384
    buffer_load_dwordx4 v19, s[56:59], s77 offen lds
    s_mov_b32 m0, 8192
    s_add_u32 s77, s77, 16384
    buffer_load_dwordx4 v19, s[56:59], s77 offen lds
    s_mov_b32 m0, 9216
    s_add_u32 s77, s77, 16384
    buffer_load_dwordx4 v19, s[56:59], s77 offen lds
    s_mov_b32 m0, 10240
    s_add_u32 s77, s77, 16384
    buffer_load_dwordx4 v19, s[56:59], s77 offen lds
    s_mov_b32 m0, 11264
    s_add_u32 s77, s77, 16384
    buffer_load_dwordx4 v19, s[56:59], s77 offen lds
    s_mov_b32 m0, 12288
    s_add_u32 s77, s77, 16384
    buffer_load_dwordx4 v19, s[56:59], s77 offen lds
    s_mov_b32 m0, 13312
    s_add_u32 s77, s77, 16384
    buffer_load_dwordx4 v19, s[56:59], s77 offen lds
    s_mov_b32 m0, 14336
    s_add_u32 s77, s77, 16384
    buffer_load_dwordx4 v19, s[56:59], s77 offen lds
    s_mov_b32 m0, 15360
    s_add_u32 s77, s77, 16384
    buffer_load_dwordx4 v19, s[56:59], s77 offen lds
    s_mov_b32 m0, 16384
    s_add_u32 s77, s77, 16384
    buffer_load_dwordx4 v19, s[56:59], s77 offen lds
    s_mov_b32 m0, 17408
    s_add_u32 s77, s77, 16384
    buffer_load_dwordx4 v19, s[56:59], s77 offen lds
    s_mov_b32 m0, 18432
    s_add_u32 s77, s77, 16384
    buffer_load_dwordx4 v19, s[56:59], s77 offen lds
    s_mov_b32 m0, 19456
    s_add_u32 s77, s77, 16384
    buffer_load_dwordx4 v19, s[56:59], s77 offen lds
    s_mov_b32 m0, 20480
    s_add_u32 s77, s77, 16384
    buffer_load_dwordx4 v19, s[56:59], s77 offen lds
    s_mov_b32 m0, 21504
    s_add_u32 s77, s77, 16384
    buffer_load_dwordx4 v19, s[56:59], s77 offen lds
    s_mov_b32 m0, 22528
    s_add_u32 s77, s77, 16384
    buffer_load_dwordx4 v19, s[56:59], s77 offen lds
    s_mov_b32 m0, 23552
    s_add_u32 s77, s77, 16384
    buffer_load_dwordx4 v19, s[56:59], s77 offen lds
    s_mov_b32 m0, 24576
    s_add_u32 s77, s77, 16384
    buffer_load_dwordx4 v19, s[56:59], s77 offen lds
    s_mov_b32 m0, 25600
    s_add_u32 s77, s77, 16384
    buffer_load_dwordx4 v19, s[56:59], s77 offen lds
    s_mov_b32 m0, 26624
    s_add_u32 s77, s77, 16384
    buffer_load_dwordx4 v19, s[56:59], s77 offen lds
    s_mov_b32 m0, 27648
    s_add_u32 s77, s77, 16384
    buffer_load_dwordx4 v19, s[56:59], s77 offen lds
    s_mov_b32 m0, 28672
    s_add_u32 s77, s77, 16384
    buffer_load_dwordx4 v19, s[56:59], s77 offen lds
    s_mov_b32 m0, 29696
    s_add_u32 s77, s77, 16384
    buffer_load_dwordx4 v19, s[56:59], s77 offen lds
    s_mov_b32 m0, 30720
    s_add_u32 s77, s77, 16384
    buffer_load_dwordx4 v19, s[56:59], s77 offen lds
    s_mov_b32 m0, 31744
    s_add_u32 s77, s77, 16384
    buffer_load_dwordx4 v19, s[56:59], s77 offen lds
    s_waitcnt vmcnt(0)
    v_mov_b32 v14, 155716
    v_mov_b32 v15, 0xf
    s_mov_b64 exec, 1
    ds_or_b32 v14, v15
    s_mov_b64 exec, -1
    s_mov_b32 s96, 1048576
L_spin_68:
    ds_read_b32 v16, v36
    s_waitcnt lgkmcnt(0)
    v_cmp_gt_u32 vcc, 12, v16
    s_sub_u32 s96, s96, 1
    s_cmp_eq_u32 s96, 0
    s_cbranch_scc1 L_spind_69
    s_nop 2
    s_cbranch_vccz L_spind_69
    s_sleep 4
    s_branch L_spin_68
L_spind_69:
    s_lshr_b32 s3, s2, 3
    s_and_b32 s3, s3, 15
    s_lshl_b32 s3, s3, 7
    s_add_u32 s77, s3, 524288
    s_mov_b32 m0, 32768
    s_nop 0
    buffer_load_dwordx4 v19, s[56:59], s77 offen lds
    s_mov_b32 m0, 33792
    s_add_u32 s77, s77, 16384
    buffer_load_dwordx4 v19, s[56:59], s77 offen lds
    s_mov_b32 m0, 34816
    s_add_u32 s77, s77, 16384
    buffer_load_dwordx4 v19, s[56:59], s77 offen lds
    s_mov_b32 m0, 35840
    s_add_u32 s77, s77, 16384
    buffer_load_dwordx4 v19, s[56:59], s77 offen lds
    s_mov_b32 m0, 36864
    s_add_u32 s77, s77, 16384
    buffer_load_dwordx4 v19, s[56:59], s77 offen lds
    s_mov_b32 m0, 37888
    s_add_u32 s77, s77, 16384
    buffer_load_dwordx4 v19, s[56:59], s77 offen lds
    s_mov_b32 m0, 38912
    s_add_u32 s77, s77, 16384
    buffer_load_dwordx4 v19, s[56:59], s77 offen lds
    s_mov_b32 m0, 39936
    s_add_u32 s77, s77, 16384
    buffer_load_dwordx4 v19, s[56:59], s77 offen lds
    s_mov_b32 m0, 40960
    s_add_u32 s77, s77, 16384
    buffer_load_dwordx4 v19, s[56:59], s77 offen lds
    s_mov_b32 m0, 41984
    s_add_u32 s77, s77, 16384
    buffer_load_dwordx4 v19, s[56:59], s77 offen lds
    s_mov_b32 m0, 43008
    s_add_u32 s77, s77, 16384
    buffer_load_dwordx4 v19, s[56:59], s77 offen lds
    s_mov_b32 m0, 44032
    s_add_u32 s77, s77, 16384
    buffer_load_dwordx4 v19, s[56:59], s77 offen lds
    s_mov_b32 m0, 45056
    s_add_u32 s77, s77, 16384
    buffer_load_dwordx4 v19, s[56:59], s77 offen lds
    s_mov_b32 m0, 46080
    s_add_u32 s77, s77, 16384
    buffer_load_dwordx4 v19, s[56:59], s77 offen lds
    s_mov_b32 m0, 47104
    s_add_u32 s77, s77, 16384
    buffer_load_dwordx4 v19, s[56:59], s77 offen lds
    s_mov_b32 m0, 48128
    s_add_u32 s77, s77, 16384
    buffer_load_dwordx4 v19, s[56:59], s77 offen lds
    s_mov_b32 m0, 49152
    s_add_u32 s77, s77, 16384
    buffer_load_dwordx4 v19, s[56:59], s77 offen lds
    s_mov_b32 m0, 50176
    s_add_u32 s77, s77, 16384
    buffer_load_dwordx4 v19, s[56:59], s77 offen lds
    s_mov_b32 m0, 51200
    s_add_u32 s77, s77, 16384
    buffer_load_dwordx4 v19, s[56:59], s77 offen lds
    s_mov_b32 m0, 52224
    s_add_u32 s77, s77, 16384
    buffer_load_dwordx4 v19, s[56:59], s77 offen lds
    s_mov_b32 m0, 53248
    s_add_u32 s77, s77, 16384
    buffer_load_dwordx4 v19, s[56:59], s77 offen lds
    s_mov_b32 m0, 54272
    s_add_u32 s77, s77, 16384
    buffer_load_dwordx4 v19, s[56:59], s77 offen lds
    s_mov_b32 m0, 55296
    s_add_u32 s77, s77, 16384
    buffer_load_dwordx4 v19, s[56:59], s77 offen lds
    s_mov_b32 m0, 56320
    s_add_u32 s77, s77, 16384
    buffer_load_dwordx4 v19, s[56:59], s77 offen lds
    s_mov_b32 m0, 57344
    s_add_u32 s77, s77, 16384
    buffer_load_dwordx4 v19, s[56:59], s77 offen lds
    s_mov_b32 m0, 58368
    s_add_u32 s77, s77, 16384
    buffer_load_dwordx4 v19, s[56:59], s77 offen lds
    s_mov_b32 m0, 59392
    s_add_u32 s77, s77, 16384
    buffer_load_dwordx4 v19, s[56:59], s77 offen lds
    s_mov_b32 m0, 60416
    s_add_u32 s77, s77, 16384
    buffer_load_dwordx4 v19, s[56:59], s77 offen lds
    s_mov_b32 m0, 61440
    s_add_u32 s77, s77, 16384
    buffer_load_dwordx4 v19, s[56:59], s77 offen lds
    s_mov_b32 m0, 62464
    s_add_u32 s77, s77, 16384
    buffer_load_dwordx4 v19, s[56:59], s77 offen lds
    s_mov_b32 m0, 63488
    s_add_u32 s77, s77, 16384
    buffer_load_dwordx4 v19, s[56:59], s77 offen lds
    s_mov_b32 m0, 64512
    s_add_u32 s77, s77, 16384
    buffer_load_dwordx4 v19, s[56:59], s77 offen lds
    s_waitcnt vmcnt(0)
    v_mov_b32 v14, 155716
    v_mov_b32 v15, 0xf0
    s_mov_b64 exec, 1
    ds_or_b32 v14, v15
    s_mov_b64 exec, -1
    s_mov_b32 s96, 1048576
L_spin_70:
    ds_read_b32 v16, v36
    s_waitcnt lgkmcnt(0)
    v_cmp_gt_u32 vcc, 14, v16
    s_sub_u32 s96, s96, 1
    s_cmp_eq_u32 s96, 0
    s_cbranch_scc1 L_spind_71
    s_nop 2
    s_cbranch_vccz L_spind_71
    s_sleep 4
    s_branch L_spin_70
L_spind_71:
    s_lshr_b32 s3, s2, 3
    s_and_b32 s3, s3, 15
    s_lshl_b32 s3, s3, 7
    s_add_u32 s77, s3, 1048576
    s_mov_b32 m0, 65536
    s_nop 0
    buffer_load_dwordx4 v19, s[56:59], s77 offen lds
    s_mov_b32 m0, 66560
    s_add_u32 s77, s77, 16384
    buffer_load_dwordx4 v19, s[56:59], s77 offen lds
    s_mov_b32 m0, 67584
    s_add_u32 s77, s77, 16384
    buffer_load_dwordx4 v19, s[56:59], s77 offen lds
    s_mov_b32 m0, 68608
    s_add_u32 s77, s77, 16384
    buffer_load_dwordx4 v19, s[56:59], s77 offen lds
    s_mov_b32 m0, 69632
    s_add_u32 s77, s77, 16384
    buffer_load_dwordx4 v19, s[56:59], s77 offen lds
    s_mov_b32 m0, 70656
    s_add_u32 s77, s77, 16384
    buffer_load_dwordx4 v19, s[56:59], s77 offen lds
    s_mov_b32 m0, 71680
    s_add_u32 s77, s77, 16384
    buffer_load_dwordx4 v19, s[56:59], s77 offen lds
    s_mov_b32 m0, 72704
    s_add_u32 s77, s77, 16384
    buffer_load_dwordx4 v19, s[56:59], s77 offen lds
    s_mov_b32 m0, 73728
    s_add_u32 s77, s77, 16384
    buffer_load_dwordx4 v19, s[56:59], s77 offen lds
    s_mov_b32 m0, 74752
    s_add_u32 s77, s77, 16384
    buffer_load_dwordx4 v19, s[56:59], s77 offen lds
    s_mov_b32 m0, 75776
    s_add_u32 s77, s77, 16384
    buffer_load_dwordx4 v19, s[56:59], s77 offen lds
    s_mov_b32 m0, 76800
    s_add_u32 s77, s77, 16384
    buffer_load_dwordx4 v19, s[56:59], s77 offen lds
    s_mov_b32 m0, 77824
    s_add_u32 s77, s77, 16384
    buffer_load_dwordx4 v19, s[56:59], s77 offen lds
    s_mov_b32 m0, 78848
    s_add_u32 s77, s77, 16384
    buffer_load_dwordx4 v19, s[56:59], s77 offen lds
    s_mov_b32 m0, 79872
    s_add_u32 s77, s77, 16384
    buffer_load_dwordx4 v19, s[56:59], s77 offen lds
    s_mov_b32 m0, 80896
    s_add_u32 s77, s77, 16384
    buffer_load_dwordx4 v19, s[56:59], s77 offen lds
    s_mov_b32 m0, 81920
    s_add_u32 s77, s77, 16384
    buffer_load_dwordx4 v19, s[56:59], s77 offen lds
    s_mov_b32 m0, 82944
    s_add_u32 s77, s77, 16384
    buffer_load_dwordx4 v19, s[56:59], s77 offen lds
    s_mov_b32 m0, 83968
    s_add_u32 s77, s77, 16384
    buffer_load_dwordx4 v19, s[56:59], s77 offen lds
    s_mov_b32 m0, 84992
    s_add_u32 s77, s77, 16384
    buffer_load_dwordx4 v19, s[56:59], s77 offen lds
    s_mov_b32 m0, 86016
    s_add_u32 s77, s77, 16384
    buffer_load_dwordx4 v19, s[56:59], s77 offen lds
    s_mov_b32 m0, 87040
    s_add_u32 s77, s77, 16384
    buffer_load_dwordx4 v19, s[56:59], s77 offen lds
    s_mov_b32 m0, 88064
    s_add_u32 s77, s77, 16384
    buffer_load_dwordx4 v19, s[56:59], s77 offen lds
    s_mov_b32 m0, 89088
    s_add_u32 s77, s77, 16384
    buffer_load_dwordx4 v19, s[56:59], s77 offen lds
    s_mov_b32 m0, 90112
    s_add_u32 s77, s77, 16384
    buffer_load_dwordx4 v19, s[56:59], s77 offen lds
    s_mov_b32 m0, 91136
    s_add_u32 s77, s77, 16384
    buffer_load_dwordx4 v19, s[56:59], s77 offen lds
    s_mov_b32 m0, 92160
    s_add_u32 s77, s77, 16384
    buffer_load_dwordx4 v19, s[56:59], s77 offen lds
    s_mov_b32 m0, 93184
    s_add_u32 s77, s77, 16384
    buffer_load_dwordx4 v19, s[56:59], s77 offen lds
    s_mov_b32 m0, 94208
    s_add_u32 s77, s77, 16384
    buffer_load_dwordx4 v19, s[56:59], s77 offen lds
    s_mov_b32 m0, 95232
    s_add_u32 s77, s77, 16384
    buffer_load_dwordx4 v19, s[56:59], s77 offen lds
    s_mov_b32 m0, 96256
    s_add_u32 s77, s77, 16384
    buffer_load_dwordx4 v19, s[56:59], s77 offen lds
    s_mov_b32 m0, 97280
    s_add_u32 s77, s77, 16384
    buffer_load_dwordx4 v19, s[56:59], s77 offen lds
    s_waitcnt vmcnt(0)
    v_mov_b32 v14, 155716
    v_mov_b32 v15, 0xf00
    s_mov_b64 exec, 1
    ds_or_b32 v14, v15
    s_mov_b64 exec, -1
    s_and_b32 s3, s2, 7
    s_lshl_b32 s3, s3, 1
    s_lshr_b32 s4, s2, 7
    s_add_u32 s3, s3, s4
    s_lshl_b32 s5, s3, 7
    s_add_u32 s5, s5, 12978176
    v_mov_b32 v15, 155712
    s_mov_b32 s96, 1048576
L_spin_72:
    ds_read_b32 v16, v36
    s_waitcnt lgkmcnt(0)
    v_cmp_gt_u32 vcc, 14, v16
    s_sub_u32 s96, s96, 1
    s_cmp_eq_u32 s96, 0
    s_cbranch_scc1 L_spind_73
    s_nop 2
    s_cbranch_vccz L_spind_73
    s_sleep 2
    s_branch L_spin_72
L_spind_73:
    v_lshlrev_b32 v14, 3, v166
    s_and_b32 s3, s2, 7
    s_lshl_b32 s3, s3, 1
    s_lshr_b32 s4, s2, 7
    s_add_u32 s3, s3, s4
    s_lshl_b32 s3, s3, 18
    s_lshr_b32 s4, s2, 3
    s_and_b32 s4, s4, 15
    s_lshr_b32 s8, s4, 2
    s_lshl_b32 s8, s8, 16
    s_add_u32 s3, s3, s8
    s_and_b32 s4, s4, 3
    s_lshl_b32 s4, s4, 10
    s_add_u32 s3, s3, s4
    s_add_u32 s8, s3, 8388608
    s_add_u32 s9, s8, 32768
    v_lshrrev_b32 v40, 3, v166
    v_and_b32 v41, 7, v166
    v_lshlrev_b32 v41, 7, v41
    v_lshl_add_u32 v41, v40, 12, v41
    s_mov_b32 s10, 0
    v_mov_b32 v44, 0x7f000000
    s_mov_b32 s96, 65536
L_poll_74:
    s_mov_b64 exec, 0xffff
    buffer_load_dwordx2 v[16:17], v14, s[48:51], s5 offen sc1
    s_waitcnt vmcnt(0)
    v_cmp_eq_u32 vcc, s15, v16
    v_cmp_eq_u32 s[6:7], s15, v17
    s_sub_u32 s96, s96, 1
    s_cmp_eq_u32 s96, 0
    s_cselect_b32 s3, 0xffff, 0
    s_nop 1
    s_and_b32 s4, vcc_lo, s6
    s_or_b32 s3, s4, s3
    v_mov_b32 v16, s3
    ds_write_b32 v15, v16
    s_mov_b64 exec, -1
    s_andn2_b32 s11, s3, s10
    s_cbranch_scc0 L_not_76
    ds_read_b32 v42, v37
    s_waitcnt lgkmcnt(0)
    v_readfirstlane_b32 s4, v42
    s_nop 1
    s_cmp_ge_u32 s4, 16
    s_cbranch_scc1 L_not_76
    s_mov_b32 s10, s3
    v_lshrrev_b32 v42, v40, s11
    v_and_b32 v42, 1, v42
    v_cmp_eq_u32 vcc, 1, v42
    s_nop 1
    v_cndmask_b32 v43, v44, v41, vcc
    buffer_load_dword v42, v43, s[48:51], s8 offen sc1
    s_lshr_b32 s11, s11, 8
    v_lshrrev_b32 v42, v40, s11
    v_and_b32 v42, 1, v42
    v_cmp_eq_u32 vcc, 1, v42
    s_nop 1
    v_cndmask_b32 v43, v44, v41, vcc
    buffer_load_dword v42, v43, s[48:51], s9 offen sc1
L_not_76:
    s_cmp_eq_u32 s3, 0xffff
    s_cbranch_scc1 L_polld_75
    s_sleep 4
    s_branch L_poll_74
L_polld_75:
    s_waitcnt lgkmcnt(0)
    s_mov_b64 exec, -1
    s_endpgm
L_h2_1:
    s_bitcmp1_b32 s65, 0
    s_cselect_b32 s3, 114688, 0
    s_cselect_b32 s4, 0, 114688
    v_add_u32 v20, s3, v165
    v_add_u32 v21, s4, v165
    ds_read_b128 v[32:35], v20 offset:0
    ds_read_b128 v[36:39], v20 offset:1024
    ds_read_b128 v[40:43], v20 offset:2048
    ds_read_b128 v[44:47], v20 offset:3072
    ds_read_b128 v[48:51], v20 offset:4096
    ds_read_b128 v[52:55], v20 offset:5120
    ds_read_b128 v[56:59], v20 offset:6144
    ds_read_b128 v[60:63], v20 offset:7168
    ds_read_b128 v[64:67], v20 offset:8192
    ds_read_b128 v[68:71], v20 offset:9216
    ds_read_b128 v[72:75], v20 offset:10240
    ds_read_b128 v[76:79], v20 offset:11264
    s_waitcnt lgkmcnt(4)
    ds_read_b128 v[80:83], v20 offset:12288
    ds_read_b128 v[84:87], v20 offset:13312
    ds_read_b128 v[88:91], v20 offset:14336
    ds_read_b128 v[92:95], v20 offset:15360
    ds_read_b128 v[96:99], v21 offset:0
    ds_read_b128 v[100:103], v21 offset:1024
    ds_read_b128 v[104:107], v21 offset:2048
    ds_read_b128 v[108:111], v21 offset:3072
    ds_read_b128 v[112:115], v21 offset:4096
    ds_read_b128 v[116:119], v21 offset:5120
    ds_read_b128 v[120:123], v21 offset:6144
    ds_read_b128 v[124:127], v21 offset:7168
    s_waitcnt lgkmcnt(4)
    ds_read_b128 v[128:131], v21 offset:8192
    ds_read_b128 v[132:135], v21 offset:9216
    ds_read_b128 v[136:139], v21 offset:10240
    ds_read_b128 v[140:143], v21 offset:11264
    ds_read_b128 v[144:147], v21 offset:12288
    ds_read_b128 v[148:151], v21 offset:13312
    ds_read_b128 v[152:155], v21 offset:14336
    ds_read_b128 v[156:159], v21 offset:15360
    s_lshl_b32 s83, s65, 15
    s_add_u32 s83, s83, s74
    v_mov_b32 v14, 155664
    v_mov_b32 v15, 1
    s_waitcnt lgkmcnt(0)
    ds_write_b32 v14, v15
    v_mov_b32 v14, 155680
    s_mov_b32 s96, 20
L_spin_77:
    ds_read_b32 v16, v14
    s_waitcnt lgkmcnt(0)
    v_cmp_gt_u32 vcc, 2, v16
    s_sub_u32 s96, s96, 1
    s_cmp_eq_u32 s96, 0
    s_cbranch_scc1 L_spind_78
    s_nop 2
    s_cbranch_vccz L_spind_78
    s_sleep 4
    s_branch L_spin_77
L_spind_78:
    s_bfe_u32 s5, s65, 0x20001
    s_lshl_b32 s5, s5, 2
    s_lshr_b32 s5, 0x0, s5
    s_and_b32 s5, s5, 15
    s_mul_i32 s6, s5, 8
    s_add_u32 s6, s6, 6
    v_mov_b32 v14, 155904
    s_mov_b32 s96, s6
L_spin_79:
    ds_read_b32 v16, v14
    s_waitcnt lgkmcnt(0)
    v_cmp_gt_u32 vcc, s5, v16
    s_sub_u32 s96, s96, 1
    s_cmp_eq_u32 s96, 0
    s_cbranch_scc1 L_spind_80
    s_nop 2
    s_cbranch_vccz L_spind_80
    s_sleep 4
    s_branch L_spin_79
L_spind_80:
    buffer_store_dwordx4 v[32:35], v165, s[48:51], s83 offen offset:0 sc1
    buffer_store_dwordx4 v[36:39], v165, s[48:51], s83 offen offset:1024 sc1
    buffer_store_dwordx4 v[40:43], v165, s[48:51], s83 offen offset:2048 sc1
    buffer_store_dwordx4 v[44:47], v165, s[48:51], s83 offen offset:3072 sc1
    s_add_u32 s83, s83, 4096
    buffer_store_dwordx4 v[48:51], v165, s[48:51], s83 offen offset:0 sc1
    buffer_store_dwordx4 v[52:55], v165, s[48:51], s83 offen offset:1024 sc1
    buffer_store_dwordx4 v[56:59], v165, s[48:51], s83 offen offset:2048 sc1
    buffer_store_dwordx4 v[60:63], v165, s[48:51], s83 offen offset:3072 sc1
    s_add_u32 s83, s83, 4096
    buffer_store_dwordx4 v[64:67], v165, s[48:51], s83 offen offset:0 sc1
    buffer_store_dwordx4 v[68:71], v165, s[48:51], s83 offen offset:1024 sc1
    buffer_store_dwordx4 v[72:75], v165, s[48:51], s83 offen offset:2048 sc1
    buffer_store_dwordx4 v[76:79], v165, s[48:51], s83 offen offset:3072 sc1
    s_add_u32 s83, s83, 4096
    buffer_store_dwordx4 v[80:83], v165, s[48:51], s83 offen offset:0 sc1
    buffer_store_dwordx4 v[84:87], v165, s[48:51], s83 offen offset:1024 sc1
    buffer_store_dwordx4 v[88:91], v165, s[48:51], s83 offen offset:2048 sc1
    buffer_store_dwordx4 v[92:95], v165, s[48:51], s83 offen offset:3072 sc1
    s_add_u32 s83, s83, 4096
    buffer_store_dwordx4 v[96:99], v165, s[48:51], s83 offen offset:0 sc1
    buffer_store_dwordx4 v[100:103], v165, s[48:51], s83 offen offset:1024 sc1
    buffer_store_dwordx4 v[104:107], v165, s[48:51], s83 offen offset:2048 sc1
    buffer_store_dwordx4 v[108:111], v165, s[48:51], s83 offen offset:3072 sc1
    s_add_u32 s83, s83, 4096
    buffer_store_dwordx4 v[112:115], v165, s[48:51], s83 offen offset:0 sc1
    buffer_store_dwordx4 v[116:119], v165, s[48:51], s83 offen offset:1024 sc1
    buffer_store_dwordx4 v[120:123], v165, s[48:51], s83 offen offset:2048 sc1
    buffer_store_dwordx4 v[124:127], v165, s[48:51], s83 offen offset:3072 sc1
    s_add_u32 s83, s83, 4096
    buffer_store_dwordx4 v[128:131], v165, s[48:51], s83 offen offset:0 sc1
    buffer_store_dwordx4 v[132:135], v165, s[48:51], s83 offen offset:1024 sc1
    buffer_store_dwordx4 v[136:139], v165, s[48:51], s83 offen offset:2048 sc1
    buffer_store_dwordx4 v[140:143], v165, s[48:51], s83 offen offset:3072 sc1
    s_add_u32 s83, s83, 4096
    buffer_store_dwordx4 v[144:147], v165, s[48:51], s83 offen offset:0 sc1
    buffer_store_dwordx4 v[148:151], v165, s[48:51], s83 offen offset:1024 sc1
    buffer_store_dwordx4 v[152:155], v165, s[48:51], s83 offen offset:2048 sc1
    buffer_store_dwordx4 v[156:159], v165, s[48:51], s83 offen offset:3072 sc1
    s_add_u32 s83, s83, 4096
    s_waitcnt vmcnt(0)
    v_mov_b32 v14, 155660
    s_mov_b32 s96, 1048576
L_spin_81:
    ds_read_b32 v16, v14
    s_waitcnt lgkmcnt(0)
    v_cmp_gt_u32 vcc, 2, v16
    s_sub_u32 s96, s96, 1
    s_cmp_eq_u32 s96, 0
    s_cbranch_scc1 L_spind_82
    s_nop 2
    s_cbranch_vccz L_spind_82
    s_sleep 2
    s_branch L_spin_81
L_spind_82:
    s_lshl_b32 s3, s66, 4
    s_add_u32 s3, s3, s65
    s_lshl_b32 s3, s3, 2
    s_add_u32 s3, s3, 12976128
    v_mov_b32 v14, 0
    v_mov_b32 v15, s15
    s_mov_b64 exec, 1
    buffer_store_dword v15, v14, s[48:51], s3 offen sc1
    s_mov_b64 exec, -1
    s_mov_b32 s56, s20
    s_and_b32 s57, s21, 0xffff
    s_mov_b32 s58, 2097152
    s_mov_b32 s59, 0x20000
    v_lshrrev_b32 v19, 3, v166
    v_lshl_add_u32 v19, v19, 11, v13
    s_bfe_u32 s5, s65, 0x20001
    s_lshl_b32 s5, s5, 2
    s_lshr_b32 s5, 0x5567, s5
    s_and_b32 s5, s5, 15
    s_mul_i32 s6, s5, 8
    s_add_u32 s6, s6, 6
    v_mov_b32 v14, 155904
    s_mov_b32 s96, s6
L_spin_83:
    ds_read_b32 v16, v14
    s_waitcnt lgkmcnt(0)
    v_cmp_gt_u32 vcc, s5, v16
    s_sub_u32 s96, s96, 1
    s_cmp_eq_u32 s96, 0
    s_cbranch_scc1 L_spind_84
    s_nop 2
    s_cbranch_vccz L_spind_84
    s_sleep 4
    s_branch L_spin_83
L_spind_84:
    s_lshr_b32 s3, s2, 3
    s_and_b32 s3, s3, 15
    s_lshl_b32 s3, s3, 7
    s_add_u32 s3, s3, 1572864
    buffer_load_dwordx4 v[32:35], v19, s[56:59], s3 offen
    s_add_u32 s3, s3, 16384
    buffer_load_dwordx4 v[36:39], v19, s[56:59], s3 offen
    s_add_u32 s3, s3, 16384
    buffer_load_dwordx4 v[40:43], v19, s[56:59], s3 offen
    s_add_u32 s3, s3, 16384
    buffer_load_dwordx4 v[44:47], v19, s[56:59], s3 offen
    s_add_u32 s3, s3, 16384
    buffer_load_dwordx4 v[48:51], v19, s[56:59], s3 offen
    s_add_u32 s3, s3, 16384
    buffer_load_dwordx4 v[52:55], v19, s[56:59], s3 offen
    s_add_u32 s3, s3, 16384
    buffer_load_dwordx4 v[56:59], v19, s[56:59], s3 offen
    s_add_u32 s3, s3, 16384
    buffer_load_dwordx4 v[60:63], v19, s[56:59], s3 offen
    s_add_u32 s3, s3, 16384
    buffer_load_dwordx4 v[64:67], v19, s[56:59], s3 offen
    s_add_u32 s3, s3, 16384
    buffer_load_dwordx4 v[68:71], v19, s[56:59], s3 offen
    s_add_u32 s3, s3, 16384
    buffer_load_dwordx4 v[72:75], v19, s[56:59], s3 offen
    s_add_u32 s3, s3, 16384
    buffer_load_dwordx4 v[76:79], v19, s[56:59], s3 offen
    s_add_u32 s3, s3, 16384
    buffer_load_dwordx4 v[80:83], v19, s[56:59], s3 offen
    s_add_u32 s3, s3, 16384
    buffer_load_dwordx4 v[84:87], v19, s[56:59], s3 offen
    s_add_u32 s3, s3, 16384
    buffer_load_dwordx4 v[88:91], v19, s[56:59], s3 offen
    s_add_u32 s3, s3, 16384
    buffer_load_dwordx4 v[92:95], v19, s[56:59], s3 offen
    s_add_u32 s3, s3, 16384
    buffer_load_dwordx4 v[96:99], v19, s[56:59], s3 offen
    s_add_u32 s3, s3, 16384
    buffer_load_dwordx4 v[100:103], v19, s[56:59], s3 offen
    s_add_u32 s3, s3, 16384
    buffer_load_dwordx4 v[104:107], v19, s[56:59], s3 offen
    s_add_u32 s3, s3, 16384
    buffer_load_dwordx4 v[108:111], v19, s[56:59], s3 offen
    s_add_u32 s3, s3, 16384
    buffer_load_dwordx4 v[112:115], v19, s[56:59], s3 offen
    s_add_u32 s3, s3, 16384
    buffer_load_dwordx4 v[116:119], v19, s[56:59], s3 offen
    s_add_u32 s3, s3, 16384
    buffer_load_dwordx4 v[120:123], v19, s[56:59], s3 offen
    s_add_u32 s3, s3, 16384
    buffer_load_dwordx4 v[124:127], v19, s[56:59], s3 offen
    s_add_u32 s3, s3, 16384
    buffer_load_dwordx4 v[128:131], v19, s[56:59], s3 offen
    s_add_u32 s3, s3, 16384
    buffer_load_dwordx4 v[132:135], v19, s[56:59], s3 offen
    s_add_u32 s3, s3, 16384
    buffer_load_dwordx4 v[136:139], v19, s[56:59], s3 offen
    s_add_u32 s3, s3, 16384
    buffer_load_dwordx4 v[140:143], v19, s[56:59], s3 offen
    s_add_u32 s3, s3, 16384
    buffer_load_dwordx4 v[144:147], v19, s[56:59], s3 offen
    s_add_u32 s3, s3, 16384
    buffer_load_dwordx4 v[148:151], v19, s[56:59], s3 offen
    s_add_u32 s3, s3, 16384
    buffer_load_dwordx4 v[152:155], v19, s[56:59], s3 offen
    s_add_u32 s3, s3, 16384
    buffer_load_dwordx4 v[156:159], v19, s[56:59], s3 offen
    s_add_u32 s3, s3, 16384
    v_add_u32 v20, 98304, v165
    s_waitcnt vmcnt(0)
    v_min_u32 v14, 7, v166
    v_mul_u32_u24 v14, 256, v14
    v_add_u32 v14, 155904, v14
    s_mov_b32 s96, 1048576
L_spin_85:
    ds_read_b32 v16, v14
    s_waitcnt lgkmcnt(0)
    v_cmp_gt_u32 vcc, 15, v16
    s_sub_u32 s96, s96, 1
    s_cmp_eq_u32 s96, 0
    s_cbranch_scc1 L_spind_86
    s_nop 2
    s_cbranch_vccz L_spind_86
    s_sleep 2
    s_branch L_spin_85
L_spind_86:
    ds_write_b128 v20, v[32:35] offset:0
    ds_write_b128 v20, v[36:39] offset:1024
    ds_write_b128 v20, v[40:43] offset:2048
    ds_write_b128 v20, v[44:47] offset:3072
    ds_write_b128 v20, v[48:51] offset:4096
    ds_write_b128 v20, v[52:55] offset:5120
    ds_write_b128 v20, v[56:59] offset:6144
    ds_write_b128 v20, v[60:63] offset:7168
    ds_write_b128 v20, v[64:67] offset:8192
    ds_write_b128 v20, v[68:71] offset:9216
    ds_write_b128 v20, v[72:75] offset:10240
    ds_write_b128 v20, v[76:79] offset:11264
    s_waitcnt lgkmcnt(4)
    ds_write_b128 v20, v[80:83] offset:12288
    ds_write_b128 v20, v[84:87] offset:13312
    ds_write_b128 v20, v[88:91] offset:14336
    ds_write_b128 v20, v[92:95] offset:15360
    s_waitcnt lgkmcnt(0)
    v_mov_b32 v14, 155716
    v_mov_b32 v15, 0x3000
    s_mov_b64 exec, 1
    ds_or_b32 v14, v15
    s_mov_b64 exec, -1
    v_min_u32 v14, 7, v166
    v_mul_u32_u24 v14, 256, v14
    v_add_u32 v14, 155904, v14
    s_mov_b32 s96, 1048576
L_spin_87:
    ds_read_b32 v16, v14
    s_waitcnt lgkmcnt(0)
    v_cmp_gt_u32 vcc, 16, v16
    s_sub_u32 s96, s96, 1
    s_cmp_eq_u32 s96, 0
    s_cbranch_scc1 L_spind_88
    s_nop 2
    s_cbranch_vccz L_spind_88
    s_sleep 2
    s_branch L_spin_87
L_spind_88:
    ds_write_b128 v20, v[96:99] offset:16384
    ds_write_b128 v20, v[100:103] offset:17408
    ds_write_b128 v20, v[104:107] offset:18432
    ds_write_b128 v20, v[108:111] offset:19456
    ds_write_b128 v20, v[112:115] offset:20480
    ds_write_b128 v20, v[116:119] offset:21504
    ds_write_b128 v20, v[120:123] offset:22528
    ds_write_b128 v20, v[124:127] offset:23552
    ds_write_b128 v20, v[128:131] offset:24576
    ds_write_b128 v20, v[132:135] offset:25600
    ds_write_b128 v20, v[136:139] offset:26624
    ds_write_b128 v20, v[140:143] offset:27648
    s_waitcnt lgkmcnt(4)
    ds_write_b128 v20, v[144:147] offset:28672
    ds_write_b128 v20, v[148:151] offset:29696
    ds_write_b128 v20, v[152:155] offset:30720
    ds_write_b128 v20, v[156:159] offset:31744
    s_waitcnt lgkmcnt(0)
    v_mov_b32 v14, 155716
    v_mov_b32 v15, 0xc000
    s_mov_b64 exec, 1
    ds_or_b32 v14, v15
    s_mov_b64 exec, -1
    s_endpgm
L_h2_2:
    v_min_u32 v36, 7, v166
    v_lshlrev_b32 v36, 8, v36
    v_add_u32 v36, 155904, v36
    v_mov_b32 v37, 155904
    v_mov_b32 v38, 155680
    s_mov_b32 s96, 30
L_spin_89:
    ds_read_b32 v16, v37
    s_waitcnt lgkmcnt(0)
    v_cmp_gt_u32 vcc, 2, v16
    s_sub_u32 s96, s96, 1
    s_cmp_eq_u32 s96, 0
    s_cbranch_scc1 L_spind_90
    s_nop 2
    s_cbranch_vccz L_spind_90
    s_sleep 4
    s_branch L_spin_89
L_spind_90:
    s_mov_b32 s96, 65536
    s_mov_b32 s5, 12980224
L_poll_91:
    buffer_load_dwordx4 v[20:23], v165, s[48:51], s5 offen sc1
    buffer_load_dwordx4 v[24:27], v165, s[48:51], s5 offen offset:1024 sc1
    s_waitcnt vmcnt(0)
    v_xor_b32 v28, s15, v21
    v_xor_b32 v29, s15, v23
    v_xor_b32 v30, s15, v25
    v_xor_b32 v31, s15, v27
    v_or3_b32 v28, v28, v29, v30
    v_or_b32 v28, v28, v31
    v_cmp_ne_u32 vcc, 0, v28
    s_sub_u32 s96, s96, 1
    s_cmp_eq_u32 s96, 0
    s_cbranch_scc1 L_polld_92
    s_nop 2
    s_cbranch_vccz L_polld_92
    s_sleep 16
    s_branch L_poll_91
L_polld_92:
    v_max_u32 v16, v20, v22
    v_max3_u32 v16, v16, v24, v26
    s_nop 1
    v_max_u32_dpp v16, v16, v16 quad_perm:[1,0,3,2] row_mask:0xf bank_mask:0xf
    s_nop 1
    v_max_u32_dpp v16, v16, v16 quad_perm:[2,3,0,1] row_mask:0xf bank_mask:0xf
    s_nop 1
    v_max_u32_dpp v16, v16, v16 row_half_mirror row_mask:0xf bank_mask:0xf
    s_nop 1
    v_max_u32_dpp v16, v16, v16 row_mirror row_mask:0xf bank_mask:0xf
    s_nop 1
    v_readlane_b32 s71, v16, 0
    v_readlane_b32 s3, v16, 16
    s_nop 1
    s_max_u32 s71, s71, s3
    v_readlane_b32 s3, v16, 32
    s_nop 1
    s_max_u32 s71, s71, s3
    v_readlane_b32 s3, v16, 48
    s_nop 1
    s_max_u32 s71, s71, s3
    s_and_b32 s3, s71, 2047
    s_sub_u32 s70, 2047, s3
    v_mov_b32 v14, 155676
    v_mov_b32 v15, s71
    ds_write_b32 v14, v15
    s_waitcnt lgkmcnt(0)
    v_mov_b32 v14, 155668
    v_mov_b32 v15, 1
    ds_write_b32 v14, v15
    s_mov_b32 s56, s26
    s_and_b32 s57, s27, 0xffff
    s_mov_b32 s58, 7340032
    s_mov_b32 s59, 0x20000
    s_mov_b32 s60, s28
    s_and_b32 s61, s29, 0xffff
    s_mov_b32 s62, 7340032
    s_mov_b32 s63, 0x20000
    s_mov_b32 s92, s30
    s_and_b32 s93, s31, 0xffff
    s_mov_b32 s94, 7340032
    s_mov_b32 s95, 0x20000
    s_cmp_ge_u32 s2, 224
    s_cselect_b32 s58, 0, s58
    s_cselect_b32 s62, 0, s62
    v_lshrrev_b32 v19, 3, v166
    s_movk_i32 s3, 7168
    v_mul_lo_u32 v18, v19, s3
    v_and_b32 v15, 7, v166
    v_bfe_u32 v14, v166, 4, 2
    v_lshlrev_b32 v14, 1, v14
    v_xor_b32 v15, v15, v14
    v_lshl_add_u32 v18, v15, 4, v18
    v_lshlrev_b32 v19, 11, v19
    v_lshl_add_u32 v19, v15, 4, v19
    v_lshrrev_b32 v17, 2, v166
    v_lshlrev_b32 v17, 7, v17
    v_and_b32 v15, 3, v166
    v_lshl_add_u32 v17, v15, 3, v17
    v_add_u32 v17, 131072, v17
    v_bfe_u32 v14, v166, 3, 2
    v_lshl_add_u32 v30, v14, 5, v17
    v_xor_b32 v31, 32, v30
    v_xor_b32 v32, 64, v30
    v_xor_b32 v33, 96, v30
    v_lshlrev_b32 v35, 2, v166
    v_add_u32 v35, 158208, v35
    v_lshlrev_b32 v34, 3, v166
    s_and_b32 s3, s2, 3
    s_lshl_b32 s3, s3, 8
    s_add_u32 s3, s3, 0
    s_mul_i32 s80, s3, 7168
    s_lshr_b32 s3, s2, 2
    s_lshl_b32 s3, s3, 7
    s_add_u32 s80, s80, s3
    s_lshr_b32 s3, s2, 4
    s_mul_i32 s3, s3, 224
    s_add_u32 s3, s3, 0
    s_lshl_b32 s81, s3, 11
    s_and_b32 s3, s2, 15
    s_lshl_b32 s3, s3, 7
    s_add_u32 s81, s81, s3
    s_bfe_u32 s5, s65, 0x20001
    s_lshl_b32 s5, s5, 2
    s_lshr_b32 s5, 0x6655, s5
    s_and_b32 s5, s5, 15
    s_mul_i32 s6, s5, 8
    s_add_u32 s6, s6, 6
    s_mov_b32 s96, s6
L_spin_93:
    ds_read_b32 v16, v37
    s_waitcnt lgkmcnt(0)
    v_cmp_gt_u32 vcc, s5, v16
    s_sub_u32 s96, s96, 1
    s_cmp_eq_u32 s96, 0
    s_cbranch_scc1 L_spind_94
    s_nop 2
    s_cbranch_vccz L_spind_94
    s_sleep 4
    s_branch L_spin_93
L_spind_94:
    s_mov_b32 s96, 1048576
L_spin_95:
    ds_read_b32 v16, v36
    s_waitcnt lgkmcnt(0)
    v_cmp_gt_u32 vcc, 1, v16
    s_sub_u32 s96, s96, 1
    s_cmp_eq_u32 s96, 0
    s_cbranch_scc1 L_spind_96
    s_nop 2
    s_cbranch_vccz L_spind_96
    s_sleep 4
    s_branch L_spin_95
L_spind_96:
    v_mov_b32 v14, 155660
    s_mov_b32 s96, 1048576
L_spin_97:
    ds_read_b32 v16, v14
    s_waitcnt lgkmcnt(0)
    v_cmp_gt_u32 vcc, 1, v16
    s_sub_u32 s96, s96, 1
    s_cmp_eq_u32 s96, 0
    s_cbranch_scc1 L_spind_98
    s_nop 2
    s_cbranch_vccz L_spind_98
    s_sleep 4
    s_branch L_spin_97
L_spind_98:
    s_add_u32 s3, s80, 0
    s_mov_b32 m0, 131072
    s_nop 0
    buffer_load_dwordx4 v18, s[56:59], s3 offen nt lds
    s_mov_b32 m0, 132096
    s_add_u32 s3, s3, 57344
    buffer_load_dwordx4 v18, s[56:59], s3 offen nt lds
    s_mov_b32 m0, 133120
    s_add_u32 s3, s3, 57344
    buffer_load_dwordx4 v18, s[56:59], s3 offen nt lds
    s_mov_b32 m0, 134144
    s_add_u32 s3, s3, 57344
    buffer_load_dwordx4 v18, s[56:59], s3 offen nt lds
    s_add_u32 s3, s80, 229376
    s_mov_b32 m0, 135168
    s_nop 0
    buffer_load_dwordx4 v18, s[56:59], s3 offen nt lds
    s_mov_b32 m0, 136192
    s_add_u32 s3, s3, 57344
    buffer_load_dwordx4 v18, s[56:59], s3 offen nt lds
    s_mov_b32 m0, 137216
    s_add_u32 s3, s3, 57344
    buffer_load_dwordx4 v18, s[56:59], s3 offen nt lds
    s_mov_b32 m0, 138240
    s_add_u32 s3, s3, 57344
    buffer_load_dwordx4 v18, s[56:59], s3 offen nt lds
    s_add_u32 s3, s80, 458752
    s_mov_b32 m0, 139264
    s_nop 0
    buffer_load_dwordx4 v18, s[56:59], s3 offen nt lds
    s_mov_b32 m0, 140288
    s_add_u32 s3, s3, 57344
    buffer_load_dwordx4 v18, s[56:59], s3 offen nt lds
    s_mov_b32 m0, 141312
    s_add_u32 s3, s3, 57344
    buffer_load_dwordx4 v18, s[56:59], s3 offen nt lds
    s_mov_b32 m0, 142336
    s_add_u32 s3, s3, 57344
    buffer_load_dwordx4 v18, s[56:59], s3 offen nt lds
    v_mov_b32 v14, 155668
    s_mov_b32 s96, 1048576
L_spin_99:
    ds_read_b32 v16, v14
    s_waitcnt lgkmcnt(0)
    v_cmp_gt_u32 vcc, 1, v16
    s_sub_u32 s96, s96, 1
    s_cmp_eq_u32 s96, 0
    s_cbranch_scc1 L_spind_100
    s_nop 2
    s_cbranch_vccz L_spind_100
    s_sleep 4
    s_branch L_spin_99
L_spind_100:
    v_mov_b32 v14, 155676
    ds_read_b32 v14, v14
    s_waitcnt vmcnt(0) lgkmcnt(0)
    v_readfirstlane_b32 s71, v14
    s_nop 1
    s_and_b32 s3, s71, 2047
    s_sub_u32 s70, 2047, s3
    v_lshrrev_b32 v15, 4, v166
    v_lshlrev_b32 v15, 3, v15
    s_and_b32 s3, s2, 3
    s_lshl_b32 s3, s3, 9
    s_add_u32 s3, s3, 0
    s_lshl_b32 s4, s70, 11
    s_add_u32 s3, s3, s4
    buffer_load_dwordx2 v[40:41], v15, s[40:43], s3 offen offset:0
    buffer_load_dwordx2 v[42:43], v15, s[40:43], s3 offen offset:32
    buffer_load_dwordx2 v[44:45], v15, s[40:43], s3 offen offset:64
    buffer_load_dwordx2 v[46:47], v15, s[40:43], s3 offen offset:96
    buffer_load_dwordx2 v[48:49], v15, s[40:43], s3 offen offset:128
    buffer_load_dwordx2 v[50:51], v15, s[40:43], s3 offen offset:160
    buffer_load_dwordx2 v[52:53], v15, s[40:43], s3 offen offset:192
    buffer_load_dwordx2 v[54:55], v15, s[40:43], s3 offen offset:224
    ds_read_b64_tr_b16 v[100:101], v30 offset:0
    ds_read_b64_tr_b16 v[102:103], v30 offset:2048
    ds_read_b64_tr_b16 v[104:105], v31 offset:0
    ds_read_b64_tr_b16 v[106:107], v31 offset:2048
    ds_read_b64_tr_b16 v[108:109], v32 offset:0
    ds_read_b64_tr_b16 v[110:111], v32 offset:2048
    ds_read_b64_tr_b16 v[112:113], v33 offset:0
    ds_read_b64_tr_b16 v[114:115], v33 offset:2048
    s_waitcnt lgkmcnt(0)
    ds_read_b64_tr_b16 v[116:117], v30 offset:4096
    ds_read_b64_tr_b16 v[118:119], v30 offset:6144
    ds_read_b64_tr_b16 v[120:121], v31 offset:4096
    ds_read_b64_tr_b16 v[122:123], v31 offset:6144
    ds_read_b64_tr_b16 v[124:125], v32 offset:4096
    ds_read_b64_tr_b16 v[126:127], v32 offset:6144
    ds_read_b64_tr_b16 v[128:129], v33 offset:4096
    ds_read_b64_tr_b16 v[130:131], v33 offset:6144
    s_waitcnt lgkmcnt(0)
    ds_read_b64_tr_b16 v[132:133], v30 offset:8192
    ds_read_b64_tr_b16 v[134:135], v30 offset:10240
    ds_read_b64_tr_b16 v[136:137], v31 offset:8192
    ds_read_b64_tr_b16 v[138:139], v31 offset:10240
    ds_read_b64_tr_b16 v[140:141], v32 offset:8192
    ds_read_b64_tr_b16 v[142:143], v32 offset:10240
    ds_read_b64_tr_b16 v[144:145], v33 offset:8192
    ds_read_b64_tr_b16 v[146:147], v33 offset:10240
    s_waitcnt lgkmcnt(0)
    s_bfe_u32 s5, s65, 0x20001
    s_lshl_b32 s5, s5, 2
    s_lshr_b32 s5, 0x7776, s5
    s_and_b32 s5, s5, 15
    s_mul_i32 s6, s5, 8
    s_add_u32 s6, s6, 6
    s_mov_b32 s96, s6
L_spin_101:
    ds_read_b32 v16, v37
    s_waitcnt lgkmcnt(0)
    v_cmp_gt_u32 vcc, s5, v16
    s_sub_u32 s96, s96, 1
    s_cmp_eq_u32 s96, 0
    s_cbranch_scc1 L_spind_102
    s_nop 2
    s_cbranch_vccz L_spind_102
    s_sleep 4
    s_branch L_spin_101
L_spind_102:
    s_add_u32 s3, s80, 688128
    s_mov_b32 m0, 131072
    s_nop 0
    buffer_load_dwordx4 v18, s[56:59], s3 offen nt lds
    s_mov_b32 m0, 132096
    s_add_u32 s3, s3, 57344
    buffer_load_dwordx4 v18, s[56:59], s3 offen nt lds
    s_mov_b32 m0, 133120
    s_add_u32 s3, s3, 57344
    buffer_load_dwordx4 v18, s[56:59], s3 offen nt lds
    s_mov_b32 m0, 134144
    s_add_u32 s3, s3, 57344
    buffer_load_dwordx4 v18, s[56:59], s3 offen nt lds
    s_add_u32 s3, s80, 0
    s_mov_b32 m0, 135168
    s_nop 0
    buffer_load_dwordx4 v18, s[60:63], s3 offen nt lds
    s_mov_b32 m0, 136192
    s_add_u32 s3, s3, 57344
    buffer_load_dwordx4 v18, s[60:63], s3 offen nt lds
    s_mov_b32 m0, 137216
    s_add_u32 s3, s3, 57344
    buffer_load_dwordx4 v18, s[60:63], s3 offen nt lds
    s_mov_b32 m0, 138240
    s_add_u32 s3, s3, 57344
    buffer_load_dwordx4 v18, s[60:63], s3 offen nt lds
    s_add_u32 s3, s80, 229376
    s_mov_b32 m0, 139264
    s_nop 0
    buffer_load_dwordx4 v18, s[60:63], s3 offen nt lds
    s_mov_b32 m0, 140288
    s_add_u32 s3, s3, 57344
    buffer_load_dwordx4 v18, s[60:63], s3 offen nt lds
    s_mov_b32 m0, 141312
    s_add_u32 s3, s3, 57344
    buffer_load_dwordx4 v18, s[60:63], s3 offen nt lds
    s_mov_b32 m0, 142336
    s_add_u32 s3, s3, 57344
    buffer_load_dwordx4 v18, s[60:63], s3 offen nt lds
    s_waitcnt vmcnt(12)
    s_setprio 0
    v_mfma_f32_16x16x32_bf16 v[72:75], v[40:43], v[100:103], 0
    v_mfma_f32_16x16x32_bf16 v[76:79], v[40:43], v[104:107], 0
    v_mfma_f32_16x16x32_bf16 v[80:83], v[40:43], v[108:111], 0
    v_mfma_f32_16x16x32_bf16 v[84:87], v[40:43], v[112:115], 0
    s_setprio 3
    s_setprio 0
    v_mfma_f32_16x16x32_bf16 v[72:75], v[44:47], v[116:119], v[72:75]
    v_mfma_f32_16x16x32_bf16 v[76:79], v[44:47], v[120:123], v[76:79]
    v_mfma_f32_16x16x32_bf16 v[80:83], v[44:47], v[124:127], v[80:83]
    v_mfma_f32_16x16x32_bf16 v[84:87], v[44:47], v[128:131], v[84:87]
    s_setprio 3
    s_setprio 0
    v_mfma_f32_16x16x32_bf16 v[72:75], v[48:51], v[132:135], v[72:75]
    v_mfma_f32_16x16x32_bf16 v[76:79], v[48:51], v[136:139], v[76:79]
    v_mfma_f32_16x16x32_bf16 v[80:83], v[48:51], v[140:143], v[80:83]
    v_mfma_f32_16x16x32_bf16 v[84:87], v[48:51], v[144:147], v[84:87]
    s_setprio 3
    s_waitcnt vmcnt(0)
    ds_read_b64_tr_b16 v[100:101], v30 offset:0
    ds_read_b64_tr_b16 v[102:103], v30 offset:2048
    ds_read_b64_tr_b16 v[104:105], v31 offset:0
    ds_read_b64_tr_b16 v[106:107], v31 offset:2048
    ds_read_b64_tr_b16 v[108:109], v32 offset:0
    ds_read_b64_tr_b16 v[110:111], v32 offset:2048
    ds_read_b64_tr_b16 v[112:113], v33 offset:0
    ds_read_b64_tr_b16 v[114:115], v33 offset:2048
    s_waitcnt lgkmcnt(0)
    ds_read_b64_tr_b16 v[116:117], v30 offset:4096
    ds_read_b64_tr_b16 v[118:119], v30 offset:6144
    ds_read_b64_tr_b16 v[120:121], v31 offset:4096
    ds_read_b64_tr_b16 v[122:123], v31 offset:6144
    ds_read_b64_tr_b16 v[124:125], v32 offset:4096
    ds_read_b64_tr_b16 v[126:127], v32 offset:6144
    ds_read_b64_tr_b16 v[128:129], v33 offset:4096
    ds_read_b64_tr_b16 v[130:131], v33 offset:6144
    s_waitcnt lgkmcnt(0)
    ds_read_b64_tr_b16 v[132:133], v30 offset:8192
    ds_read_b64_tr_b16 v[134:135], v30 offset:10240
    ds_read_b64_tr_b16 v[136:137], v31 offset:8192
    ds_read_b64_tr_b16 v[138:139], v31 offset:10240
    ds_read_b64_tr_b16 v[140:141], v32 offset:8192
    ds_read_b64_tr_b16 v[142:143], v32 offset:10240
    ds_read_b64_tr_b16 v[144:145], v33 offset:8192
    ds_read_b64_tr_b16 v[146:147], v33 offset:10240
    s_waitcnt lgkmcnt(0)
    s_bfe_u32 s5, s65, 0x20001
    s_lshl_b32 s5, s5, 2
    s_lshr_b32 s5, 0x9888, s5
    s_and_b32 s5, s5, 15
    s_mul_i32 s6, s5, 8
    s_add_u32 s6, s6, 6
    s_mov_b32 s96, s6
L_spin_103:
    ds_read_b32 v16, v37
    s_waitcnt lgkmcnt(0)
    v_cmp_gt_u32 vcc, s5, v16
    s_sub_u32 s96, s96, 1
    s_cmp_eq_u32 s96, 0
    s_cbranch_scc1 L_spind_104
    s_nop 2
    s_cbranch_vccz L_spind_104
    s_sleep 4
    s_branch L_spin_103
L_spind_104:
    s_add_u32 s3, s80, 458752
    s_mov_b32 m0, 131072
    s_nop 0
    buffer_load_dwordx4 v18, s[60:63], s3 offen nt lds
    s_mov_b32 m0, 132096
    s_add_u32 s3, s3, 57344
    buffer_load_dwordx4 v18, s[60:63], s3 offen nt lds
    s_mov_b32 m0, 133120
    s_add_u32 s3, s3, 57344
    buffer_load_dwordx4 v18, s[60:63], s3 offen nt lds
    s_mov_b32 m0, 134144
    s_add_u32 s3, s3, 57344
    buffer_load_dwordx4 v18, s[60:63], s3 offen nt lds
    s_add_u32 s3, s80, 688128
    s_mov_b32 m0, 135168
    s_nop 0
    buffer_load_dwordx4 v18, s[60:63], s3 offen nt lds
    s_mov_b32 m0, 136192
    s_add_u32 s3, s3, 57344
    buffer_load_dwordx4 v18, s[60:63], s3 offen nt lds
    s_mov_b32 m0, 137216
    s_add_u32 s3, s3, 57344
    buffer_load_dwordx4 v18, s[60:63], s3 offen nt lds
    s_mov_b32 m0, 138240
    s_add_u32 s3, s3, 57344
    buffer_load_dwordx4 v18, s[60:63], s3 offen nt lds
    s_add_u32 s3, s81, 0
    s_mov_b32 m0, 139264
    s_nop 0
    buffer_load_dwordx4 v19, s[92:95], s3 offen nt lds
    s_mov_b32 m0, 140288
    s_add_u32 s3, s3, 16384
    buffer_load_dwordx4 v19, s[92:95], s3 offen nt lds
    s_mov_b32 m0, 141312
    s_add_u32 s3, s3, 16384
    buffer_load_dwordx4 v19, s[92:95], s3 offen nt lds
    s_mov_b32 m0, 142336
    s_add_u32 s3, s3, 16384
    buffer_load_dwordx4 v19, s[92:95], s3 offen nt lds
    s_setprio 0
    v_mfma_f32_16x16x32_bf16 v[72:75], v[52:55], v[100:103], v[72:75]
    v_mfma_f32_16x16x32_bf16 v[76:79], v[52:55], v[104:107], v[76:79]
    v_mfma_f32_16x16x32_bf16 v[80:83], v[52:55], v[108:111], v[80:83]
    v_mfma_f32_16x16x32_bf16 v[84:87], v[52:55], v[112:115], v[84:87]
    s_setprio 3
    s_setprio 0
    v_mfma_f32_16x16x32_bf16 v[56:59], v[40:43], v[116:119], 0
    v_mfma_f32_16x16x32_bf16 v[60:63], v[40:43], v[120:123], 0
    v_mfma_f32_16x16x32_bf16 v[64:67], v[40:43], v[124:127], 0
    v_mfma_f32_16x16x32_bf16 v[68:71], v[40:43], v[128:131], 0
    s_setprio 3
    s_setprio 0
    v_mfma_f32_16x16x32_bf16 v[56:59], v[44:47], v[132:135], v[56:59]
    v_mfma_f32_16x16x32_bf16 v[60:63], v[44:47], v[136:139], v[60:63]
    v_mfma_f32_16x16x32_bf16 v[64:67], v[44:47], v[140:143], v[64:67]
    v_mfma_f32_16x16x32_bf16 v[68:71], v[44:47], v[144:147], v[68:71]
    s_setprio 3
    s_nop 7
    s_mov_b64 exec, 0xffff
    ds_write_b32 v35, v72 offset:0
    ds_write_b32 v35, v76 offset:64
    ds_write_b32 v35, v80 offset:128
    ds_write_b32 v35, v84 offset:192
    s_mov_b64 exec, -1
    s_waitcnt vmcnt(0)
    ds_read_b64_tr_b16 v[100:101], v30 offset:0
    ds_read_b64_tr_b16 v[102:103], v30 offset:2048
    ds_read_b64_tr_b16 v[104:105], v31 offset:0
    ds_read_b64_tr_b16 v[106:107], v31 offset:2048
    ds_read_b64_tr_b16 v[108:109], v32 offset:0
    ds_read_b64_tr_b16 v[110:111], v32 offset:2048
    ds_read_b64_tr_b16 v[112:113], v33 offset:0
    ds_read_b64_tr_b16 v[114:115], v33 offset:2048
    s_waitcnt lgkmcnt(0)
    ds_read_b64_tr_b16 v[116:117], v30 offset:4096
    ds_read_b64_tr_b16 v[118:119], v30 offset:6144
    ds_read_b64_tr_b16 v[120:121], v31 offset:4096
    ds_read_b64_tr_b16 v[122:123], v31 offset:6144
    ds_read_b64_tr_b16 v[124:125], v32 offset:4096
    ds_read_b64_tr_b16 v[126:127], v32 offset:6144
    ds_read_b64_tr_b16 v[128:129], v33 offset:4096
    ds_read_b64_tr_b16 v[130:131], v33 offset:6144
    s_waitcnt lgkmcnt(0)
    ds_read_b64_tr_b16 v[148:149], v30 offset:8192
    ds_read_b64_tr_b16 v[150:151], v30 offset:10240
    ds_read_b64_tr_b16 v[152:153], v31 offset:8192
    ds_read_b64_tr_b16 v[154:155], v31 offset:10240
    ds_read_b64_tr_b16 v[156:157], v32 offset:8192
    ds_read_b64_tr_b16 v[158:159], v32 offset:10240
    ds_read_b64_tr_b16 v[160:161], v33 offset:8192
    ds_read_b64_tr_b16 v[162:163], v33 offset:10240
    s_waitcnt lgkmcnt(0)
    s_setprio 0
    v_mfma_f32_16x16x32_bf16 v[56:59], v[48:51], v[100:103], v[56:59]
    v_mfma_f32_16x16x32_bf16 v[60:63], v[48:51], v[104:107], v[60:63]
    v_mfma_f32_16x16x32_bf16 v[64:67], v[48:51], v[108:111], v[64:67]
    v_mfma_f32_16x16x32_bf16 v[68:71], v[48:51], v[112:115], v[68:71]
    s_setprio 3
    s_setprio 0
    v_mfma_f32_16x16x32_bf16 v[56:59], v[52:55], v[116:119], v[56:59]
    v_mfma_f32_16x16x32_bf16 v[60:63], v[52:55], v[120:123], v[60:63]
    v_mfma_f32_16x16x32_bf16 v[64:67], v[52:55], v[124:127], v[64:67]
    v_mfma_f32_16x16x32_bf16 v[68:71], v[52:55], v[128:131], v[68:71]
    s_setprio 3
    s_nop 7
    s_mov_b64 exec, 0xffff
    ds_write_b32 v35, v56 offset:256
    ds_write_b32 v35, v60 offset:320
    ds_write_b32 v35, v64 offset:384
    ds_write_b32 v35, v68 offset:448
    s_mov_b64 exec, -1
    s_waitcnt lgkmcnt(0)
    v_mov_b32 v14, 155652
    v_mov_b32 v15, 1
    s_mov_b64 exec, 1
    ds_add_rtn_u32 v16, v14, v15
    s_waitcnt lgkmcnt(0)
    s_mov_b64 exec, -1
    v_readfirstlane_b32 s3, v16
    s_nop 1
    s_cmp_lg_u32 s3, 1
    s_cbranch_scc1 L_last_105
    s_cmp_ge_u32 s2, 224
    s_cbranch_scc1 L_skip_106
    ds_read_b32 v92, v35
    ds_read_b32 v94, v35 offset:256
    ds_read_b32 v96, v35 offset:512
    ds_read_b32 v97, v35 offset:768
    v_mov_b32 v93, s15
    v_mov_b32 v95, s15
    s_waitcnt lgkmcnt(0)
    v_add_f32 v92, v92, v96
    v_add_f32 v94, v94, v97
    s_and_b32 s3, s2, 3
    s_mul_i32 s3, s3, 57344
    s_lshr_b32 s4, s2, 2
    s_lshl_b32 s4, s4, 9
    s_add_u32 s3, s3, s4
    s_add_u32 s3, s3, 12599296
    s_add_u32 s4, s3, 28672
    buffer_store_dwordx2 v[92:93], v34, s[48:51], s3 offen sc1
    buffer_store_dwordx2 v[94:95], v34, s[48:51], s4 offen sc1
L_skip_106:
L_last_105:
    s_bfe_u32 s5, s65, 0x20001
    s_lshl_b32 s5, s5, 2
    s_lshr_b32 s5, 0xaa99, s5
    s_and_b32 s5, s5, 15
    s_mul_i32 s6, s5, 8
    s_add_u32 s6, s6, 6
    s_mov_b32 s96, s6
L_spin_107:
    ds_read_b32 v16, v37
    s_waitcnt lgkmcnt(0)
    v_cmp_gt_u32 vcc, s5, v16
    s_sub_u32 s96, s96, 1
    s_cmp_eq_u32 s96, 0
    s_cbranch_scc1 L_spind_108
    s_nop 2
    s_cbranch_vccz L_spind_108
    s_sleep 4
    s_branch L_spin_107
L_spind_108:
    s_add_u32 s3, s81, 65536
    s_mov_b32 m0, 131072
    s_nop 0
    buffer_load_dwordx4 v19, s[92:95], s3 offen nt lds
    s_mov_b32 m0, 132096
    s_add_u32 s3, s3, 16384
    buffer_load_dwordx4 v19, s[92:95], s3 offen nt lds
    s_mov_b32 m0, 133120
    s_add_u32 s3, s3, 16384
    buffer_load_dwordx4 v19, s[92:95], s3 offen nt lds
    s_mov_b32 m0, 134144
    s_add_u32 s3, s3, 16384
    buffer_load_dwordx4 v19, s[92:95], s3 offen nt lds
    s_add_u32 s3, s81, 131072
    s_mov_b32 m0, 135168
    s_nop 0
    buffer_load_dwordx4 v19, s[92:95], s3 offen nt lds
    s_mov_b32 m0, 136192
    s_add_u32 s3, s3, 16384
    buffer_load_dwordx4 v19, s[92:95], s3 offen nt lds
    s_mov_b32 m0, 137216
    s_add_u32 s3, s3, 16384
    buffer_load_dwordx4 v19, s[92:95], s3 offen nt lds
    s_mov_b32 m0, 138240
    s_add_u32 s3, s3, 16384
    buffer_load_dwordx4 v19, s[92:95], s3 offen nt lds
    s_add_u32 s3, s81, 196608
    s_mov_b32 m0, 139264
    s_nop 0
    buffer_load_dwordx4 v19, s[92:95], s3 offen nt lds
    s_mov_b32 m0, 140288
    s_add_u32 s3, s3, 16384
    buffer_load_dwordx4 v19, s[92:95], s3 offen nt lds
    s_mov_b32 m0, 141312
    s_add_u32 s3, s3, 16384
    buffer_load_dwordx4 v19, s[92:95], s3 offen nt lds
    s_mov_b32 m0, 142336
    s_add_u32 s3, s3, 16384
    buffer_load_dwordx4 v19, s[92:95], s3 offen nt lds
    s_waitcnt vmcnt(0)
    ds_read_b64_tr_b16 v[100:101], v30 offset:0
    ds_read_b64_tr_b16 v[102:103], v30 offset:2048
    ds_read_b64_tr_b16 v[104:105], v31 offset:0
    ds_read_b64_tr_b16 v[106:107], v31 offset:2048
    ds_read_b64_tr_b16 v[108:109], v32 offset:0
    ds_read_b64_tr_b16 v[110:111], v32 offset:2048
    ds_read_b64_tr_b16 v[112:113], v33 offset:0
    ds_read_b64_tr_b16 v[114:115], v33 offset:2048
    s_waitcnt lgkmcnt(0)
    ds_read_b64_tr_b16 v[116:117], v30 offset:4096
    ds_read_b64_tr_b16 v[118:119], v30 offset:6144
    ds_read_b64_tr_b16 v[120:121], v31 offset:4096
    ds_read_b64_tr_b16 v[122:123], v31 offset:6144
    ds_read_b64_tr_b16 v[124:125], v32 offset:4096
    ds_read_b64_tr_b16 v[126:127], v32 offset:6144
    ds_read_b64_tr_b16 v[128:129], v33 offset:4096
    ds_read_b64_tr_b16 v[130:131], v33 offset:6144
    s_waitcnt lgkmcnt(0)
    ds_read_b64_tr_b16 v[132:133], v30 offset:8192
    ds_read_b64_tr_b16 v[134:135], v30 offset:10240
    ds_read_b64_tr_b16 v[136:137], v31 offset:8192
    ds_read_b64_tr_b16 v[138:139], v31 offset:10240
    ds_read_b64_tr_b16 v[140:141], v32 offset:8192
    ds_read_b64_tr_b16 v[142:143], v32 offset:10240
    ds_read_b64_tr_b16 v[144:145], v33 offset:8192
    ds_read_b64_tr_b16 v[146:147], v33 offset:10240
    s_waitcnt lgkmcnt(0)
    s_mov_b32 s96, 1048576
L_spin_109:
    ds_read_b32 v16, v37
    s_waitcnt lgkmcnt(0)
    v_cmp_gt_u32 vcc, 11, v16
    s_sub_u32 s96, s96, 1
    s_cmp_eq_u32 s96, 0
    s_cbranch_scc1 L_spind_110
    s_nop 2
    s_cbranch_vccz L_spind_110
    s_sleep 8
    s_branch L_spin_109
L_spind_110:
    s_lshr_b32 s3, s2, 4
    s_mul_i32 s3, s3, 224
    s_add_u32 s3, s3, 0
    s_lshl_b32 s3, s3, 3
    v_min_u32 v14, 63, v166
    v_lshlrev_b32 v14, 4, v14
    v_add_u32 v14, s3, v14
    s_mov_b32 s96, 65536
L_poll_111:
    s_mov_b32 s5, 12599296
    buffer_load_dwordx4 v[56:59], v14, s[48:51], s5 offen sc1
    s_mov_b32 s5, 12627968
    buffer_load_dwordx4 v[60:63], v14, s[48:51], s5 offen sc1
    s_mov_b32 s5, 12656640
    buffer_load_dwordx4 v[64:67], v14, s[48:51], s5 offen sc1
    s_mov_b32 s5, 12685312
    buffer_load_dwordx4 v[68:71], v14, s[48:51], s5 offen sc1
    s_mov_b32 s5, 12713984
    buffer_load_dwordx4 v[72:75], v14, s[48:51], s5 offen sc1
    s_mov_b32 s5, 12742656
    buffer_load_dwordx4 v[76:79], v14, s[48:51], s5 offen sc1
    s_mov_b32 s5, 12771328
    buffer_load_dwordx4 v[80:83], v14, s[48:51], s5 offen sc1
    s_mov_b32 s5, 12800000
    buffer_load_dwordx4 v[84:87], v14, s[48:51], s5 offen sc1
    s_waitcnt vmcnt(0)
    v_min3_u32 v16, v57, v59, v61
    v_max3_u32 v17, v57, v59, v61
    v_min3_u32 v16, v16, v63, v65
    v_max3_u32 v17, v17, v63, v65
    v_min3_u32 v16, v16, v67, v69
    v_max3_u32 v17, v17, v67, v69
    v_min3_u32 v16, v16, v71, v73
    v_max3_u32 v17, v17, v71, v73
    v_min3_u32 v16, v16, v75, v77
    v_max3_u32 v17, v17, v75, v77
    v_min3_u32 v16, v16, v79, v81
    v_max3_u32 v17, v17, v79, v81
    v_min3_u32 v16, v16, v83, v85
    v_max3_u32 v17, v17, v83, v85
    v_min_u32 v16, v16, v87
    v_max_u32 v17, v17, v87
    v_cmp_ne_u32 vcc, s15, v16
    v_cmp_ne_u32 s[6:7], s15, v17
    s_nop 3
    s_or_b64 vcc, vcc, s[6:7]
    s_sub_u32 s96, s96, 1
    s_cmp_eq_u32 s96, 0
    s_cbranch_scc1 L_polld_112
    s_nop 2
    s_cbranch_vccz L_polld_112
    s_sleep 24
    s_branch L_poll_111
L_polld_112:
    v_add_f32 v88, v56, v64
    v_add_f32 v92, v72, v80
    v_add_f32 v88, v88, v92
    v_add_f32 v89, v58, v66
    v_add_f32 v93, v74, v82
    v_add_f32 v89, v89, v93
    v_add_f32 v90, v60, v68
    v_add_f32 v94, v76, v84
    v_add_f32 v90, v90, v94
    v_add_f32 v91, v62, v70
    v_add_f32 v95, v78, v86
    v_add_f32 v91, v91, v95
    v_cvt_pk_bf16_f32 v92, v88, v89
    v_cvt_pk_bf16_f32 v93, v90, v91
    v_lshlrev_b32 v88, 16, v92
    v_and_b32 v89, 0xffff0000, v92
    v_lshlrev_b32 v90, 16, v93
    v_and_b32 v91, 0xffff0000, v93
    v_mul_f32 v92, 0xbfb8aa3b, v88
    v_mul_f32 v93, 0xbfb8aa3b, v89
    v_exp_f32 v92, v92
    v_exp_f32 v93, v93
    s_nop 0
    v_add_f32 v92, 1.0, v92
    v_add_f32 v93, 1.0, v93
    v_rcp_f32 v92, v92
    v_rcp_f32 v93, v93
    s_nop 0
    v_mul_f32 v92, v88, v92
    v_mul_f32 v93, v89, v93
    v_cvt_pk_bf16_f32 v92, v92, v93
    v_lshlrev_b32 v88, 16, v92
    v_and_b32 v89, 0xffff0000, v92
    v_mul_f32 v88, v88, v90
    v_mul_f32 v89, v89, v91
    v_cvt_pk_bf16_f32 v90, v88, v89
    v_lshlrev_b32 v14, 2, v166
    v_add_u32 v14, 160256, v14
    ds_write_b32 v14, v90
    v_lshrrev_b32 v15, 4, v166
    v_lshlrev_b32 v15, 3, v15
    v_add_u32 v15, 160256, v15
    s_waitcnt lgkmcnt(0)
    ds_read_b64 v[40:41], v15 offset:0
    ds_read_b64 v[42:43], v15 offset:32
    ds_read_b64 v[44:45], v15 offset:64
    ds_read_b64 v[46:47], v15 offset:96
    ds_read_b64 v[48:49], v15 offset:128
    ds_read_b64 v[50:51], v15 offset:160
    ds_read_b64 v[52:53], v15 offset:192
    ds_read_b64 v[54:55], v15 offset:224
    s_waitcnt lgkmcnt(0)
    s_setprio 0
    v_mfma_f32_16x16x32_bf16 v[72:75], v[40:43], v[148:151], 0
    v_mfma_f32_16x16x32_bf16 v[76:79], v[40:43], v[152:155], 0
    v_mfma_f32_16x16x32_bf16 v[80:83], v[40:43], v[156:159], 0
    v_mfma_f32_16x16x32_bf16 v[84:87], v[40:43], v[160:163], 0
    s_setprio 3
    s_setprio 0
    v_mfma_f32_16x16x32_bf16 v[72:75], v[44:47], v[100:103], v[72:75]
    v_mfma_f32_16x16x32_bf16 v[76:79], v[44:47], v[104:107], v[76:79]
    v_mfma_f32_16x16x32_bf16 v[80:83], v[44:47], v[108:111], v[80:83]
    v_mfma_f32_16x16x32_bf16 v[84:87], v[44:47], v[112:115], v[84:87]
    s_setprio 3
    s_setprio 0
    v_mfma_f32_16x16x32_bf16 v[72:75], v[48:51], v[116:119], v[72:75]
    v_mfma_f32_16x16x32_bf16 v[76:79], v[48:51], v[120:123], v[76:79]
    v_mfma_f32_16x16x32_bf16 v[80:83], v[48:51], v[124:127], v[80:83]
    v_mfma_f32_16x16x32_bf16 v[84:87], v[48:51], v[128:131], v[84:87]
    s_setprio 3
    s_setprio 0
    v_mfma_f32_16x16x32_bf16 v[72:75], v[52:55], v[132:135], v[72:75]
    v_mfma_f32_16x16x32_bf16 v[76:79], v[52:55], v[136:139], v[76:79]
    v_mfma_f32_16x16x32_bf16 v[80:83], v[52:55], v[140:143], v[80:83]
    v_mfma_f32_16x16x32_bf16 v[84:87], v[52:55], v[144:147], v[84:87]
    s_setprio 3
    s_nop 7
    s_mov_b64 exec, 0xffff
    ds_write_b32 v35, v72 offset:1536
    ds_write_b32 v35, v76 offset:1600
    ds_write_b32 v35, v80 offset:1664
    ds_write_b32 v35, v84 offset:1728
    s_mov_b64 exec, -1
    s_waitcnt lgkmcnt(0)
    v_mov_b32 v14, 155656
    v_mov_b32 v15, 1
    s_mov_b64 exec, 1
    ds_add_rtn_u32 v16, v14, v15
    s_waitcnt lgkmcnt(0)
    s_mov_b64 exec, -1
    v_readfirstlane_b32 s3, v16
    s_nop 1
    s_cmp_lg_u32 s3, 1
    s_cbranch_scc1 L_last_113
    ds_read_b32 v92, v35 offset:1536
    ds_read_b32 v94, v35 offset:1792
    v_mov_b32 v93, s15
    s_waitcnt lgkmcnt(0)
    v_add_f32 v92, v92, v94
    s_lshr_b32 s3, s2, 4
    s_lshl_b32 s3, s3, 13
    s_and_b32 s4, s2, 15
    s_lshl_b32 s4, s4, 9
    s_add_u32 s3, s3, s4
    s_add_u32 s3, s3, 12845056
    buffer_store_dwordx2 v[92:93], v34, s[48:51], s3 offen sc1
L_last_113:
    s_endpgm
L_h2_3:
    v_min_u32 v36, 7, v166
    v_lshlrev_b32 v36, 8, v36
    v_add_u32 v36, 155904, v36
    v_mov_b32 v37, 155904
    v_mov_b32 v38, 155680
    v_lshlrev_b32 v14, 3, v166
    v_add_u32 v14, 161792, v14
    ds_read_b64 v[24:25], v14
    v_add_u32 v14, 139264, v165
    ds_read_b128 v[100:103], v14 offset:0
    ds_read_b128 v[104:107], v14 offset:1024
    ds_read_b128 v[108:111], v14 offset:2048
    ds_read_b128 v[112:115], v14 offset:3072
    ds_read_b128 v[116:119], v14 offset:4096
    ds_read_b128 v[120:123], v14 offset:5120
    ds_read_b128 v[124:127], v14 offset:6144
    ds_read_b128 v[128:131], v14 offset:7168
    v_mov_b32 v14, 155660
    v_mov_b32 v15, 1
    s_waitcnt lgkmcnt(0)
    ds_write_b32 v14, v15
    s_nop 1
    v_add_f32_dpp v24, v24, v24 quad_perm:[1,0,3,2] row_mask:0xf bank_mask:0xf
    s_nop 1
    v_add_f32_dpp v24, v24, v24 quad_perm:[2,3,0,1] row_mask:0xf bank_mask:0xf
    s_nop 1
    v_add_f32_dpp v24, v24, v24 row_half_mirror row_mask:0xf bank_mask:0xf
    s_nop 1
    v_add_f32_dpp v25, v25, v25 quad_perm:[1,0,3,2] row_mask:0xf bank_mask:0xf
    s_nop 1
    v_add_f32_dpp v25, v25, v25 quad_perm:[2,3,0,1] row_mask:0xf bank_mask:0xf
    s_nop 1
    v_add_f32_dpp v25, v25, v25 row_half_mirror row_mask:0xf bank_mask:0xf
    v_cvt_pk_bf16_f32 v26, v25, v25
    v_lshlrev_b32 v26, 16, v26
    v_mul_f32 v26, 0xbfb8aa3b, v26
    v_exp_f32 v26, v26
    s_nop 0
    v_add_f32 v26, 1.0, v26
    v_rcp_f32 v26, v26
    s_nop 0
    v_cvt_pk_bf16_f32 v26, v26, v26
    v_lshlrev_b32 v26, 16, v26
    s_lshl_b32 s3, s65, 7
    s_lshl_b32 s4, s66, 3
    s_add_u32 s3, s3, s4
    v_lshrrev_b32 v27, 3, v166
    v_add_u32 v27, s3, v27
    v_lshlrev_b32 v14, 2, v27
    s_mov_b32 exec_lo, 0x01010101
    s_mov_b32 exec_hi, 0x01010101
    s_mov_b32 s5, 12582912
    buffer_store_dword v26, v14, s[48:51], s5 offen sc1
    s_mov_b64 exec, -1
    v_cvt_pk_bf16_f32 v15, v24, v24
    v_lshlrev_b32 v15, 16, v15
    v_ashrrev_i32 v16, 31, v15
    v_or_b32 v16, 0x80000000, v16
    v_and_b32 v16, 0xffff0000, v16
    v_xor_b32 v15, v15, v16
    v_sub_u32 v27, 2047, v27
    v_or_b32 v15, v15, v27
    s_nop 1
    v_readlane_b32 s3, v15, 0
    v_readlane_b32 s4, v15, 8
    s_nop 1
    s_max_u32 s3, s3, s4
    v_readlane_b32 s4, v15, 16
    s_nop 1
    s_max_u32 s3, s3, s4
    v_readlane_b32 s4, v15, 24
    s_nop 1
    s_max_u32 s3, s3, s4
    v_readlane_b32 s4, v15, 32
    s_nop 1
    s_max_u32 s3, s3, s4
    v_readlane_b32 s4, v15, 40
    s_nop 1
    s_max_u32 s3, s3, s4
    v_readlane_b32 s4, v15, 48
    s_nop 1
    s_max_u32 s3, s3, s4
    v_readlane_b32 s4, v15, 56
    s_nop 1
    s_max_u32 s3, s3, s4
    s_mov_b32 s71, s3
    s_waitcnt vmcnt(0)
    s_lshl_b32 s3, s2, 3
    s_add_u32 s3, s3, 12980224
    v_mov_b32 v14, 0
    v_mov_b32 v16, s71
    v_mov_b32 v17, s15
    s_mov_b64 exec, 1
    buffer_store_dwordx2 v[16:17], v14, s[48:51], s3 offen sc1
    s_mov_b64 exec, -1
    s_mov_b32 s96, 20
L_spin_114:
    ds_read_b32 v16, v38
    s_waitcnt lgkmcnt(0)
    v_cmp_gt_u32 vcc, 2, v16
    s_sub_u32 s96, s96, 1
    s_cmp_eq_u32 s96, 0
    s_cbranch_scc1 L_spind_115
    s_nop 2
    s_cbranch_vccz L_spind_115
    s_sleep 4
    s_branch L_spin_114
L_spind_115:
    s_bfe_u32 s5, s65, 0x20001
    s_lshl_b32 s5, s5, 2
    s_lshr_b32 s5, 0x0, s5
    s_and_b32 s5, s5, 15
    s_mul_i32 s6, s5, 8
    s_add_u32 s6, s6, 6
    s_mov_b32 s96, s6
L_spin_116:
    ds_read_b32 v16, v37
    s_waitcnt lgkmcnt(0)
    v_cmp_gt_u32 vcc, s5, v16
    s_sub_u32 s96, s96, 1
    s_cmp_eq_u32 s96, 0
    s_cbranch_scc1 L_spind_117
    s_nop 2
    s_cbranch_vccz L_spind_117
    s_sleep 4
    s_branch L_spin_116
L_spind_117:
    s_lshl_b32 s3, s66, 17
    s_lshl_b32 s4, s65, 13
    s_add_u32 s3, s3, s4
    s_add_u32 s3, s3, 31457280
    buffer_store_dwordx4 v[100:103], v165, s[48:51], s3 offen offset:0 sc1
    buffer_store_dwordx4 v[104:107], v165, s[48:51], s3 offen offset:1024 sc1
    buffer_store_dwordx4 v[108:111], v165, s[48:51], s3 offen offset:2048 sc1
    buffer_store_dwordx4 v[112:115], v165, s[48:51], s3 offen offset:3072 sc1
    s_add_u32 s3, s3, 4096
    buffer_store_dwordx4 v[116:119], v165, s[48:51], s3 offen offset:0 sc1
    buffer_store_dwordx4 v[120:123], v165, s[48:51], s3 offen offset:1024 sc1
    buffer_store_dwordx4 v[124:127], v165, s[48:51], s3 offen offset:2048 sc1
    buffer_store_dwordx4 v[128:131], v165, s[48:51], s3 offen offset:3072 sc1
    s_waitcnt vmcnt(0)
    v_mov_b32 v14, 155660
    v_mov_b32 v15, 2
    ds_write_b32 v14, v15
    s_mov_b32 s56, s26
    s_and_b32 s57, s27, 0xffff
    s_mov_b32 s58, 7340032
    s_mov_b32 s59, 0x20000
    s_mov_b32 s60, s28
    s_and_b32 s61, s29, 0xffff
    s_mov_b32 s62, 7340032
    s_mov_b32 s63, 0x20000
    s_mov_b32 s92, s30
    s_and_b32 s93, s31, 0xffff
    s_mov_b32 s94, 7340032
    s_mov_b32 s95, 0x20000
    s_cmp_ge_u32 s2, 224
    s_cselect_b32 s58, 0, s58
    s_cselect_b32 s62, 0, s62
    v_lshrrev_b32 v19, 3, v166
    s_movk_i32 s3, 7168
    v_mul_lo_u32 v18, v19, s3
    v_and_b32 v15, 7, v166
    v_bfe_u32 v14, v166, 4, 2
    v_lshlrev_b32 v14, 1, v14
    v_xor_b32 v15, v15, v14
    v_lshl_add_u32 v18, v15, 4, v18
    v_lshlrev_b32 v19, 11, v19
    v_lshl_add_u32 v19, v15, 4, v19
    v_lshrrev_b32 v17, 2, v166
    v_lshlrev_b32 v17, 7, v17
    v_and_b32 v15, 3, v166
    v_lshl_add_u32 v17, v15, 3, v17
    v_add_u32 v17, 143360, v17
    v_bfe_u32 v14, v166, 3, 2
    v_lshl_add_u32 v30, v14, 5, v17
    v_xor_b32 v31, 32, v30
    v_xor_b32 v32, 64, v30
    v_xor_b32 v33, 96, v30
    v_lshlrev_b32 v35, 2, v166
    v_add_u32 v35, 158208, v35
    v_lshlrev_b32 v34, 3, v166
    s_and_b32 s3, s2, 3
    s_lshl_b32 s3, s3, 8
    s_add_u32 s3, s3, 128
    s_mul_i32 s80, s3, 7168
    s_lshr_b32 s3, s2, 2
    s_lshl_b32 s3, s3, 7
    s_add_u32 s80, s80, s3
    s_lshr_b32 s3, s2, 4
    s_mul_i32 s3, s3, 224
    s_add_u32 s3, s3, 128
    s_lshl_b32 s81, s3, 11
    s_and_b32 s3, s2, 15
    s_lshl_b32 s3, s3, 7
    s_add_u32 s81, s81, s3
    s_bfe_u32 s5, s65, 0x20001
    s_lshl_b32 s5, s5, 2
    s_lshr_b32 s5, 0x6655, s5
    s_and_b32 s5, s5, 15
    s_mul_i32 s6, s5, 8
    s_add_u32 s6, s6, 6
    s_mov_b32 s96, s6
L_spin_118:
    ds_read_b32 v16, v37
    s_waitcnt lgkmcnt(0)
    v_cmp_gt_u32 vcc, s5, v16
    s_sub_u32 s96, s96, 1
    s_cmp_eq_u32 s96, 0
    s_cbranch_scc1 L_spind_119
    s_nop 2
    s_cbranch_vccz L_spind_119
    s_sleep 4
    s_branch L_spin_118
L_spind_119:
    s_mov_b32 s96, 1048576
L_spin_120:
    ds_read_b32 v16, v36
    s_waitcnt lgkmcnt(0)
    v_cmp_gt_u32 vcc, 1, v16
    s_sub_u32 s96, s96, 1
    s_cmp_eq_u32 s96, 0
    s_cbranch_scc1 L_spind_121
    s_nop 2
    s_cbranch_vccz L_spind_121
    s_sleep 4
    s_branch L_spin_120
L_spind_121:
    v_mov_b32 v14, 155660
    s_mov_b32 s96, 1048576
L_spin_122:
    ds_read_b32 v16, v14
    s_waitcnt lgkmcnt(0)
    v_cmp_gt_u32 vcc, 1, v16
    s_sub_u32 s96, s96, 1
    s_cmp_eq_u32 s96, 0
    s_cbranch_scc1 L_spind_123
    s_nop 2
    s_cbranch_vccz L_spind_123
    s_sleep 4
    s_branch L_spin_122
L_spind_123:
    s_add_u32 s3, s80, 0
    s_mov_b32 m0, 143360
    s_nop 0
    buffer_load_dwordx4 v18, s[56:59], s3 offen nt lds
    s_mov_b32 m0, 144384
    s_add_u32 s3, s3, 57344
    buffer_load_dwordx4 v18, s[56:59], s3 offen nt lds
    s_mov_b32 m0, 145408
    s_add_u32 s3, s3, 57344
    buffer_load_dwordx4 v18, s[56:59], s3 offen nt lds
    s_mov_b32 m0, 146432
    s_add_u32 s3, s3, 57344
    buffer_load_dwordx4 v18, s[56:59], s3 offen nt lds
    s_add_u32 s3, s80, 229376
    s_mov_b32 m0, 147456
    s_nop 0
    buffer_load_dwordx4 v18, s[56:59], s3 offen nt lds
    s_mov_b32 m0, 148480
    s_add_u32 s3, s3, 57344
    buffer_load_dwordx4 v18, s[56:59], s3 offen nt lds
    s_mov_b32 m0, 149504
    s_add_u32 s3, s3, 57344
    buffer_load_dwordx4 v18, s[56:59], s3 offen nt lds
    s_mov_b32 m0, 150528
    s_add_u32 s3, s3, 57344
    buffer_load_dwordx4 v18, s[56:59], s3 offen nt lds
    s_add_u32 s3, s80, 458752
    s_mov_b32 m0, 151552
    s_nop 0
    buffer_load_dwordx4 v18, s[56:59], s3 offen nt lds
    s_mov_b32 m0, 152576
    s_add_u32 s3, s3, 57344
    buffer_load_dwordx4 v18, s[56:59], s3 offen nt lds
    s_mov_b32 m0, 153600
    s_add_u32 s3, s3, 57344
    buffer_load_dwordx4 v18, s[56:59], s3 offen nt lds
    s_mov_b32 m0, 154624
    s_add_u32 s3, s3, 57344
    buffer_load_dwordx4 v18, s[56:59], s3 offen nt lds
    v_mov_b32 v14, 155668
    s_mov_b32 s96, 1048576
L_spin_124:
    ds_read_b32 v16, v14
    s_waitcnt lgkmcnt(0)
    v_cmp_gt_u32 vcc, 1, v16
    s_sub_u32 s96, s96, 1
    s_cmp_eq_u32 s96, 0
    s_cbranch_scc1 L_spind_125
    s_nop 2
    s_cbranch_vccz L_spind_125
    s_sleep 4
    s_branch L_spin_124
L_spind_125:
    v_mov_b32 v14, 155676
    ds_read_b32 v14, v14
    s_waitcnt vmcnt(0) lgkmcnt(0)
    v_readfirstlane_b32 s71, v14
    s_nop 1
    s_and_b32 s3, s71, 2047
    s_sub_u32 s70, 2047, s3
    v_lshrrev_b32 v15, 4, v166
    v_lshlrev_b32 v15, 3, v15
    s_and_b32 s3, s2, 3
    s_lshl_b32 s3, s3, 9
    s_add_u32 s3, s3, 256
    s_lshl_b32 s4, s70, 11
    s_add_u32 s3, s3, s4
    buffer_load_dwordx2 v[40:41], v15, s[40:43], s3 offen offset:0
    buffer_load_dwordx2 v[42:43], v15, s[40:43], s3 offen offset:32
    buffer_load_dwordx2 v[44:45], v15, s[40:43], s3 offen offset:64
    buffer_load_dwordx2 v[46:47], v15, s[40:43], s3 offen offset:96
    buffer_load_dwordx2 v[48:49], v15, s[40:43], s3 offen offset:128
    buffer_load_dwordx2 v[50:51], v15, s[40:43], s3 offen offset:160
    buffer_load_dwordx2 v[52:53], v15, s[40:43], s3 offen offset:192
    buffer_load_dwordx2 v[54:55], v15, s[40:43], s3 offen offset:224
    ds_read_b64_tr_b16 v[100:101], v30 offset:0
    ds_read_b64_tr_b16 v[102:103], v30 offset:2048
    ds_read_b64_tr_b16 v[104:105], v31 offset:0
    ds_read_b64_tr_b16 v[106:107], v31 offset:2048
    ds_read_b64_tr_b16 v[108:109], v32 offset:0
    ds_read_b64_tr_b16 v[110:111], v32 offset:2048
    ds_read_b64_tr_b16 v[112:113], v33 offset:0
    ds_read_b64_tr_b16 v[114:115], v33 offset:2048
    s_waitcnt lgkmcnt(0)
    ds_read_b64_tr_b16 v[116:117], v30 offset:4096
    ds_read_b64_tr_b16 v[118:119], v30 offset:6144
    ds_read_b64_tr_b16 v[120:121], v31 offset:4096
    ds_read_b64_tr_b16 v[122:123], v31 offset:6144
    ds_read_b64_tr_b16 v[124:125], v32 offset:4096
    ds_read_b64_tr_b16 v[126:127], v32 offset:6144
    ds_read_b64_tr_b16 v[128:129], v33 offset:4096
    ds_read_b64_tr_b16 v[130:131], v33 offset:6144
    s_waitcnt lgkmcnt(0)
    ds_read_b64_tr_b16 v[132:133], v30 offset:8192
    ds_read_b64_tr_b16 v[134:135], v30 offset:10240
    ds_read_b64_tr_b16 v[136:137], v31 offset:8192
    ds_read_b64_tr_b16 v[138:139], v31 offset:10240
    ds_read_b64_tr_b16 v[140:141], v32 offset:8192
    ds_read_b64_tr_b16 v[142:143], v32 offset:10240
    ds_read_b64_tr_b16 v[144:145], v33 offset:8192
    ds_read_b64_tr_b16 v[146:147], v33 offset:10240
    s_waitcnt lgkmcnt(0)
    s_bfe_u32 s5, s65, 0x20001
    s_lshl_b32 s5, s5, 2
    s_lshr_b32 s5, 0x7776, s5
    s_and_b32 s5, s5, 15
    s_mul_i32 s6, s5, 8
    s_add_u32 s6, s6, 6
    s_mov_b32 s96, s6
L_spin_126:
    ds_read_b32 v16, v37
    s_waitcnt lgkmcnt(0)
    v_cmp_gt_u32 vcc, s5, v16
    s_sub_u32 s96, s96, 1
    s_cmp_eq_u32 s96, 0
    s_cbranch_scc1 L_spind_127
    s_nop 2
    s_cbranch_vccz L_spind_127
    s_sleep 4
    s_branch L_spin_126
L_spind_127:
    s_add_u32 s3, s80, 688128
    s_mov_b32 m0, 143360
    s_nop 0
    buffer_load_dwordx4 v18, s[56:59], s3 offen nt lds
    s_mov_b32 m0, 144384
    s_add_u32 s3, s3, 57344
    buffer_load_dwordx4 v18, s[56:59], s3 offen nt lds
    s_mov_b32 m0, 145408
    s_add_u32 s3, s3, 57344
    buffer_load_dwordx4 v18, s[56:59], s3 offen nt lds
    s_mov_b32 m0, 146432
    s_add_u32 s3, s3, 57344
    buffer_load_dwordx4 v18, s[56:59], s3 offen nt lds
    s_add_u32 s3, s80, 0
    s_mov_b32 m0, 147456
    s_nop 0
    buffer_load_dwordx4 v18, s[60:63], s3 offen nt lds
    s_mov_b32 m0, 148480
    s_add_u32 s3, s3, 57344
    buffer_load_dwordx4 v18, s[60:63], s3 offen nt lds
    s_mov_b32 m0, 149504
    s_add_u32 s3, s3, 57344
    buffer_load_dwordx4 v18, s[60:63], s3 offen nt lds
    s_mov_b32 m0, 150528
    s_add_u32 s3, s3, 57344
    buffer_load_dwordx4 v18, s[60:63], s3 offen nt lds
    s_add_u32 s3, s80, 229376
    s_mov_b32 m0, 151552
    s_nop 0
    buffer_load_dwordx4 v18, s[60:63], s3 offen nt lds
    s_mov_b32 m0, 152576
    s_add_u32 s3, s3, 57344
    buffer_load_dwordx4 v18, s[60:63], s3 offen nt lds
    s_mov_b32 m0, 153600
    s_add_u32 s3, s3, 57344
    buffer_load_dwordx4 v18, s[60:63], s3 offen nt lds
    s_mov_b32 m0, 154624
    s_add_u32 s3, s3, 57344
    buffer_load_dwordx4 v18, s[60:63], s3 offen nt lds
    s_waitcnt vmcnt(12)
    s_setprio 0
    v_mfma_f32_16x16x32_bf16 v[72:75], v[40:43], v[100:103], 0
    v_mfma_f32_16x16x32_bf16 v[76:79], v[40:43], v[104:107], 0
    v_mfma_f32_16x16x32_bf16 v[80:83], v[40:43], v[108:111], 0
    v_mfma_f32_16x16x32_bf16 v[84:87], v[40:43], v[112:115], 0
    s_setprio 3
    s_setprio 0
    v_mfma_f32_16x16x32_bf16 v[72:75], v[44:47], v[116:119], v[72:75]
    v_mfma_f32_16x16x32_bf16 v[76:79], v[44:47], v[120:123], v[76:79]
    v_mfma_f32_16x16x32_bf16 v[80:83], v[44:47], v[124:127], v[80:83]
    v_mfma_f32_16x16x32_bf16 v[84:87], v[44:47], v[128:131], v[84:87]
    s_setprio 3
    s_setprio 0
    v_mfma_f32_16x16x32_bf16 v[72:75], v[48:51], v[132:135], v[72:75]
    v_mfma_f32_16x16x32_bf16 v[76:79], v[48:51], v[136:139], v[76:79]
    v_mfma_f32_16x16x32_bf16 v[80:83], v[48:51], v[140:143], v[80:83]
    v_mfma_f32_16x16x32_bf16 v[84:87], v[48:51], v[144:147], v[84:87]
    s_setprio 3
    s_waitcnt vmcnt(0)
    ds_read_b64_tr_b16 v[100:101], v30 offset:0
    ds_read_b64_tr_b16 v[102:103], v30 offset:2048
    ds_read_b64_tr_b16 v[104:105], v31 offset:0
    ds_read_b64_tr_b16 v[106:107], v31 offset:2048
    ds_read_b64_tr_b16 v[108:109], v32 offset:0
    ds_read_b64_tr_b16 v[110:111], v32 offset:2048
    ds_read_b64_tr_b16 v[112:113], v33 offset:0
    ds_read_b64_tr_b16 v[114:115], v33 offset:2048
    s_waitcnt lgkmcnt(0)
    ds_read_b64_tr_b16 v[116:117], v30 offset:4096
    ds_read_b64_tr_b16 v[118:119], v30 offset:6144
    ds_read_b64_tr_b16 v[120:121], v31 offset:4096
    ds_read_b64_tr_b16 v[122:123], v31 offset:6144
    ds_read_b64_tr_b16 v[124:125], v32 offset:4096
    ds_read_b64_tr_b16 v[126:127], v32 offset:6144
    ds_read_b64_tr_b16 v[128:129], v33 offset:4096
    ds_read_b64_tr_b16 v[130:131], v33 offset:6144
    s_waitcnt lgkmcnt(0)
    ds_read_b64_tr_b16 v[132:133], v30 offset:8192
    ds_read_b64_tr_b16 v[134:135], v30 offset:10240
    ds_read_b64_tr_b16 v[136:137], v31 offset:8192
    ds_read_b64_tr_b16 v[138:139], v31 offset:10240
    ds_read_b64_tr_b16 v[140:141], v32 offset:8192
    ds_read_b64_tr_b16 v[142:143], v32 offset:10240
    ds_read_b64_tr_b16 v[144:145], v33 offset:8192
    ds_read_b64_tr_b16 v[146:147], v33 offset:10240
    s_waitcnt lgkmcnt(0)
    s_bfe_u32 s5, s65, 0x20001
    s_lshl_b32 s5, s5, 2
    s_lshr_b32 s5, 0x9888, s5
    s_and_b32 s5, s5, 15
    s_mul_i32 s6, s5, 8
    s_add_u32 s6, s6, 6
    s_mov_b32 s96, s6
L_spin_128:
    ds_read_b32 v16, v37
    s_waitcnt lgkmcnt(0)
    v_cmp_gt_u32 vcc, s5, v16
    s_sub_u32 s96, s96, 1
    s_cmp_eq_u32 s96, 0
    s_cbranch_scc1 L_spind_129
    s_nop 2
    s_cbranch_vccz L_spind_129
    s_sleep 4
    s_branch L_spin_128
L_spind_129:
    s_add_u32 s3, s80, 458752
    s_mov_b32 m0, 143360
    s_nop 0
    buffer_load_dwordx4 v18, s[60:63], s3 offen nt lds
    s_mov_b32 m0, 144384
    s_add_u32 s3, s3, 57344
    buffer_load_dwordx4 v18, s[60:63], s3 offen nt lds
    s_mov_b32 m0, 145408
    s_add_u32 s3, s3, 57344
    buffer_load_dwordx4 v18, s[60:63], s3 offen nt lds
    s_mov_b32 m0, 146432
    s_add_u32 s3, s3, 57344
    buffer_load_dwordx4 v18, s[60:63], s3 offen nt lds
    s_add_u32 s3, s80, 688128
    s_mov_b32 m0, 147456
    s_nop 0
    buffer_load_dwordx4 v18, s[60:63], s3 offen nt lds
    s_mov_b32 m0, 148480
    s_add_u32 s3, s3, 57344
    buffer_load_dwordx4 v18, s[60:63], s3 offen nt lds
    s_mov_b32 m0, 149504
    s_add_u32 s3, s3, 57344
    buffer_load_dwordx4 v18, s[60:63], s3 offen nt lds
    s_mov_b32 m0, 150528
    s_add_u32 s3, s3, 57344
    buffer_load_dwordx4 v18, s[60:63], s3 offen nt lds
    s_add_u32 s3, s81, 0
    s_mov_b32 m0, 151552
    s_nop 0
    buffer_load_dwordx4 v19, s[92:95], s3 offen nt lds
    s_mov_b32 m0, 152576
    s_add_u32 s3, s3, 16384
    buffer_load_dwordx4 v19, s[92:95], s3 offen nt lds
    s_mov_b32 m0, 153600
    s_add_u32 s3, s3, 16384
    buffer_load_dwordx4 v19, s[92:95], s3 offen nt lds
    s_mov_b32 m0, 154624
    s_add_u32 s3, s3, 16384
    buffer_load_dwordx4 v19, s[92:95], s3 offen nt lds
    s_setprio 0
    v_mfma_f32_16x16x32_bf16 v[72:75], v[52:55], v[100:103], v[72:75]
    v_mfma_f32_16x16x32_bf16 v[76:79], v[52:55], v[104:107], v[76:79]
    v_mfma_f32_16x16x32_bf16 v[80:83], v[52:55], v[108:111], v[80:83]
    v_mfma_f32_16x16x32_bf16 v[84:87], v[52:55], v[112:115], v[84:87]
    s_setprio 3
    s_setprio 0
    v_mfma_f32_16x16x32_bf16 v[56:59], v[40:43], v[116:119], 0
    v_mfma_f32_16x16x32_bf16 v[60:63], v[40:43], v[120:123], 0
    v_mfma_f32_16x16x32_bf16 v[64:67], v[40:43], v[124:127], 0
    v_mfma_f32_16x16x32_bf16 v[68:71], v[40:43], v[128:131], 0
    s_setprio 3
    s_setprio 0
    v_mfma_f32_16x16x32_bf16 v[56:59], v[44:47], v[132:135], v[56:59]
    v_mfma_f32_16x16x32_bf16 v[60:63], v[44:47], v[136:139], v[60:63]
    v_mfma_f32_16x16x32_bf16 v[64:67], v[44:47], v[140:143], v[64:67]
    v_mfma_f32_16x16x32_bf16 v[68:71], v[44:47], v[144:147], v[68:71]
    s_setprio 3
    s_nop 7
    s_mov_b64 exec, 0xffff
    ds_write_b32 v35, v72 offset:512
    ds_write_b32 v35, v76 offset:576
    ds_write_b32 v35, v80 offset:640
    ds_write_b32 v35, v84 offset:704
    s_mov_b64 exec, -1
    s_waitcnt vmcnt(0)
    ds_read_b64_tr_b16 v[100:101], v30 offset:0
    ds_read_b64_tr_b16 v[102:103], v30 offset:2048
    ds_read_b64_tr_b16 v[104:105], v31 offset:0
    ds_read_b64_tr_b16 v[106:107], v31 offset:2048
    ds_read_b64_tr_b16 v[108:109], v32 offset:0
    ds_read_b64_tr_b16 v[110:111], v32 offset:2048
    ds_read_b64_tr_b16 v[112:113], v33 offset:0
    ds_read_b64_tr_b16 v[114:115], v33 offset:2048
    s_waitcnt lgkmcnt(0)
    ds_read_b64_tr_b16 v[116:117], v30 offset:4096
    ds_read_b64_tr_b16 v[118:119], v30 offset:6144
    ds_read_b64_tr_b16 v[120:121], v31 offset:4096
    ds_read_b64_tr_b16 v[122:123], v31 offset:6144
    ds_read_b64_tr_b16 v[124:125], v32 offset:4096
    ds_read_b64_tr_b16 v[126:127], v32 offset:6144
    ds_read_b64_tr_b16 v[128:129], v33 offset:4096
    ds_read_b64_tr_b16 v[130:131], v33 offset:6144
    s_waitcnt lgkmcnt(0)
    ds_read_b64_tr_b16 v[148:149], v30 offset:8192
    ds_read_b64_tr_b16 v[150:151], v30 offset:10240
    ds_read_b64_tr_b16 v[152:153], v31 offset:8192
    ds_read_b64_tr_b16 v[154:155], v31 offset:10240
    ds_read_b64_tr_b16 v[156:157], v32 offset:8192
    ds_read_b64_tr_b16 v[158:159], v32 offset:10240
    ds_read_b64_tr_b16 v[160:161], v33 offset:8192
    ds_read_b64_tr_b16 v[162:163], v33 offset:10240
    s_waitcnt lgkmcnt(0)
    s_setprio 0
    v_mfma_f32_16x16x32_bf16 v[56:59], v[48:51], v[100:103], v[56:59]
    v_mfma_f32_16x16x32_bf16 v[60:63], v[48:51], v[104:107], v[60:63]
    v_mfma_f32_16x16x32_bf16 v[64:67], v[48:51], v[108:111], v[64:67]
    v_mfma_f32_16x16x32_bf16 v[68:71], v[48:51], v[112:115], v[68:71]
    s_setprio 3
    s_setprio 0
    v_mfma_f32_16x16x32_bf16 v[56:59], v[52:55], v[116:119], v[56:59]
    v_mfma_f32_16x16x32_bf16 v[60:63], v[52:55], v[120:123], v[60:63]
    v_mfma_f32_16x16x32_bf16 v[64:67], v[52:55], v[124:127], v[64:67]
    v_mfma_f32_16x16x32_bf16 v[68:71], v[52:55], v[128:131], v[68:71]
    s_setprio 3
    s_nop 7
    s_mov_b64 exec, 0xffff
    ds_write_b32 v35, v56 offset:768
    ds_write_b32 v35, v60 offset:832
    ds_write_b32 v35, v64 offset:896
    ds_write_b32 v35, v68 offset:960
    s_mov_b64 exec, -1
    s_waitcnt lgkmcnt(0)
    v_mov_b32 v14, 155652
    v_mov_b32 v15, 1
    s_mov_b64 exec, 1
    ds_add_rtn_u32 v16, v14, v15
    s_waitcnt lgkmcnt(0)
    s_mov_b64 exec, -1
    v_readfirstlane_b32 s3, v16
    s_nop 1
    s_cmp_lg_u32 s3, 1
    s_cbranch_scc1 L_last_130
    s_cmp_ge_u32 s2, 224
    s_cbranch_scc1 L_skip_131
    ds_read_b32 v92, v35
    ds_read_b32 v94, v35 offset:256
    ds_read_b32 v96, v35 offset:512
    ds_read_b32 v97, v35 offset:768
    v_mov_b32 v93, s15
    v_mov_b32 v95, s15
    s_waitcnt lgkmcnt(0)
    v_add_f32 v92, v92, v96
    v_add_f32 v94, v94, v97
    s_and_b32 s3, s2, 3
    s_mul_i32 s3, s3, 57344
    s_lshr_b32 s4, s2, 2
    s_lshl_b32 s4, s4, 9
    s_add_u32 s3, s3, s4
    s_add_u32 s3, s3, 12599296
    s_add_u32 s4, s3, 28672
    buffer_store_dwordx2 v[92:93], v34, s[48:51], s3 offen sc1
    buffer_store_dwordx2 v[94:95], v34, s[48:51], s4 offen sc1
L_skip_131:
L_last_130:
    s_bfe_u32 s5, s65, 0x20001
    s_lshl_b32 s5, s5, 2
    s_lshr_b32 s5, 0xaa99, s5
    s_and_b32 s5, s5, 15
    s_mul_i32 s6, s5, 8
    s_add_u32 s6, s6, 6
    s_mov_b32 s96, s6
L_spin_132:
    ds_read_b32 v16, v37
    s_waitcnt lgkmcnt(0)
    v_cmp_gt_u32 vcc, s5, v16
    s_sub_u32 s96, s96, 1
    s_cmp_eq_u32 s96, 0
    s_cbranch_scc1 L_spind_133
    s_nop 2
    s_cbranch_vccz L_spind_133
    s_sleep 4
    s_branch L_spin_132
L_spind_133:
    s_add_u32 s3, s81, 65536
    s_mov_b32 m0, 143360
    s_nop 0
    buffer_load_dwordx4 v19, s[92:95], s3 offen nt lds
    s_mov_b32 m0, 144384
    s_add_u32 s3, s3, 16384
    buffer_load_dwordx4 v19, s[92:95], s3 offen nt lds
    s_mov_b32 m0, 145408
    s_add_u32 s3, s3, 16384
    buffer_load_dwordx4 v19, s[92:95], s3 offen nt lds
    s_mov_b32 m0, 146432
    s_add_u32 s3, s3, 16384
    buffer_load_dwordx4 v19, s[92:95], s3 offen nt lds
    s_add_u32 s3, s81, 131072
    s_mov_b32 m0, 147456
    s_nop 0
    buffer_load_dwordx4 v19, s[92:95], s3 offen nt lds
    s_mov_b32 m0, 148480
    s_add_u32 s3, s3, 16384
    buffer_load_dwordx4 v19, s[92:95], s3 offen nt lds
    s_mov_b32 m0, 149504
    s_add_u32 s3, s3, 16384
    buffer_load_dwordx4 v19, s[92:95], s3 offen nt lds
    s_mov_b32 m0, 150528
    s_add_u32 s3, s3, 16384
    buffer_load_dwordx4 v19, s[92:95], s3 offen nt lds
    s_waitcnt vmcnt(0)
    ds_read_b64_tr_b16 v[100:101], v30 offset:0
    ds_read_b64_tr_b16 v[102:103], v30 offset:2048
    ds_read_b64_tr_b16 v[104:105], v31 offset:0
    ds_read_b64_tr_b16 v[106:107], v31 offset:2048
    ds_read_b64_tr_b16 v[108:109], v32 offset:0
    ds_read_b64_tr_b16 v[110:111], v32 offset:2048
    ds_read_b64_tr_b16 v[112:113], v33 offset:0
    ds_read_b64_tr_b16 v[114:115], v33 offset:2048
    s_waitcnt lgkmcnt(0)
    ds_read_b64_tr_b16 v[116:117], v30 offset:4096
    ds_read_b64_tr_b16 v[118:119], v30 offset:6144
    ds_read_b64_tr_b16 v[120:121], v31 offset:4096
    ds_read_b64_tr_b16 v[122:123], v31 offset:6144
    ds_read_b64_tr_b16 v[124:125], v32 offset:4096
    ds_read_b64_tr_b16 v[126:127], v32 offset:6144
    ds_read_b64_tr_b16 v[128:129], v33 offset:4096
    ds_read_b64_tr_b16 v[130:131], v33 offset:6144
    s_waitcnt lgkmcnt(0)
    s_mov_b32 s96, 1048576
L_spin_134:
    ds_read_b32 v16, v37
    s_waitcnt lgkmcnt(0)
    v_cmp_gt_u32 vcc, 11, v16
    s_sub_u32 s96, s96, 1
    s_cmp_eq_u32 s96, 0
    s_cbranch_scc1 L_spind_135
    s_nop 2
    s_cbranch_vccz L_spind_135
    s_sleep 8
    s_branch L_spin_134
L_spind_135:
    s_lshr_b32 s3, s2, 4
    s_mul_i32 s3, s3, 224
    s_add_u32 s3, s3, 128
    s_lshl_b32 s3, s3, 3
    v_min_u32 v14, 47, v166
    v_lshlrev_b32 v14, 4, v14
    v_add_u32 v14, s3, v14
    s_mov_b32 s96, 65536
L_poll_136:
    s_mov_b32 s5, 12599296
    buffer_load_dwordx4 v[56:59], v14, s[48:51], s5 offen sc1
    s_mov_b32 s5, 12627968
    buffer_load_dwordx4 v[60:63], v14, s[48:51], s5 offen sc1
    s_mov_b32 s5, 12656640
    buffer_load_dwordx4 v[64:67], v14, s[48:51], s5 offen sc1
    s_mov_b32 s5, 12685312
    buffer_load_dwordx4 v[68:71], v14, s[48:51], s5 offen sc1
    s_mov_b32 s5, 12713984
    buffer_load_dwordx4 v[72:75], v14, s[48:51], s5 offen sc1
    s_mov_b32 s5, 12742656
    buffer_load_dwordx4 v[76:79], v14, s[48:51], s5 offen sc1
    s_mov_b32 s5, 12771328
    buffer_load_dwordx4 v[80:83], v14, s[48:51], s5 offen sc1
    s_mov_b32 s5, 12800000
    buffer_load_dwordx4 v[84:87], v14, s[48:51], s5 offen sc1
    s_waitcnt vmcnt(0)
    v_min3_u32 v16, v57, v59, v61
    v_max3_u32 v17, v57, v59, v61
    v_min3_u32 v16, v16, v63, v65
    v_max3_u32 v17, v17, v63, v65
    v_min3_u32 v16, v16, v67, v69
    v_max3_u32 v17, v17, v67, v69
    v_min3_u32 v16, v16, v71, v73
    v_max3_u32 v17, v17, v71, v73
    v_min3_u32 v16, v16, v75, v77
    v_max3_u32 v17, v17, v75, v77
    v_min3_u32 v16, v16, v79, v81
    v_max3_u32 v17, v17, v79, v81
    v_min3_u32 v16, v16, v83, v85
    v_max3_u32 v17, v17, v83, v85
    v_min_u32 v16, v16, v87
    v_max_u32 v17, v17, v87
    v_cmp_ne_u32 vcc, s15, v16
    v_cmp_ne_u32 s[6:7], s15, v17
    s_nop 3
    s_or_b64 vcc, vcc, s[6:7]
    s_sub_u32 s96, s96, 1
    s_cmp_eq_u32 s96, 0
    s_cbranch_scc1 L_polld_137
    s_nop 2
    s_cbranch_vccz L_polld_137
    s_sleep 24
    s_branch L_poll_136
L_polld_137:
    v_add_f32 v88, v56, v64
    v_add_f32 v92, v72, v80
    v_add_f32 v88, v88, v92
    v_add_f32 v89, v58, v66
    v_add_f32 v93, v74, v82
    v_add_f32 v89, v89, v93
    v_add_f32 v90, v60, v68
    v_add_f32 v94, v76, v84
    v_add_f32 v90, v90, v94
    v_add_f32 v91, v62, v70
    v_add_f32 v95, v78, v86
    v_add_f32 v91, v91, v95
    v_cvt_pk_bf16_f32 v92, v88, v89
    v_cvt_pk_bf16_f32 v93, v90, v91
    v_lshlrev_b32 v88, 16, v92
    v_and_b32 v89, 0xffff0000, v92
    v_lshlrev_b32 v90, 16, v93
    v_and_b32 v91, 0xffff0000, v93
    v_mul_f32 v92, 0xbfb8aa3b, v88
    v_mul_f32 v93, 0xbfb8aa3b, v89
    v_exp_f32 v92, v92
    v_exp_f32 v93, v93
    s_nop 0
    v_add_f32 v92, 1.0, v92
    v_add_f32 v93, 1.0, v93
    v_rcp_f32 v92, v92
    v_rcp_f32 v93, v93
    s_nop 0
    v_mul_f32 v92, v88, v92
    v_mul_f32 v93, v89, v93
    v_cvt_pk_bf16_f32 v92, v92, v93
    v_lshlrev_b32 v88, 16, v92
    v_and_b32 v89, 0xffff0000, v92
    v_mul_f32 v88, v88, v90
    v_mul_f32 v89, v89, v91
    v_cvt_pk_bf16_f32 v90, v88, v89
    v_lshlrev_b32 v14, 2, v166
    v_add_u32 v14, 160512, v14
    ds_write_b32 v14, v90
    v_lshrrev_b32 v15, 4, v166
    v_lshlrev_b32 v15, 3, v15
    v_add_u32 v15, 160512, v15
    s_waitcnt lgkmcnt(0)
    ds_read_b64 v[40:41], v15 offset:0
    ds_read_b64 v[42:43], v15 offset:32
    ds_read_b64 v[44:45], v15 offset:64
    ds_read_b64 v[46:47], v15 offset:96
    ds_read_b64 v[48:49], v15 offset:128
    ds_read_b64 v[50:51], v15 offset:160
    s_waitcnt lgkmcnt(0)
    s_setprio 0
    v_mfma_f32_16x16x32_bf16 v[72:75], v[40:43], v[148:151], 0
    v_mfma_f32_16x16x32_bf16 v[76:79], v[40:43], v[152:155], 0
    v_mfma_f32_16x16x32_bf16 v[80:83], v[40:43], v[156:159], 0
    v_mfma_f32_16x16x32_bf16 v[84:87], v[40:43], v[160:163], 0
    s_setprio 3
    s_setprio 0
    v_mfma_f32_16x16x32_bf16 v[72:75], v[44:47], v[100:103], v[72:75]
    v_mfma_f32_16x16x32_bf16 v[76:79], v[44:47], v[104:107], v[76:79]
    v_mfma_f32_16x16x32_bf16 v[80:83], v[44:47], v[108:111], v[80:83]
    v_mfma_f32_16x16x32_bf16 v[84:87], v[44:47], v[112:115], v[84:87]
    s_setprio 3
    s_setprio 0
    v_mfma_f32_16x16x32_bf16 v[72:75], v[48:51], v[116:119], v[72:75]
    v_mfma_f32_16x16x32_bf16 v[76:79], v[48:51], v[120:123], v[76:79]
    v_mfma_f32_16x16x32_bf16 v[80:83], v[48:51], v[124:127], v[80:83]
    v_mfma_f32_16x16x32_bf16 v[84:87], v[48:51], v[128:131], v[84:87]
    s_setprio 3
    s_nop 7
    s_mov_b64 exec, 0xffff
    ds_write_b32 v35, v72 offset:1792
    ds_write_b32 v35, v76 offset:1856
    ds_write_b32 v35, v80 offset:1920
    ds_write_b32 v35, v84 offset:1984
    s_mov_b64 exec, -1
    s_waitcnt lgkmcnt(0)
    v_mov_b32 v14, 155656
    v_mov_b32 v15, 1
    s_mov_b64 exec, 1
    ds_add_rtn_u32 v16, v14, v15
    s_waitcnt lgkmcnt(0)
    s_mov_b64 exec, -1
    v_readfirstlane_b32 s3, v16
    s_nop 1
    s_cmp_lg_u32 s3, 1
    s_cbranch_scc1 L_last_138
    ds_read_b32 v92, v35 offset:1536
    ds_read_b32 v94, v35 offset:1792
    v_mov_b32 v93, s15
    s_waitcnt lgkmcnt(0)
    v_add_f32 v92, v92, v94
    s_lshr_b32 s3, s2, 4
    s_lshl_b32 s3, s3, 13
    s_and_b32 s4, s2, 15
    s_lshl_b32 s4, s4, 9
    s_add_u32 s3, s3, s4
    s_add_u32 s3, s3, 12845056
    buffer_store_dwordx2 v[92:93], v34, s[48:51], s3 offen sc1
L_last_138:
    s_endpgm
L_groupa:
    s_waitcnt lgkmcnt(0)
    s_mov_b32 s40, s16
    s_and_b32 s41, s17, 0xffff
    s_mov_b32 s42, 4194304
    s_mov_b32 s43, 0x20000
    s_mov_b32 s44, s18
    s_and_b32 s45, s19, 0xffff
    s_mov_b32 s46, 6291456
    s_mov_b32 s47, 0x20000
    s_mov_b32 s48, s38
    s_and_b32 s49, s39, 0xffff
    s_mov_b32 s50, 33554432
    s_mov_b32 s51, 0x20000
    s_mov_b32 s52, s36
    s_and_b32 s53, s37, 0xffff
    s_mov_b32 s54, 256
    s_mov_b32 s55, 0x20000
    v_mov_b32 v166, v0
    v_lshlrev_b32 v165, 4, v0
    s_and_b32 s67, s64, 1
    s_lshl_b32 s3, s2, 4
    s_add_u32 s3, s3, s64
    s_cmp_lg_u32 s3, 1
    s_cbranch_scc1 L_tag_139
    s_memrealtime s[4:5]
    s_waitcnt lgkmcnt(0)
    s_and_b32 s4, s4, 0x7ffffff0
    s_or_b32 s4, s4, 0x80000000
    v_mov_b32 v141, 0
    v_mov_b32 v142, s4
    s_mov_b64 exec, 1
    buffer_store_dword v142, v141, s[52:55], 0 offen sc1
    s_mov_b64 exec, -1
L_tag_139:
    v_and_b32 v155, 15, v0
    v_lshrrev_b32 v156, 4, v0
    v_lshrrev_b32 v157, 1, v155
    v_xor_b32 v157, v157, v156
    v_lshlrev_b32 v157, 4, v157
    v_lshl_add_u32 v157, v155, 7, v157
    s_lshr_b32 s3, s64, 1
    s_lshl_b32 s3, s3, 13
    v_add_u32 v152, s3, v157
    v_xor_b32 v153, 64, v152
    v_lshrrev_b32 v157, 2, v155
    v_lshl_add_u32 v157, v156, 3, v157
    v_lshlrev_b32 v157, 7, v157
    v_and_b32 v158, 3, v0
    v_lshl_add_u32 v157, v158, 3, v157
    v_bfe_u32 v158, v0, 3, 1
    v_lshl_add_u32 v157, v158, 5, v157
    v_bfe_u32 v158, v0, 4, 1
    v_xor_b32 v158, s67, v158
    v_lshl_add_u32 v154, v158, 6, v157
    v_xor_b32 v155, 32, v154
    v_mov_b32 v163, 155680
    s_lshl_b32 s4, s64, 8
    s_add_u32 s4, s4, 155904
    v_lshl_add_u32 v164, v166, 2, s4
    v_and_b32 v156, 1, v166
    v_mov_b32 v157, 0x44444444
    v_mov_b32 v158, 0xeeeeeeee
    v_cmp_eq_u32 vcc, 0, v156
    s_nop 1
    v_cndmask_b32 v162, v158, v157, vcc
    v_and_b32 v156, 2, v166
    v_bfe_u32 v157, v166, 2, 1
    v_mov_b32 v158, 0x3f803f80
    v_cmp_eq_u32 vcc, 0, v156
    s_nop 1
    v_cndmask_b32 v160, 0, v158, vcc
    v_cmp_eq_u32 vcc, 0, v157
    s_nop 1
    v_cndmask_b32 v161, 0, v160, vcc
    v_mov_b32 v0, 0
    v_mov_b32 v1, 0
    v_mov_b32 v2, 0
    v_mov_b32 v3, 0
    v_mov_b32 v4, 0
    v_mov_b32 v5, 0
    v_mov_b32 v6, 0
    v_mov_b32 v7, 0
    v_mov_b32 v8, 0
    v_mov_b32 v9, 0
    v_mov_b32 v10, 0
    v_mov_b32 v11, 0
    v_mov_b32 v12, 0
    v_mov_b32 v13, 0
    v_mov_b32 v14, 0
    v_mov_b32 v15, 0
    v_mov_b32 v16, 0
    v_mov_b32 v17, 0
    v_mov_b32 v18, 0
    v_mov_b32 v19, 0
    v_mov_b32 v20, 0
    v_mov_b32 v21, 0
    v_mov_b32 v22, 0
    v_mov_b32 v23, 0
    v_mov_b32 v24, 0
    v_mov_b32 v25, 0
    v_mov_b32 v26, 0
    v_mov_b32 v27, 0
    v_mov_b32 v28, 0
    v_mov_b32 v29, 0
    v_mov_b32 v30, 0
    v_mov_b32 v31, 0
    v_mov_b32 v32, 0
    v_mov_b32 v33, 0
    v_mov_b32 v34, 0
    v_mov_b32 v35, 0
    v_mov_b32 v36, 0
    v_mov_b32 v37, 0
    v_mov_b32 v38, 0
    v_mov_b32 v39, 0
    v_mov_b32 v40, 0
    v_mov_b32 v41, 0
    v_mov_b32 v42, 0
    v_mov_b32 v43, 0
    v_mov_b32 v44, 0
    v_mov_b32 v45, 0
    v_mov_b32 v46, 0
    v_mov_b32 v47, 0
    v_mov_b32 v48, 0
    v_mov_b32 v49, 0
    v_mov_b32 v50, 0
    v_mov_b32 v51, 0
    v_mov_b32 v52, 0
    v_mov_b32 v53, 0
    v_mov_b32 v54, 0
    v_mov_b32 v55, 0
    v_mov_b32 v56, 0
    v_mov_b32 v57, 0
    v_mov_b32 v58, 0
    v_mov_b32 v59, 0
    v_mov_b32 v60, 0
    v_mov_b32 v61, 0
    v_mov_b32 v62, 0
    v_mov_b32 v63, 0
    v_mov_b32 v64, 0
    v_mov_b32 v65, 0
    v_mov_b32 v66, 0
    v_mov_b32 v67, 0
    v_mov_b32 v68, 0
    v_mov_b32 v69, 0
    v_mov_b32 v70, 0
    v_mov_b32 v71, 0
    v_mov_b32 v72, 0
    v_mov_b32 v73, 0
    v_mov_b32 v74, 0
    v_mov_b32 v75, 0
    v_mov_b32 v76, 0
    v_mov_b32 v77, 0
    v_mov_b32 v78, 0
    v_mov_b32 v79, 0
    v_mov_b32 v80, 0
    v_mov_b32 v81, 0
    v_mov_b32 v82, 0
    v_mov_b32 v83, 0
    v_mov_b32 v84, 0
    v_mov_b32 v85, 0
    v_mov_b32 v86, 0
    v_mov_b32 v87, 0
    v_mov_b32 v88, 0
    v_mov_b32 v89, 0
    v_mov_b32 v90, 0
    v_mov_b32 v91, 0
    v_mov_b32 v92, 0
    v_mov_b32 v93, 0
    v_mov_b32 v94, 0
    v_mov_b32 v95, 0
    s_mov_b32 s74, 16
    s_mov_b32 s75, 0
    s_mov_b32 s77, 4294844416
    s_mov_b32 s78, 40960
    s_barrier
    ds_read_b64_tr_b16 v[128:129], v154 offset:16384
    ds_read_b64_tr_b16 v[130:131], v154 offset:16896
    ds_read_b128 v[96:99], v152 offset:0
    ds_read_b128 v[100:103], v152 offset:2048
    ds_read_b128 v[104:107], v152 offset:4096
    ds_read_b128 v[108:111], v152 offset:6144
    ds_read_b64_tr_b16 v[132:133], v155 offset:16384
    ds_read_b64_tr_b16 v[134:135], v155 offset:16896
    ds_read_b64_tr_b16 v[136:137], v154 offset:24576
    ds_read_b64_tr_b16 v[138:139], v154 offset:25088
    ds_read_b64_tr_b16 v[140:141], v155 offset:24576
    ds_read_b64_tr_b16 v[142:143], v155 offset:25088
    ds_read_b64_tr_b16 v[144:145], v154 offset:32768
    ds_read_b64_tr_b16 v[146:147], v154 offset:33280
.p2align 6
L_g1loop:
    s_waitcnt lgkmcnt(11)
    v_mfma_f32_16x16x32_bf16 v[0:3], v[128:131], v[96:99], v[0:3]
    ds_read_b64_tr_b16 v[148:149], v155 offset:32768
    s_waitcnt lgkmcnt(11)
    v_mfma_f32_16x16x32_bf16 v[8:11], v[128:131], v[100:103], v[8:11]
    ds_read_b64_tr_b16 v[150:151], v155 offset:33280
    s_waitcnt lgkmcnt(11)
    v_mfma_f32_16x16x32_bf16 v[16:19], v[128:131], v[104:107], v[16:19]
    ds_read_b128 v[112:115], v153 offset:0
    s_waitcnt lgkmcnt(11)
    v_mfma_f32_16x16x32_bf16 v[24:27], v[128:131], v[108:111], v[24:27]
    s_add_u32 s75, s75, 1
    s_waitcnt lgkmcnt(9)
    v_mfma_f32_16x16x32_bf16 v[4:7], v[132:135], v[96:99], v[4:7]
    ds_read_b64_tr_b16 v[128:129], v154 offset:20480
    v_mfma_f32_16x16x32_bf16 v[12:15], v[132:135], v[100:103], v[12:15]
    ds_read_b64_tr_b16 v[130:131], v154 offset:20992
    v_mfma_f32_16x16x32_bf16 v[20:23], v[132:135], v[104:107], v[20:23]
    ds_read_b128 v[116:119], v153 offset:2048
    v_mfma_f32_16x16x32_bf16 v[28:31], v[132:135], v[108:111], v[28:31]
    s_cmp_eq_u32 s75, 4
    s_waitcnt lgkmcnt(10)
    v_mfma_f32_16x16x32_bf16 v[32:35], v[136:139], v[96:99], v[32:35]
    ds_read_b64_tr_b16 v[132:133], v155 offset:20480
    v_mfma_f32_16x16x32_bf16 v[40:43], v[136:139], v[100:103], v[40:43]
    ds_read_b64_tr_b16 v[134:135], v155 offset:20992
    v_mfma_f32_16x16x32_bf16 v[48:51], v[136:139], v[104:107], v[48:51]
    ds_read_b128 v[120:123], v153 offset:4096
    v_mfma_f32_16x16x32_bf16 v[56:59], v[136:139], v[108:111], v[56:59]
    s_cselect_b32 s76, s77, s78
    s_waitcnt lgkmcnt(11)
    v_mfma_f32_16x16x32_bf16 v[36:39], v[140:143], v[96:99], v[36:39]
    ds_read_b64_tr_b16 v[136:137], v154 offset:28672
    v_mfma_f32_16x16x32_bf16 v[44:47], v[140:143], v[100:103], v[44:47]
    ds_read_b64_tr_b16 v[138:139], v154 offset:29184
    v_mfma_f32_16x16x32_bf16 v[52:55], v[140:143], v[104:107], v[52:55]
    ds_read_b128 v[124:127], v153 offset:6144
    v_mfma_f32_16x16x32_bf16 v[60:63], v[140:143], v[108:111], v[60:63]
    s_cselect_b32 s75, 0, s75
    s_waitcnt lgkmcnt(12)
    v_mfma_f32_16x16x32_bf16 v[64:67], v[96:99], v[144:147], v[64:67]
    ds_read_b64_tr_b16 v[140:141], v155 offset:28672
    v_mfma_f32_16x16x32_bf16 v[72:75], v[100:103], v[144:147], v[72:75]
    ds_read_b64_tr_b16 v[142:143], v155 offset:29184
    v_mfma_f32_16x16x32_bf16 v[80:83], v[104:107], v[144:147], v[80:83]
    v_add_u32 v152, s76, v152
    v_mfma_f32_16x16x32_bf16 v[88:91], v[108:111], v[144:147], v[88:91]
    s_sub_u32 s74, s74, 1
    s_waitcnt lgkmcnt(12)
    v_mfma_f32_16x16x32_bf16 v[68:71], v[96:99], v[148:151], v[68:71]
    ds_read_b64_tr_b16 v[144:145], v154 offset:36864
    v_mfma_f32_16x16x32_bf16 v[76:79], v[100:103], v[148:151], v[76:79]
    ds_read_b64_tr_b16 v[146:147], v154 offset:37376
    v_mfma_f32_16x16x32_bf16 v[84:87], v[104:107], v[148:151], v[84:87]
    v_mfma_f32_16x16x32_bf16 v[92:95], v[108:111], v[148:151], v[92:95]
    s_waitcnt lgkmcnt(11)
    v_mfma_f32_16x16x32_bf16 v[0:3], v[128:131], v[112:115], v[0:3]
    ds_read_b64_tr_b16 v[148:149], v155 offset:36864
    s_waitcnt lgkmcnt(11)
    v_mfma_f32_16x16x32_bf16 v[8:11], v[128:131], v[116:119], v[8:11]
    ds_read_b64_tr_b16 v[150:151], v155 offset:37376
    s_waitcnt lgkmcnt(9)
    v_mfma_f32_16x16x32_bf16 v[16:19], v[128:131], v[120:123], v[16:19]
    v_add_u32 v153, s76, v153
    s_waitcnt lgkmcnt(6)
    v_mfma_f32_16x16x32_bf16 v[24:27], v[128:131], v[124:127], v[24:27]
    v_add_u32 v154, s76, v154
    v_mfma_f32_16x16x32_bf16 v[4:7], v[132:135], v[112:115], v[4:7]
    v_add_u32 v155, s76, v155
    v_mfma_f32_16x16x32_bf16 v[12:15], v[132:135], v[116:119], v[12:15]
    v_mfma_f32_16x16x32_bf16 v[20:23], v[132:135], v[120:123], v[20:23]
    v_mfma_f32_16x16x32_bf16 v[28:31], v[132:135], v[124:127], v[28:31]
    s_waitcnt lgkmcnt(0)
    s_barrier
    v_mfma_f32_16x16x32_bf16 v[32:35], v[136:139], v[112:115], v[32:35]
    ds_read_b64_tr_b16 v[128:129], v154 offset:16384
    v_mfma_f32_16x16x32_bf16 v[40:43], v[136:139], v[116:119], v[40:43]
    ds_read_b64_tr_b16 v[130:131], v154 offset:16896
    v_mfma_f32_16x16x32_bf16 v[48:51], v[136:139], v[120:123], v[48:51]
    ds_read_b128 v[96:99], v152 offset:0
    v_mfma_f32_16x16x32_bf16 v[56:59], v[136:139], v[124:127], v[56:59]
    ds_read_b128 v[100:103], v152 offset:2048
    v_mfma_f32_16x16x32_bf16 v[36:39], v[140:143], v[112:115], v[36:39]
    ds_read_b128 v[104:107], v152 offset:4096
    v_mfma_f32_16x16x32_bf16 v[44:47], v[140:143], v[116:119], v[44:47]
    ds_read_b128 v[108:111], v152 offset:6144
    v_mfma_f32_16x16x32_bf16 v[52:55], v[140:143], v[120:123], v[52:55]
    ds_read_b64_tr_b16 v[132:133], v155 offset:16384
    v_mfma_f32_16x16x32_bf16 v[60:63], v[140:143], v[124:127], v[60:63]
    ds_read_b64_tr_b16 v[134:135], v155 offset:16896
    v_mfma_f32_16x16x32_bf16 v[64:67], v[112:115], v[144:147], v[64:67]
    ds_read_b64_tr_b16 v[136:137], v154 offset:24576
    v_mfma_f32_16x16x32_bf16 v[72:75], v[116:119], v[144:147], v[72:75]
    ds_read_b64_tr_b16 v[138:139], v154 offset:25088
    v_mfma_f32_16x16x32_bf16 v[80:83], v[120:123], v[144:147], v[80:83]
    ds_read_b64_tr_b16 v[140:141], v155 offset:24576
    v_mfma_f32_16x16x32_bf16 v[88:91], v[124:127], v[144:147], v[88:91]
    ds_read_b64_tr_b16 v[142:143], v155 offset:25088
    v_mfma_f32_16x16x32_bf16 v[68:71], v[112:115], v[148:151], v[68:71]
    ds_read_b64_tr_b16 v[144:145], v154 offset:32768
    v_mfma_f32_16x16x32_bf16 v[76:79], v[116:119], v[148:151], v[76:79]
    ds_read_b64_tr_b16 v[146:147], v154 offset:33280
    v_mfma_f32_16x16x32_bf16 v[84:87], v[120:123], v[148:151], v[84:87]
    s_cmp_lg_u32 s74, 0
    v_mfma_f32_16x16x32_bf16 v[92:95], v[124:127], v[148:151], v[92:95]
    s_cbranch_scc1 L_g1loop
    v_mov_b32 v156, 98304
    ds_read_b32 v156, v156
    s_getreg_b32 s73, hwreg(HW_REG_XCC_ID, 0, 4)
    s_lshr_b32 s4, s64, 1
    s_lshl_b32 s4, s4, 13
    s_lshl_b32 s3, s67, 14
    s_add_u32 s3, s3, s4
    s_lshl_b32 s5, s66, 19
    s_lshl_b32 s6, s65, 15
    s_add_u32 s5, s5, s6
    s_lshr_b32 s8, s5, 2
    s_add_u32 s5, s5, s3
    s_add_u32 s5, s5, 20971520
    s_add_u32 s6, s5, 4096
    s_lshr_b32 s9, s4, 1
    s_add_u32 s8, s8, s9
    s_add_u32 s8, s8, 29360128
    s_xor_b32 s7, s65, s67
    s_bitcmp1_b32 s7, 0
    s_cselect_b32 s7, 114688, 0
    s_cselect_b32 s8, s8, 0x7f000000
    s_cselect_b32 s10, 8192, 0
    s_add_u32 s7, s7, s4
    s_add_u32 s9, s9, s10
    s_add_u32 s9, s9, 131072
    s_mov_b32 s3, 1048744942
    v_pk_mul_f32 v[0:1], v[0:1], s[2:3] op_sel:[0,1] op_sel_hi:[1,1]
    v_pk_mul_f32 v[2:3], v[2:3], s[2:3] op_sel:[0,1] op_sel_hi:[1,1]
    v_pk_mul_f32 v[4:5], v[4:5], s[2:3] op_sel:[0,1] op_sel_hi:[1,1]
    v_pk_mul_f32 v[6:7], v[6:7], s[2:3] op_sel:[0,1] op_sel_hi:[1,1]
    v_pk_mul_f32 v[8:9], v[8:9], s[2:3] op_sel:[0,1] op_sel_hi:[1,1]
    v_pk_mul_f32 v[10:11], v[10:11], s[2:3] op_sel:[0,1] op_sel_hi:[1,1]
    v_pk_mul_f32 v[12:13], v[12:13], s[2:3] op_sel:[0,1] op_sel_hi:[1,1]
    v_pk_mul_f32 v[14:15], v[14:15], s[2:3] op_sel:[0,1] op_sel_hi:[1,1]
    s_waitcnt lgkmcnt(0)
    v_readfirstlane_b32 s15, v156
    v_add_u32 v141, s7, v165
    v_add_u32 v142, s9, v165
    v_cvt_pk_bf16_f32 v128, v0, v1
    v_cvt_pk_bf16_f32 v129, v2, v3
    v_cvt_pk_bf16_f32 v130, v4, v5
    v_cvt_pk_bf16_f32 v131, v6, v7
    v_cvt_pk_bf16_f32 v132, v8, v9
    v_cvt_pk_bf16_f32 v133, v10, v11
    v_cvt_pk_bf16_f32 v134, v12, v13
    v_cvt_pk_bf16_f32 v135, v14, v15
    v_pk_mul_f32 v[16:17], v[16:17], s[2:3] op_sel:[0,1] op_sel_hi:[1,1]
    v_pk_mul_f32 v[18:19], v[18:19], s[2:3] op_sel:[0,1] op_sel_hi:[1,1]
    v_pk_mul_f32 v[20:21], v[20:21], s[2:3] op_sel:[0,1] op_sel_hi:[1,1]
    v_pk_mul_f32 v[22:23], v[22:23], s[2:3] op_sel:[0,1] op_sel_hi:[1,1]
    v_pk_mul_f32 v[24:25], v[24:25], s[2:3] op_sel:[0,1] op_sel_hi:[1,1]
    v_pk_mul_f32 v[26:27], v[26:27], s[2:3] op_sel:[0,1] op_sel_hi:[1,1]
    v_pk_mul_f32 v[28:29], v[28:29], s[2:3] op_sel:[0,1] op_sel_hi:[1,1]
    v_pk_mul_f32 v[30:31], v[30:31], s[2:3] op_sel:[0,1] op_sel_hi:[1,1]
    v_cvt_pk_bf16_f32 v144, v16, v17
    v_cvt_pk_bf16_f32 v145, v18, v19
    v_cvt_pk_bf16_f32 v146, v20, v21
    v_cvt_pk_bf16_f32 v147, v22, v23
    v_cvt_pk_bf16_f32 v148, v24, v25
    v_cvt_pk_bf16_f32 v149, v26, v27
    v_cvt_pk_bf16_f32 v150, v28, v29
    v_cvt_pk_bf16_f32 v151, v30, v31
    v_permlane16_swap_b32 v128, v132
    v_permlane16_swap_b32 v129, v133
    v_permlane16_swap_b32 v130, v134
    v_permlane16_swap_b32 v131, v135
    v_permlane16_swap_b32 v144, v148
    v_permlane16_swap_b32 v145, v149
    v_permlane16_swap_b32 v146, v150
    v_permlane16_swap_b32 v147, v151
    s_cmp_eq_u32 s10, 0
    s_cbranch_scc1 L_noq_140
    buffer_store_dwordx4 v[128:131], v165, s[48:51], s8 offen offset:0
    buffer_store_dwordx4 v[132:135], v165, s[48:51], s8 offen offset:1024
    buffer_store_dwordx4 v[144:147], v165, s[48:51], s8 offen offset:2048
    buffer_store_dwordx4 v[148:151], v165, s[48:51], s8 offen offset:3072
L_noq_140:
    v_cvt_pk_bf16_f32 v96, v32, v33
    v_cvt_pk_bf16_f32 v97, v34, v35
    v_cvt_pk_bf16_f32 v98, v36, v37
    v_cvt_pk_bf16_f32 v99, v38, v39
    v_cvt_pk_bf16_f32 v100, v40, v41
    v_cvt_pk_bf16_f32 v101, v42, v43
    v_cvt_pk_bf16_f32 v102, v44, v45
    v_cvt_pk_bf16_f32 v103, v46, v47
    v_cvt_pk_bf16_f32 v104, v64, v65
    v_cvt_pk_bf16_f32 v105, v66, v67
    v_cvt_pk_bf16_f32 v106, v68, v69
    v_cvt_pk_bf16_f32 v107, v70, v71
    v_cvt_pk_bf16_f32 v108, v72, v73
    v_cvt_pk_bf16_f32 v109, v74, v75
    v_cvt_pk_bf16_f32 v110, v76, v77
    v_cvt_pk_bf16_f32 v111, v78, v79
    v_permlane16_swap_b32 v96, v100
    v_permlane16_swap_b32 v97, v101
    v_permlane16_swap_b32 v98, v102
    v_permlane16_swap_b32 v99, v103
    v_permlane16_swap_b32 v104, v106
    v_permlane16_swap_b32 v105, v107
    v_permlane16_swap_b32 v108, v110
    v_permlane16_swap_b32 v109, v111
    s_nop 0
    v_permlane32_swap_b32 v104, v106
    v_permlane32_swap_b32 v105, v107
    v_permlane32_swap_b32 v108, v110
    v_permlane32_swap_b32 v109, v111
    buffer_store_dwordx4 v[96:99], v165, s[48:51], s5 offen offset:0
    buffer_store_dwordx4 v[100:103], v165, s[48:51], s5 offen offset:1024
    buffer_store_dwordx4 v[104:107], v165, s[48:51], s5 offen offset:2048
    buffer_store_dwordx4 v[108:111], v165, s[48:51], s5 offen offset:3072
    v_cvt_pk_bf16_f32 v112, v48, v49
    v_cvt_pk_bf16_f32 v113, v50, v51
    v_cvt_pk_bf16_f32 v114, v52, v53
    v_cvt_pk_bf16_f32 v115, v54, v55
    v_cvt_pk_bf16_f32 v116, v56, v57
    v_cvt_pk_bf16_f32 v117, v58, v59
    v_cvt_pk_bf16_f32 v118, v60, v61
    v_cvt_pk_bf16_f32 v119, v62, v63
    v_cvt_pk_bf16_f32 v120, v80, v81
    v_cvt_pk_bf16_f32 v121, v82, v83
    v_cvt_pk_bf16_f32 v122, v84, v85
    v_cvt_pk_bf16_f32 v123, v86, v87
    v_cvt_pk_bf16_f32 v124, v88, v89
    v_cvt_pk_bf16_f32 v125, v90, v91
    v_cvt_pk_bf16_f32 v126, v92, v93
    v_cvt_pk_bf16_f32 v127, v94, v95
    v_permlane16_swap_b32 v112, v116
    v_permlane16_swap_b32 v113, v117
    v_permlane16_swap_b32 v114, v118
    v_permlane16_swap_b32 v115, v119
    v_permlane16_swap_b32 v120, v122
    v_permlane16_swap_b32 v121, v123
    v_permlane16_swap_b32 v124, v126
    v_permlane16_swap_b32 v125, v127
    s_nop 0
    v_permlane32_swap_b32 v120, v122
    v_permlane32_swap_b32 v121, v123
    v_permlane32_swap_b32 v124, v126
    v_permlane32_swap_b32 v125, v127
    buffer_store_dwordx4 v[112:115], v165, s[48:51], s6 offen offset:0
    buffer_store_dwordx4 v[116:119], v165, s[48:51], s6 offen offset:1024
    buffer_store_dwordx4 v[120:123], v165, s[48:51], s6 offen offset:2048
    buffer_store_dwordx4 v[124:127], v165, s[48:51], s6 offen offset:3072
    ds_write_b128 v141, v[96:99] offset:0
    ds_write_b128 v141, v[100:103] offset:1024
    ds_write_b128 v141, v[104:107] offset:2048
    ds_write_b128 v141, v[108:111] offset:3072
    ds_write_b128 v141, v[112:115] offset:4096
    ds_write_b128 v141, v[116:119] offset:5120
    ds_write_b128 v141, v[120:123] offset:6144
    ds_write_b128 v141, v[124:127] offset:7168
    ds_write_b128 v142, v[128:131] offset:0
    ds_write_b128 v142, v[132:135] offset:1024
    ds_write_b128 v142, v[144:147] offset:2048
    ds_write_b128 v142, v[148:151] offset:3072
    s_lshl_b32 s3, s66, 4
    s_add_u32 s3, s3, s65
    s_lshl_b32 s3, s3, 5
    s_add_u32 s3, s3, s64
    s_lshl_b32 s3, s3, 2
    s_add_u32 s91, s3, 12984320
    s_or_b32 s73, s73, s15
    v_mov_b32 v156, 0
    v_mov_b32 v157, s73
    s_waitcnt vmcnt(8)
    s_mov_b64 exec, 1
    buffer_store_dword v157, v156, s[48:51], s91 offen offset:16
    s_mov_b64 exec, -1
    s_waitcnt lgkmcnt(0)
    s_lshl_b32 s4, s64, 11
    s_add_u32 s4, s4, 131072
    v_add_u32 v143, s4, v165
    s_barrier
    ds_read_b128 v[128:131], v143
    ds_read_b128 v[132:135], v143 offset:1024
    v_mov_b32 v137, v165
    ds_read_b128 v[80:83], v137 offset:0
    ds_read_b128 v[84:87], v137 offset:1024
    s_and_b32 s67, s65, 1
    v_mov_b32 v156, 0
    v_mov_b32 v157, s73
    s_waitcnt vmcnt(1)
    s_mov_b64 exec, 1
    buffer_store_dword v157, v156, s[48:51], s91 offen
    s_mov_b64 exec, -1
    s_waitcnt lgkmcnt(0)
    ds_read_b128 v[88:91], v137 offset:2048
    ds_read_b128 v[92:95], v137 offset:3072
    ds_read_b128 v[96:99], v137 offset:6144
    ds_read_b128 v[100:103], v137 offset:7168
    v_mfma_f32_32x32x16_bf16 v[0:15], v[80:83], v[128:131], 0
    v_mfma_f32_32x32x16_bf16 v[0:15], v[84:87], v[132:135], v[0:15]
    v_mov_b32 v124, v161
    v_mov_b32 v125, v161
    v_sub_u32 v126, v160, v161
    v_sub_u32 v127, v160, v161
    v_mov_b32 v32, 0
    v_mov_b32 v33, 0
    v_mov_b32 v34, 0
    v_mov_b32 v35, 0
    v_mov_b32 v36, 0
    v_mov_b32 v37, 0
    v_mov_b32 v38, 0
    v_mov_b32 v39, 0
    v_mov_b32 v40, 0
    v_mov_b32 v41, 0
    v_mov_b32 v42, 0
    v_mov_b32 v43, 0
    v_mov_b32 v44, 0
    v_mov_b32 v45, 0
    v_mov_b32 v46, 0
    v_mov_b32 v47, 0
    v_mov_b32 v120, 0
    v_mov_b32 v121, 0
    v_mov_b32 v122, 0
    v_mov_b32 v123, 0
    v_mov_b32 v149, 0
    s_mov_b32 s75, 0
    s_mov_b32 s94, 0
    s_mov_b32 s79, 0
    v_max3_f32 v156, v0, v1, v2
    v_max3_f32 v156, v156, v3, v4
    v_max3_f32 v156, v156, v5, v6
    v_max3_f32 v156, v156, v7, v8
    v_max3_f32 v156, v156, v9, v10
    v_max3_f32 v156, v156, v11, v12
    v_max3_f32 v156, v156, v13, v14
    v_max_f32 v156, v156, v15
    v_mov_b32 v157, v156
    s_nop 1
    v_permlane32_swap_b32 v156, v157
    s_nop 1
    v_max_f32 v156, v156, v157
    v_sub_f32 v48, 0, v156
    v_sub_f32 v49, 0, v156
    v_sub_f32 v50, 0, v156
    v_sub_f32 v51, 0, v156
    v_sub_f32 v52, 0, v156
    v_sub_f32 v53, 0, v156
    v_sub_f32 v54, 0, v156
    v_sub_f32 v55, 0, v156
    v_sub_f32 v56, 0, v156
    v_sub_f32 v57, 0, v156
    v_sub_f32 v58, 0, v156
    v_sub_f32 v59, 0, v156
    v_sub_f32 v60, 0, v156
    v_sub_f32 v61, 0, v156
    v_sub_f32 v62, 0, v156
    v_sub_f32 v63, 0, v156
    s_nop 1
    v_mfma_f32_32x32x16_bf16 v[0:15], v[80:83], v[128:131], v[48:63]
    v_mfma_f32_32x32x16_bf16 v[0:15], v[84:87], v[132:135], v[0:15]
    ds_read_b128 v[80:83], v137 offset:4096
    ds_read_b128 v[84:87], v137 offset:5120
    s_nop 7
    s_setprio 2
    s_waitcnt lgkmcnt(0)
    s_nop 2
    v_mfma_f32_32x32x16_bf16 v[16:31], v[80:83], v[128:131], v[48:63]
    v_exp_f32 v0, v0
    v_exp_f32 v1, v1
    v_exp_f32 v2, v2
    v_cvt_pk_bf16_f32 v64, v0, v1
    v_exp_f32 v3, v3
    v_mfma_f32_32x32x16_bf16 v[16:31], v[84:87], v[132:135], v[16:31]
    ds_read_b128 v[80:83], v137 offset:8192
    v_exp_f32 v4, v4
    v_exp_f32 v5, v5
    v_cvt_pk_bf16_f32 v65, v2, v3
    v_exp_f32 v6, v6
    v_exp_f32 v7, v7
    ds_read_b128 v[84:87], v137 offset:9216
    v_cvt_pk_bf16_f32 v66, v4, v5
    v_exp_f32 v8, v8
    v_cvt_pk_bf16_f32 v67, v6, v7
    v_exp_f32 v9, v9
    v_exp_f32 v10, v10
    ds_read_b128 v[104:107], v137 offset:10240
    v_exp_f32 v11, v11
    v_cvt_pk_bf16_f32 v68, v8, v9
    v_exp_f32 v12, v12
    v_exp_f32 v13, v13
    v_cvt_pk_bf16_f32 v69, v10, v11
    ds_read_b128 v[108:111], v137 offset:11264
    v_exp_f32 v14, v14
    v_exp_f32 v15, v15
    v_cvt_pk_bf16_f32 v70, v12, v13
    v_cvt_pk_bf16_f32 v71, v14, v15
    s_waitcnt lgkmcnt(2)
    v_mfma_f32_32x32x16_bf16 v[0:15], v[80:83], v[128:131], v[48:63]
    v_exp_f32 v16, v16
    v_exp_f32 v17, v17
    v_exp_f32 v18, v18
    v_cvt_pk_bf16_f32 v72, v16, v17
    v_exp_f32 v19, v19
    v_mfma_f32_32x32x16_bf16 v[0:15], v[84:87], v[132:135], v[0:15]
    ds_read_b128 v[80:83], v137 offset:12288
    v_exp_f32 v20, v20
    v_exp_f32 v21, v21
    v_cvt_pk_bf16_f32 v73, v18, v19
    v_exp_f32 v22, v22
    v_exp_f32 v23, v23
    v_mfma_f32_32x32x16_bf16 v[32:47], v[88:91], v[64:67], v[32:47]
    ds_read_b128 v[84:87], v137 offset:13312
    v_cvt_pk_bf16_f32 v74, v20, v21
    v_exp_f32 v24, v24
    v_cvt_pk_bf16_f32 v75, v22, v23
    v_exp_f32 v25, v25
    v_exp_f32 v26, v26
    v_mfma_f32_32x32x16_bf16 v[32:47], v[92:95], v[68:71], v[32:47]
    ds_read_b128 v[112:115], v137 offset:14336
    v_exp_f32 v27, v27
    v_cvt_pk_bf16_f32 v76, v24, v25
    v_exp_f32 v28, v28
    v_exp_f32 v29, v29
    v_cvt_pk_bf16_f32 v77, v26, v27
    v_smfmac_f32_16x16x64_bf16 v[120:123], v[124:127], v[64:71], v162
    ds_read_b128 v[116:119], v137 offset:15360
    v_exp_f32 v30, v30
    v_exp_f32 v31, v31
    v_cvt_pk_bf16_f32 v78, v28, v29
    v_cvt_pk_bf16_f32 v79, v30, v31
    s_waitcnt lgkmcnt(2)
    v_mfma_f32_32x32x16_bf16 v[16:31], v[80:83], v[128:131], v[48:63]
    v_exp_f32 v0, v0
    v_exp_f32 v1, v1
    v_exp_f32 v2, v2
    v_cvt_pk_bf16_f32 v64, v0, v1
    v_exp_f32 v3, v3
    v_mfma_f32_32x32x16_bf16 v[16:31], v[84:87], v[132:135], v[16:31]
    v_exp_f32 v4, v4
    v_exp_f32 v5, v5
    v_cvt_pk_bf16_f32 v65, v2, v3
    v_exp_f32 v6, v6
    v_exp_f32 v7, v7
    v_mfma_f32_32x32x16_bf16 v[32:47], v[96:99], v[72:75], v[32:47]
    v_cvt_pk_bf16_f32 v66, v4, v5
    v_exp_f32 v8, v8
    v_cvt_pk_bf16_f32 v67, v6, v7
    v_exp_f32 v9, v9
    v_exp_f32 v10, v10
    v_mfma_f32_32x32x16_bf16 v[32:47], v[100:103], v[76:79], v[32:47]
    v_exp_f32 v11, v11
    v_cvt_pk_bf16_f32 v68, v8, v9
    v_exp_f32 v12, v12
    v_exp_f32 v13, v13
    v_cvt_pk_bf16_f32 v69, v10, v11
    v_smfmac_f32_16x16x64_bf16 v[120:123], v[124:127], v[72:79], v162
    v_exp_f32 v14, v14
    v_exp_f32 v15, v15
    v_cvt_pk_bf16_f32 v70, v12, v13
    v_cvt_pk_bf16_f32 v71, v14, v15
    s_setprio 0
    ds_read_b32 v139, v163
    v_exp_f32 v16, v16
    v_exp_f32 v17, v17
    v_exp_f32 v18, v18
    v_cvt_pk_bf16_f32 v72, v16, v17
    v_exp_f32 v19, v19
    v_exp_f32 v20, v20
    v_exp_f32 v21, v21
    v_cvt_pk_bf16_f32 v73, v18, v19
    v_exp_f32 v22, v22
    v_exp_f32 v23, v23
    v_mfma_f32_32x32x16_bf16 v[32:47], v[104:107], v[64:67], v[32:47]
    v_cvt_pk_bf16_f32 v74, v20, v21
    v_exp_f32 v24, v24
    v_cvt_pk_bf16_f32 v75, v22, v23
    v_exp_f32 v25, v25
    v_exp_f32 v26, v26
    v_mfma_f32_32x32x16_bf16 v[32:47], v[108:111], v[68:71], v[32:47]
    v_exp_f32 v27, v27
    v_cvt_pk_bf16_f32 v76, v24, v25
    v_exp_f32 v28, v28
    v_exp_f32 v29, v29
    v_cvt_pk_bf16_f32 v77, v26, v27
    v_smfmac_f32_16x16x64_bf16 v[120:123], v[124:127], v[64:71], v162
    s_add_u32 s75, s75, 16384
    s_and_b32 s75, s75, 131071
    s_add_u32 s79, s79, 1
    v_exp_f32 v30, v30
    v_exp_f32 v31, v31
    v_cvt_pk_bf16_f32 v78, v28, v29
    v_cvt_pk_bf16_f32 v79, v30, v31
    v_add_u32 v137, s75, v165
    v_mov_b32 v154, s79
    s_waitcnt lgkmcnt(0)
    v_readfirstlane_b32 s3, v139
    ds_write_b32 v164, v154
    s_cmp_ge_u32 s3, s79
    s_cbranch_scc0 L_hs_slowA0
L_hs_backA0:
    s_setprio 2
    ds_read_b128 v[80:83], v137 offset:0
    ds_read_b128 v[84:87], v137 offset:1024
    ds_read_b128 v[88:91], v137 offset:2048
    ds_read_b128 v[92:95], v137 offset:3072
    ds_read_b128 v[96:99], v137 offset:6144
    ds_read_b128 v[100:103], v137 offset:7168
    s_waitcnt lgkmcnt(4)
    v_mfma_f32_32x32x16_bf16 v[0:15], v[80:83], v[128:131], v[48:63]
    v_mfma_f32_32x32x16_bf16 v[0:15], v[84:87], v[132:135], v[0:15]
    ds_read_b128 v[80:83], v137 offset:4096
    ds_read_b128 v[84:87], v137 offset:5120
    s_nop 7
    s_waitcnt lgkmcnt(0)
    v_mfma_f32_32x32x16_bf16 v[16:31], v[80:83], v[128:131], v[48:63]
    v_exp_f32 v0, v0
    v_exp_f32 v1, v1
    v_exp_f32 v2, v2
    v_cvt_pk_bf16_f32 v64, v0, v1
    v_exp_f32 v3, v3
    v_mfma_f32_32x32x16_bf16 v[16:31], v[84:87], v[132:135], v[16:31]
    ds_read_b128 v[80:83], v137 offset:8192
    v_exp_f32 v4, v4
    v_exp_f32 v5, v5
    v_cvt_pk_bf16_f32 v65, v2, v3
    v_exp_f32 v6, v6
    v_exp_f32 v7, v7
    v_mfma_f32_32x32x16_bf16 v[32:47], v[112:115], v[72:75], v[32:47]
    ds_read_b128 v[84:87], v137 offset:9216
    v_cvt_pk_bf16_f32 v66, v4, v5
    v_exp_f32 v8, v8
    v_cvt_pk_bf16_f32 v67, v6, v7
    v_exp_f32 v9, v9
    v_exp_f32 v10, v10
    v_mfma_f32_32x32x16_bf16 v[32:47], v[116:119], v[76:79], v[32:47]
    ds_read_b128 v[104:107], v137 offset:10240
    v_exp_f32 v11, v11
    v_cvt_pk_bf16_f32 v68, v8, v9
    v_exp_f32 v12, v12
    v_exp_f32 v13, v13
    v_cvt_pk_bf16_f32 v69, v10, v11
    v_smfmac_f32_16x16x64_bf16 v[120:123], v[124:127], v[72:79], v162
    ds_read_b128 v[108:111], v137 offset:11264
    v_exp_f32 v14, v14
    v_exp_f32 v15, v15
    v_cvt_pk_bf16_f32 v70, v12, v13
    v_cvt_pk_bf16_f32 v71, v14, v15
    s_waitcnt lgkmcnt(2)
    v_mfma_f32_32x32x16_bf16 v[0:15], v[80:83], v[128:131], v[48:63]
    s_setprio 0
    ds_read_b32 v139, v163
    v_exp_f32 v16, v16
    v_exp_f32 v17, v17
    v_exp_f32 v18, v18
    v_cvt_pk_bf16_f32 v72, v16, v17
    v_exp_f32 v19, v19
    v_mfma_f32_32x32x16_bf16 v[0:15], v[84:87], v[132:135], v[0:15]
    ds_read_b128 v[80:83], v137 offset:12288
    v_exp_f32 v20, v20
    v_exp_f32 v21, v21
    v_cvt_pk_bf16_f32 v73, v18, v19
    v_exp_f32 v22, v22
    v_exp_f32 v23, v23
    v_mfma_f32_32x32x16_bf16 v[32:47], v[88:91], v[64:67], v[32:47]
    ds_read_b128 v[84:87], v137 offset:13312
    v_cvt_pk_bf16_f32 v74, v20, v21
    v_exp_f32 v24, v24
    v_cvt_pk_bf16_f32 v75, v22, v23
    v_exp_f32 v25, v25
    v_exp_f32 v26, v26
    v_mfma_f32_32x32x16_bf16 v[32:47], v[92:95], v[68:71], v[32:47]
    ds_read_b128 v[112:115], v137 offset:14336
    v_exp_f32 v27, v27
    v_cvt_pk_bf16_f32 v76, v24, v25
    v_exp_f32 v28, v28
    v_exp_f32 v29, v29
    v_cvt_pk_bf16_f32 v77, v26, v27
    v_smfmac_f32_16x16x64_bf16 v[120:123], v[124:127], v[64:71], v162
    ds_read_b128 v[116:119], v137 offset:15360
    s_add_u32 s75, s75, 16384
    s_and_b32 s75, s75, 131071
    s_add_u32 s79, s79, 1
    v_exp_f32 v30, v30
    v_exp_f32 v31, v31
    v_cvt_pk_bf16_f32 v78, v28, v29
    v_cvt_pk_bf16_f32 v79, v30, v31
    v_add_u32 v137, s75, v165
    v_mov_b32 v154, s79
    s_waitcnt lgkmcnt(0)
    v_readfirstlane_b32 s3, v139
    ds_write_b32 v164, v154
    s_cmp_ge_u32 s3, s79
    s_cbranch_scc0 L_hs_slowA1
L_hs_backA1:
    s_setprio 2
.p2align 6
L_attloopA:
    v_mfma_f32_32x32x16_bf16 v[16:31], v[80:83], v[128:131], v[48:63]
    v_exp_f32 v0, v0
    v_exp_f32 v1, v1
    v_exp_f32 v2, v2
    v_cvt_pk_bf16_f32 v64, v0, v1
    v_exp_f32 v3, v3
    v_mfma_f32_32x32x16_bf16 v[16:31], v[84:87], v[132:135], v[16:31]
    ds_read_b128 v[80:83], v137 offset:0
    v_exp_f32 v4, v4
    v_exp_f32 v5, v5
    v_cvt_pk_bf16_f32 v65, v2, v3
    v_exp_f32 v6, v6
    v_exp_f32 v7, v7
    v_mfma_f32_32x32x16_bf16 v[32:47], v[96:99], v[72:75], v[32:47]
    ds_read_b128 v[84:87], v137 offset:1024
    v_cvt_pk_bf16_f32 v66, v4, v5
    v_exp_f32 v8, v8
    v_cvt_pk_bf16_f32 v67, v6, v7
    v_exp_f32 v9, v9
    v_exp_f32 v10, v10
    v_mfma_f32_32x32x16_bf16 v[32:47], v[100:103], v[76:79], v[32:47]
    ds_read_b128 v[88:91], v137 offset:2048
    v_exp_f32 v11, v11
    v_cvt_pk_bf16_f32 v68, v8, v9
    v_exp_f32 v12, v12
    v_exp_f32 v13, v13
    v_cvt_pk_bf16_f32 v69, v10, v11
    v_smfmac_f32_16x16x64_bf16 v[120:123], v[124:127], v[72:79], v162
    ds_read_b128 v[92:95], v137 offset:3072
    v_exp_f32 v14, v14
    v_exp_f32 v15, v15
    v_cvt_pk_bf16_f32 v70, v12, v13
    v_cvt_pk_bf16_f32 v71, v14, v15
    s_waitcnt lgkmcnt(2)
    v_mfma_f32_32x32x16_bf16 v[0:15], v[80:83], v[128:131], v[48:63]
    v_exp_f32 v16, v16
    v_exp_f32 v17, v17
    v_exp_f32 v18, v18
    v_cvt_pk_bf16_f32 v72, v16, v17
    v_exp_f32 v19, v19
    v_mfma_f32_32x32x16_bf16 v[0:15], v[84:87], v[132:135], v[0:15]
    ds_read_b128 v[80:83], v137 offset:4096
    v_exp_f32 v20, v20
    v_exp_f32 v21, v21
    v_cvt_pk_bf16_f32 v73, v18, v19
    v_exp_f32 v22, v22
    v_exp_f32 v23, v23
    v_mfma_f32_32x32x16_bf16 v[32:47], v[104:107], v[64:67], v[32:47]
    ds_read_b128 v[84:87], v137 offset:5120
    v_cvt_pk_bf16_f32 v74, v20, v21
    v_exp_f32 v24, v24
    v_cvt_pk_bf16_f32 v75, v22, v23
    v_exp_f32 v25, v25
    v_exp_f32 v26, v26
    v_mfma_f32_32x32x16_bf16 v[32:47], v[108:111], v[68:71], v[32:47]
    ds_read_b128 v[96:99], v137 offset:6144
    v_exp_f32 v27, v27
    v_cvt_pk_bf16_f32 v76, v24, v25
    v_exp_f32 v28, v28
    v_exp_f32 v29, v29
    v_cvt_pk_bf16_f32 v77, v26, v27
    v_smfmac_f32_16x16x64_bf16 v[120:123], v[124:127], v[64:71], v162
    ds_read_b128 v[100:103], v137 offset:7168
    v_exp_f32 v30, v30
    v_exp_f32 v31, v31
    v_cvt_pk_bf16_f32 v78, v28, v29
    v_cvt_pk_bf16_f32 v79, v30, v31
    s_waitcnt lgkmcnt(2)
    v_mfma_f32_32x32x16_bf16 v[16:31], v[80:83], v[128:131], v[48:63]
    v_exp_f32 v0, v0
    v_exp_f32 v1, v1
    v_exp_f32 v2, v2
    v_cvt_pk_bf16_f32 v64, v0, v1
    v_exp_f32 v3, v3
    v_mfma_f32_32x32x16_bf16 v[16:31], v[84:87], v[132:135], v[16:31]
    ds_read_b128 v[80:83], v137 offset:8192
    v_exp_f32 v4, v4
    v_exp_f32 v5, v5
    v_cvt_pk_bf16_f32 v65, v2, v3
    v_exp_f32 v6, v6
    v_exp_f32 v7, v7
    v_mfma_f32_32x32x16_bf16 v[32:47], v[112:115], v[72:75], v[32:47]
    ds_read_b128 v[84:87], v137 offset:9216
    v_cvt_pk_bf16_f32 v66, v4, v5
    v_exp_f32 v8, v8
    v_cvt_pk_bf16_f32 v67, v6, v7
    v_exp_f32 v9, v9
    v_exp_f32 v10, v10
    v_mfma_f32_32x32x16_bf16 v[32:47], v[116:119], v[76:79], v[32:47]
    ds_read_b128 v[104:107], v137 offset:10240
    v_exp_f32 v11, v11
    v_cvt_pk_bf16_f32 v68, v8, v9
    v_exp_f32 v12, v12
    v_exp_f32 v13, v13
    v_cvt_pk_bf16_f32 v69, v10, v11
    v_smfmac_f32_16x16x64_bf16 v[120:123], v[124:127], v[72:79], v162
    ds_read_b128 v[108:111], v137 offset:11264
    v_exp_f32 v14, v14
    v_exp_f32 v15, v15
    v_cvt_pk_bf16_f32 v70, v12, v13
    v_cvt_pk_bf16_f32 v71, v14, v15
    s_waitcnt lgkmcnt(2)
    v_mfma_f32_32x32x16_bf16 v[0:15], v[80:83], v[128:131], v[48:63]
    s_setprio 0
    ds_read_b32 v139, v163
    v_exp_f32 v16, v16
    v_exp_f32 v17, v17
    v_exp_f32 v18, v18
    v_cvt_pk_bf16_f32 v72, v16, v17
    v_exp_f32 v19, v19
    v_mfma_f32_32x32x16_bf16 v[0:15], v[84:87], v[132:135], v[0:15]
    ds_read_b128 v[80:83], v137 offset:12288
    v_exp_f32 v20, v20
    v_exp_f32 v21, v21
    v_cvt_pk_bf16_f32 v73, v18, v19
    v_exp_f32 v22, v22
    v_exp_f32 v23, v23
    v_mfma_f32_32x32x16_bf16 v[32:47], v[88:91], v[64:67], v[32:47]
    ds_read_b128 v[84:87], v137 offset:13312
    v_cvt_pk_bf16_f32 v74, v20, v21
    v_exp_f32 v24, v24
    v_cvt_pk_bf16_f32 v75, v22, v23
    v_exp_f32 v25, v25
    v_exp_f32 v26, v26
    v_mfma_f32_32x32x16_bf16 v[32:47], v[92:95], v[68:71], v[32:47]
    ds_read_b128 v[112:115], v137 offset:14336
    v_exp_f32 v27, v27
    v_cvt_pk_bf16_f32 v76, v24, v25
    v_exp_f32 v28, v28
    v_exp_f32 v29, v29
    v_cvt_pk_bf16_f32 v77, v26, v27
    v_smfmac_f32_16x16x64_bf16 v[120:123], v[124:127], v[64:71], v162
    ds_read_b128 v[116:119], v137 offset:15360
    s_add_u32 s75, s75, 16384
    s_and_b32 s75, s75, 131071
    s_add_u32 s79, s79, 1
    v_exp_f32 v30, v30
    v_exp_f32 v31, v31
    v_cvt_pk_bf16_f32 v78, v28, v29
    v_cvt_pk_bf16_f32 v79, v30, v31
    v_add_u32 v137, s75, v165
    v_mov_b32 v154, s79
    s_waitcnt lgkmcnt(0)
    v_readfirstlane_b32 s3, v139
    ds_write_b32 v164, v154
    s_cmp_ge_u32 s3, s79
    s_cbranch_scc0 L_hs_slowA2
L_hs_backA2:
    s_setprio 2
    s_cmp_eq_u32 s79, 10
    s_cbranch_scc1 L_opsA
    s_cmp_lt_u32 s79, 16
    s_cbranch_scc1 L_attloopA
    v_mfma_f32_32x32x16_bf16 v[16:31], v[80:83], v[128:131], v[48:63]
    v_exp_f32 v0, v0
    v_exp_f32 v1, v1
    v_exp_f32 v2, v2
    v_cvt_pk_bf16_f32 v64, v0, v1
    v_exp_f32 v3, v3
    v_mfma_f32_32x32x16_bf16 v[16:31], v[84:87], v[132:135], v[16:31]
    v_exp_f32 v4, v4
    v_exp_f32 v5, v5
    v_cvt_pk_bf16_f32 v65, v2, v3
    v_exp_f32 v6, v6
    v_exp_f32 v7, v7
    v_mfma_f32_32x32x16_bf16 v[32:47], v[96:99], v[72:75], v[32:47]
    v_cvt_pk_bf16_f32 v66, v4, v5
    v_exp_f32 v8, v8
    v_cvt_pk_bf16_f32 v67, v6, v7
    v_exp_f32 v9, v9
    v_exp_f32 v10, v10
    v_mfma_f32_32x32x16_bf16 v[32:47], v[100:103], v[76:79], v[32:47]
    v_exp_f32 v11, v11
    v_cvt_pk_bf16_f32 v68, v8, v9
    v_exp_f32 v12, v12
    v_exp_f32 v13, v13
    v_cvt_pk_bf16_f32 v69, v10, v11
    v_smfmac_f32_16x16x64_bf16 v[120:123], v[124:127], v[72:79], v162
    v_exp_f32 v14, v14
    v_exp_f32 v15, v15
    v_cvt_pk_bf16_f32 v70, v12, v13
    v_cvt_pk_bf16_f32 v71, v14, v15
    v_exp_f32 v16, v16
    v_exp_f32 v17, v17
    v_exp_f32 v18, v18
    v_cvt_pk_bf16_f32 v72, v16, v17
    v_exp_f32 v19, v19
    v_exp_f32 v20, v20
    v_exp_f32 v21, v21
    v_cvt_pk_bf16_f32 v73, v18, v19
    v_exp_f32 v22, v22
    v_exp_f32 v23, v23
    v_mfma_f32_32x32x16_bf16 v[32:47], v[104:107], v[64:67], v[32:47]
    v_cvt_pk_bf16_f32 v74, v20, v21
    v_exp_f32 v24, v24
    v_cvt_pk_bf16_f32 v75, v22, v23
    v_exp_f32 v25, v25
    v_exp_f32 v26, v26
    v_mfma_f32_32x32x16_bf16 v[32:47], v[108:111], v[68:71], v[32:47]
    v_exp_f32 v27, v27
    v_cvt_pk_bf16_f32 v76, v24, v25
    v_exp_f32 v28, v28
    v_exp_f32 v29, v29
    v_cvt_pk_bf16_f32 v77, v26, v27
    v_smfmac_f32_16x16x64_bf16 v[120:123], v[124:127], v[64:71], v162
    v_exp_f32 v30, v30
    v_exp_f32 v31, v31
    v_cvt_pk_bf16_f32 v78, v28, v29
    v_cvt_pk_bf16_f32 v79, v30, v31
    s_nop 1
    v_mfma_f32_32x32x16_bf16 v[32:47], v[112:115], v[72:75], v[32:47]
    v_mfma_f32_32x32x16_bf16 v[32:47], v[116:119], v[76:79], v[32:47]
    v_smfmac_f32_16x16x64_bf16 v[120:123], v[124:127], v[72:79], v162
    s_branch L_att_tail
L_groupb:
    s_waitcnt lgkmcnt(0)
    s_mov_b32 s40, s16
    s_and_b32 s41, s17, 0xffff
    s_mov_b32 s42, 4194304
    s_mov_b32 s43, 0x20000
    s_mov_b32 s44, s18
    s_and_b32 s45, s19, 0xffff
    s_mov_b32 s46, 6291456
    s_mov_b32 s47, 0x20000
    s_mov_b32 s48, s38
    s_and_b32 s49, s39, 0xffff
    s_mov_b32 s50, 33554432
    s_mov_b32 s51, 0x20000
    s_mov_b32 s52, s36
    s_and_b32 s53, s37, 0xffff
    s_mov_b32 s54, 256
    s_mov_b32 s55, 0x20000
    v_mov_b32 v166, v0
    v_lshlrev_b32 v165, 4, v0
    s_and_b32 s67, s64, 1
    v_mov_b32 v163, 155680
    s_lshl_b32 s4, s64, 8
    s_add_u32 s4, s4, 155904
    v_lshl_add_u32 v164, v166, 2, s4
    v_and_b32 v156, 1, v166
    v_mov_b32 v157, 0x44444444
    v_mov_b32 v158, 0xeeeeeeee
    v_cmp_eq_u32 vcc, 0, v156
    s_nop 1
    v_cndmask_b32 v162, v158, v157, vcc
    v_and_b32 v156, 2, v166
    v_bfe_u32 v157, v166, 2, 1
    v_mov_b32 v158, 0x3f803f80
    v_cmp_eq_u32 vcc, 0, v156
    s_nop 1
    v_cndmask_b32 v160, 0, v158, vcc
    v_cmp_eq_u32 vcc, 0, v157
    s_nop 1
    v_cndmask_b32 v161, 0, v160, vcc
    s_and_b32 s4, s64, 3
    s_lshl_b32 s4, s4, 11
    s_add_u32 s4, s4, 147456
    v_add_u32 v142, s4, v165
    s_cmp_lt_u32 s64, 6
    s_cbranch_scc1 L_rg_141
    s_barrier
    s_barrier
    s_barrier
    s_barrier
    s_barrier
    s_barrier
    s_barrier
    s_barrier
    s_barrier
    s_barrier
    s_barrier
    s_barrier
    s_barrier
    s_barrier
    s_barrier
    s_barrier
    s_barrier
    s_waitcnt lgkmcnt(0)
    s_branch L_rgj_142
L_rg_141:
    s_lshr_b32 s4, s2, 3
    s_lshr_b32 s5, s4, 3
    s_add_u32 s4, s4, s5
    s_and_b32 s4, s4, 3
    s_mov_b32 s79, s4
    s_mov_b32 s82, 0x65832140
    s_mov_b32 s83, 0xfedba9c7
    s_cmp_eq_u32 s4, 1
    s_cselect_b32 s82, 0x69432501, s82
    s_cselect_b32 s83, 0xfecbad87, s83
    s_cmp_eq_u32 s4, 2
    s_cselect_b32 s82, 0xa5436102, s82
    s_cselect_b32 s83, 0xfdcbe987, s83
    s_cmp_eq_u32 s4, 3
    s_cselect_b32 s82, 0x65472103, s82
    s_cselect_b32 s83, 0xedcfa98b, s83
    s_cmp_eq_u32 s64, 4
    s_cselect_b32 s6, s24, s32
    s_cselect_b32 s7, s25, s33
    s_mov_b32 s56, s6
    s_and_b32 s57, s7, 0xffff
    s_mov_b32 s58, 2048
    s_mov_b32 s59, 0x20000
    v_lshlrev_b32 v2, 7, v0
    buffer_load_dword v140, v2, s[56:59], 0 offen
    v_lshrrev_b32 v2, 4, v0
    v_and_b32 v3, 7, v0
    v_xor_b32 v4, v2, v3
    v_lshlrev_b32 v4, 4, v4
    s_and_b32 s3, s66, 1
    s_lshl_b32 s3, s3, 6
    v_xor_b32 v4, s3, v4
    s_lshl_b32 s3, s66, 10
    v_add_u32 v5, s3, v165
    v_add_u32 v7, 81920, v5
    v_mov_b32 v6, 0
    s_barrier
    ds_read_b128 v[8:11], v5 offset:0
    s_waitcnt lgkmcnt(0)
    s_barrier
    ds_read_b128 v[12:15], v5 offset:40960
    s_waitcnt lgkmcnt(0)
    s_barrier
    ds_read_b128 v[16:19], v7 offset:0
    s_waitcnt lgkmcnt(0)
    s_barrier
    ds_read_b128 v[20:23], v7 offset:40960
    s_bfe_u32 s4, s82, 0x40000
    s_lshl_b32 s4, s4, 7
    buffer_load_dwordx4 v[72:75], v4, s[56:59], s4 offen
    s_bfe_u32 s4, s82, 0x40004
    s_lshl_b32 s4, s4, 7
    buffer_load_dwordx4 v[76:79], v4, s[56:59], s4 offen
    s_bfe_u32 s4, s82, 0x40008
    s_lshl_b32 s4, s4, 7
    buffer_load_dwordx4 v[80:83], v4, s[56:59], s4 offen
    s_bfe_u32 s4, s82, 0x4000c
    s_lshl_b32 s4, s4, 7
    buffer_load_dwordx4 v[84:87], v4, s[56:59], s4 offen
    s_bfe_u32 s4, s82, 0x40010
    s_lshl_b32 s4, s4, 7
    buffer_load_dwordx4 v[88:91], v4, s[56:59], s4 offen
    s_bfe_u32 s4, s82, 0x40014
    s_lshl_b32 s4, s4, 7
    buffer_load_dwordx4 v[92:95], v4, s[56:59], s4 offen
    s_bfe_u32 s4, s82, 0x40018
    s_lshl_b32 s4, s4, 7
    buffer_load_dwordx4 v[96:99], v4, s[56:59], s4 offen
    s_bfe_u32 s4, s82, 0x4001c
    s_lshl_b32 s4, s4, 7
    buffer_load_dwordx4 v[100:103], v4, s[56:59], s4 offen
    s_bfe_u32 s4, s83, 0x40000
    s_lshl_b32 s4, s4, 7
    buffer_load_dwordx4 v[104:107], v4, s[56:59], s4 offen
    s_bfe_u32 s4, s83, 0x40004
    s_lshl_b32 s4, s4, 7
    buffer_load_dwordx4 v[108:111], v4, s[56:59], s4 offen
    s_bfe_u32 s4, s83, 0x40008
    s_lshl_b32 s4, s4, 7
    buffer_load_dwordx4 v[112:115], v4, s[56:59], s4 offen
    s_bfe_u32 s4, s83, 0x4000c
    s_lshl_b32 s4, s4, 7
    buffer_load_dwordx4 v[116:119], v4, s[56:59], s4 offen
    s_bfe_u32 s4, s83, 0x40010
    s_lshl_b32 s4, s4, 7
    buffer_load_dwordx4 v[120:123], v4, s[56:59], s4 offen
    s_bfe_u32 s4, s83, 0x40014
    s_lshl_b32 s4, s4, 7
    buffer_load_dwordx4 v[124:127], v4, s[56:59], s4 offen
    s_bfe_u32 s4, s83, 0x40018
    s_lshl_b32 s4, s4, 7
    buffer_load_dwordx4 v[128:131], v4, s[56:59], s4 offen
    s_bfe_u32 s4, s83, 0x4001c
    s_lshl_b32 s4, s4, 7
    buffer_load_dwordx4 v[132:135], v4, s[56:59], s4 offen
    s_waitcnt lgkmcnt(0)
    s_barrier
    ds_read_b128 v[24:27], v5 offset:0
    s_waitcnt lgkmcnt(0)
    s_barrier
    ds_read_b128 v[28:31], v5 offset:40960
    s_waitcnt lgkmcnt(0)
    s_barrier
    ds_read_b128 v[32:35], v7 offset:0
    s_waitcnt lgkmcnt(0)
    s_barrier
    ds_read_b128 v[36:39], v7 offset:40960
    s_waitcnt lgkmcnt(0)
    s_barrier
    ds_read_b128 v[40:43], v5 offset:0
    s_waitcnt lgkmcnt(0)
    s_barrier
    ds_read_b128 v[44:47], v5 offset:40960
    s_waitcnt lgkmcnt(0)
    s_barrier
    ds_read_b128 v[48:51], v7 offset:0
    s_waitcnt lgkmcnt(0)
    s_barrier
    ds_read_b128 v[52:55], v7 offset:40960
    s_waitcnt lgkmcnt(0)
    s_barrier
    ds_read_b128 v[56:59], v5 offset:0
    s_waitcnt lgkmcnt(0)
    s_barrier
    ds_read_b128 v[60:63], v5 offset:40960
    s_waitcnt lgkmcnt(0)
    s_barrier
    ds_read_b128 v[64:67], v7 offset:0
    s_waitcnt lgkmcnt(0)
    s_barrier
    ds_read_b128 v[68:71], v7 offset:40960
    s_waitcnt lgkmcnt(0)
    s_barrier
    s_waitcnt vmcnt(0)
    v_dot2c_f32_bf16 v6, v8, v72
    v_dot2c_f32_bf16 v6, v9, v73
    v_dot2c_f32_bf16 v6, v10, v74
    v_dot2c_f32_bf16 v6, v11, v75
    v_dot2c_f32_bf16 v6, v12, v76
    v_dot2c_f32_bf16 v6, v13, v77
    v_dot2c_f32_bf16 v6, v14, v78
    v_dot2c_f32_bf16 v6, v15, v79
    v_dot2c_f32_bf16 v6, v16, v80
    v_dot2c_f32_bf16 v6, v17, v81
    v_dot2c_f32_bf16 v6, v18, v82
    v_dot2c_f32_bf16 v6, v19, v83
    v_dot2c_f32_bf16 v6, v20, v84
    v_dot2c_f32_bf16 v6, v21, v85
    v_dot2c_f32_bf16 v6, v22, v86
    v_dot2c_f32_bf16 v6, v23, v87
    v_dot2c_f32_bf16 v6, v24, v88
    v_dot2c_f32_bf16 v6, v25, v89
    v_dot2c_f32_bf16 v6, v26, v90
    v_dot2c_f32_bf16 v6, v27, v91
    v_dot2c_f32_bf16 v6, v28, v92
    v_dot2c_f32_bf16 v6, v29, v93
    v_dot2c_f32_bf16 v6, v30, v94
    v_dot2c_f32_bf16 v6, v31, v95
    v_dot2c_f32_bf16 v6, v32, v96
    v_dot2c_f32_bf16 v6, v33, v97
    v_dot2c_f32_bf16 v6, v34, v98
    v_dot2c_f32_bf16 v6, v35, v99
    v_dot2c_f32_bf16 v6, v36, v100
    v_dot2c_f32_bf16 v6, v37, v101
    v_dot2c_f32_bf16 v6, v38, v102
    v_dot2c_f32_bf16 v6, v39, v103
    v_dot2c_f32_bf16 v6, v40, v104
    v_dot2c_f32_bf16 v6, v41, v105
    v_dot2c_f32_bf16 v6, v42, v106
    v_dot2c_f32_bf16 v6, v43, v107
    v_dot2c_f32_bf16 v6, v44, v108
    v_dot2c_f32_bf16 v6, v45, v109
    v_dot2c_f32_bf16 v6, v46, v110
    v_dot2c_f32_bf16 v6, v47, v111
    v_dot2c_f32_bf16 v6, v48, v112
    v_dot2c_f32_bf16 v6, v49, v113
    v_dot2c_f32_bf16 v6, v50, v114
    v_dot2c_f32_bf16 v6, v51, v115
    v_dot2c_f32_bf16 v6, v52, v116
    v_dot2c_f32_bf16 v6, v53, v117
    v_dot2c_f32_bf16 v6, v54, v118
    v_dot2c_f32_bf16 v6, v55, v119
    v_dot2c_f32_bf16 v6, v56, v120
    v_dot2c_f32_bf16 v6, v57, v121
    v_dot2c_f32_bf16 v6, v58, v122
    v_dot2c_f32_bf16 v6, v59, v123
    v_dot2c_f32_bf16 v6, v60, v124
    v_dot2c_f32_bf16 v6, v61, v125
    v_dot2c_f32_bf16 v6, v62, v126
    v_dot2c_f32_bf16 v6, v63, v127
    v_dot2c_f32_bf16 v6, v64, v128
    v_dot2c_f32_bf16 v6, v65, v129
    v_dot2c_f32_bf16 v6, v66, v130
    v_dot2c_f32_bf16 v6, v67, v131
    v_dot2c_f32_bf16 v6, v68, v132
    v_dot2c_f32_bf16 v6, v69, v133
    v_dot2c_f32_bf16 v6, v70, v134
    v_dot2c_f32_bf16 v6, v71, v135
    s_and_b32 s3, s64, 1
    s_lshl_b32 s3, s3, 2
    s_add_u32 s3, s3, 161792
    v_lshlrev_b32 v2, 3, v0
    v_add_u32 v2, s3, v2
    s_nop 1
    ds_write_b32 v2, v6
    s_waitcnt lgkmcnt(0)
L_rgj_142:
    s_barrier
    v_mov_b32 v124, v161
    v_mov_b32 v125, v161
    v_sub_u32 v126, v160, v161
    v_sub_u32 v127, v160, v161
    v_mov_b32 v32, 0
    v_mov_b32 v33, 0
    v_mov_b32 v34, 0
    v_mov_b32 v35, 0
    v_mov_b32 v36, 0
    v_mov_b32 v37, 0
    v_mov_b32 v38, 0
    v_mov_b32 v39, 0
    v_mov_b32 v40, 0
    v_mov_b32 v41, 0
    v_mov_b32 v42, 0
    v_mov_b32 v43, 0
    v_mov_b32 v44, 0
    v_mov_b32 v45, 0
    v_mov_b32 v46, 0
    v_mov_b32 v47, 0
    v_mov_b32 v120, 0
    v_mov_b32 v121, 0
    v_mov_b32 v122, 0
    v_mov_b32 v123, 0
    v_mov_b32 v149, 0
    v_mov_b32 v14, 155688
    s_mov_b32 s96, 1048576
L_spin_143:
    ds_read_b32 v16, v14
    s_waitcnt lgkmcnt(0)
    v_cmp_gt_u32 vcc, 1, v16
    s_sub_u32 s96, s96, 1
    s_cmp_eq_u32 s96, 0
    s_cbranch_scc1 L_spind_144
    s_nop 2
    s_cbranch_vccz L_spind_144
    s_sleep 1
    s_branch L_spin_143
L_spind_144:
    ds_read_b128 v[128:131], v142
    ds_read_b128 v[132:135], v142 offset:1024
    v_mov_b32 v137, v165
    ds_read_b128 v[80:83], v137 offset:0
    ds_read_b128 v[84:87], v137 offset:1024
    s_and_b32 s67, s65, 1
    v_mov_b32 v156, 155692
    ds_read_b32 v156, v156
    s_getreg_b32 s73, hwreg(HW_REG_XCC_ID, 0, 4)
    s_waitcnt lgkmcnt(0)
    v_readfirstlane_b32 s15, v156
    s_nop 1
    s_or_b32 s73, s73, s15
    ds_read_b128 v[88:91], v137 offset:2048
    ds_read_b128 v[92:95], v137 offset:3072
    ds_read_b128 v[96:99], v137 offset:6144
    ds_read_b128 v[100:103], v137 offset:7168
    v_mfma_f32_32x32x16_bf16 v[0:15], v[80:83], v[128:131], 0
    v_mfma_f32_32x32x16_bf16 v[0:15], v[84:87], v[132:135], v[0:15]
    s_nop 8
    s_mov_b32 s75, 0
    s_mov_b32 s94, 0
    s_mov_b32 s79, 0
    v_max3_f32 v156, v0, v1, v2
    v_max3_f32 v156, v156, v3, v4
    v_max3_f32 v156, v156, v5, v6
    v_max3_f32 v156, v156, v7, v8
    v_max3_f32 v156, v156, v9, v10
    v_max3_f32 v156, v156, v11, v12
    v_max3_f32 v156, v156, v13, v14
    v_max_f32 v156, v156, v15
    v_mov_b32 v157, v156
    s_nop 1
    v_permlane32_swap_b32 v156, v157
    s_nop 1
    v_max_f32 v156, v156, v157
    v_sub_f32 v48, 0, v156
    v_sub_f32 v49, 0, v156
    v_sub_f32 v50, 0, v156
    v_sub_f32 v51, 0, v156
    v_sub_f32 v52, 0, v156
    v_sub_f32 v53, 0, v156
    v_sub_f32 v54, 0, v156
    v_sub_f32 v55, 0, v156
    v_sub_f32 v56, 0, v156
    v_sub_f32 v57, 0, v156
    v_sub_f32 v58, 0, v156
    v_sub_f32 v59, 0, v156
    v_sub_f32 v60, 0, v156
    v_sub_f32 v61, 0, v156
    v_sub_f32 v62, 0, v156
    v_sub_f32 v63, 0, v156
    s_nop 1
    v_mfma_f32_32x32x16_bf16 v[0:15], v[80:83], v[128:131], v[48:63]
    v_mfma_f32_32x32x16_bf16 v[0:15], v[84:87], v[132:135], v[0:15]
    ds_read_b128 v[80:83], v137 offset:4096
    ds_read_b128 v[84:87], v137 offset:5120
    s_nop 7
    s_setprio 1
    s_waitcnt lgkmcnt(0)
    s_nop 2
    v_mfma_f32_32x32x16_bf16 v[16:31], v[80:83], v[128:131], v[48:63]
    v_exp_f32 v0, v0
    v_exp_f32 v1, v1
    v_exp_f32 v2, v2
    v_cvt_pk_bf16_f32 v64, v0, v1
    v_exp_f32 v3, v3
    v_mfma_f32_32x32x16_bf16 v[16:31], v[84:87], v[132:135], v[16:31]
    ds_read_b128 v[80:83], v137 offset:8192
    v_exp_f32 v4, v4
    v_exp_f32 v5, v5
    v_cvt_pk_bf16_f32 v65, v2, v3
    v_exp_f32 v6, v6
    v_exp_f32 v7, v7
    ds_read_b128 v[84:87], v137 offset:9216
    v_cvt_pk_bf16_f32 v66, v4, v5
    v_exp_f32 v8, v8
    v_cvt_pk_bf16_f32 v67, v6, v7
    v_exp_f32 v9, v9
    v_exp_f32 v10, v10
    ds_read_b128 v[104:107], v137 offset:10240
    v_exp_f32 v11, v11
    v_cvt_pk_bf16_f32 v68, v8, v9
    v_exp_f32 v12, v12
    v_exp_f32 v13, v13
    v_cvt_pk_bf16_f32 v69, v10, v11
    ds_read_b128 v[108:111], v137 offset:11264
    v_exp_f32 v14, v14
    v_exp_f32 v15, v15
    v_cvt_pk_bf16_f32 v70, v12, v13
    v_cvt_pk_bf16_f32 v71, v14, v15
    s_waitcnt lgkmcnt(2)
    v_mfma_f32_32x32x16_bf16 v[0:15], v[80:83], v[128:131], v[48:63]
    v_exp_f32 v16, v16
    v_exp_f32 v17, v17
    v_exp_f32 v18, v18
    v_cvt_pk_bf16_f32 v72, v16, v17
    v_exp_f32 v19, v19
    v_mfma_f32_32x32x16_bf16 v[0:15], v[84:87], v[132:135], v[0:15]
    ds_read_b128 v[80:83], v137 offset:12288
    v_exp_f32 v20, v20
    v_exp_f32 v21, v21
    v_cvt_pk_bf16_f32 v73, v18, v19
    v_exp_f32 v22, v22
    v_exp_f32 v23, v23
    v_mfma_f32_32x32x16_bf16 v[32:47], v[88:91], v[64:67], v[32:47]
    ds_read_b128 v[84:87], v137 offset:13312
    v_cvt_pk_bf16_f32 v74, v20, v21
    v_exp_f32 v24, v24
    v_cvt_pk_bf16_f32 v75, v22, v23
    v_exp_f32 v25, v25
    v_exp_f32 v26, v26
    v_mfma_f32_32x32x16_bf16 v[32:47], v[92:95], v[68:71], v[32:47]
    ds_read_b128 v[112:115], v137 offset:14336
    v_exp_f32 v27, v27
    v_cvt_pk_bf16_f32 v76, v24, v25
    v_exp_f32 v28, v28
    v_exp_f32 v29, v29
    v_cvt_pk_bf16_f32 v77, v26, v27
    v_smfmac_f32_16x16x64_bf16 v[120:123], v[124:127], v[64:71], v162
    ds_read_b128 v[116:119], v137 offset:15360
    v_exp_f32 v30, v30
    v_exp_f32 v31, v31
    v_cvt_pk_bf16_f32 v78, v28, v29
    v_cvt_pk_bf16_f32 v79, v30, v31
    s_waitcnt lgkmcnt(2)
    v_mfma_f32_32x32x16_bf16 v[16:31], v[80:83], v[128:131], v[48:63]
    v_exp_f32 v0, v0
    v_exp_f32 v1, v1
    v_exp_f32 v2, v2
    v_cvt_pk_bf16_f32 v64, v0, v1
    v_exp_f32 v3, v3
    v_mfma_f32_32x32x16_bf16 v[16:31], v[84:87], v[132:135], v[16:31]
    v_exp_f32 v4, v4
    v_exp_f32 v5, v5
    v_cvt_pk_bf16_f32 v65, v2, v3
    v_exp_f32 v6, v6
    v_exp_f32 v7, v7
    v_mfma_f32_32x32x16_bf16 v[32:47], v[96:99], v[72:75], v[32:47]
    v_cvt_pk_bf16_f32 v66, v4, v5
    v_exp_f32 v8, v8
    v_cvt_pk_bf16_f32 v67, v6, v7
    v_exp_f32 v9, v9
    v_exp_f32 v10, v10
    v_mfma_f32_32x32x16_bf16 v[32:47], v[100:103], v[76:79], v[32:47]
    v_exp_f32 v11, v11
    v_cvt_pk_bf16_f32 v68, v8, v9
    v_exp_f32 v12, v12
    v_exp_f32 v13, v13
    v_cvt_pk_bf16_f32 v69, v10, v11
    v_smfmac_f32_16x16x64_bf16 v[120:123], v[124:127], v[72:79], v162
    v_exp_f32 v14, v14
    v_exp_f32 v15, v15
    v_cvt_pk_bf16_f32 v70, v12, v13
    v_cvt_pk_bf16_f32 v71, v14, v15
    ds_read_b32 v139, v163
    v_exp_f32 v16, v16
    v_exp_f32 v17, v17
    v_exp_f32 v18, v18
    v_cvt_pk_bf16_f32 v72, v16, v17
    v_exp_f32 v19, v19
    v_exp_f32 v20, v20
    v_exp_f32 v21, v21
    v_cvt_pk_bf16_f32 v73, v18, v19
    v_exp_f32 v22, v22
    v_exp_f32 v23, v23
    v_mfma_f32_32x32x16_bf16 v[32:47], v[104:107], v[64:67], v[32:47]
    v_cvt_pk_bf16_f32 v74, v20, v21
    v_exp_f32 v24, v24
    v_cvt_pk_bf16_f32 v75, v22, v23
    v_exp_f32 v25, v25
    v_exp_f32 v26, v26
    v_mfma_f32_32x32x16_bf16 v[32:47], v[108:111], v[68:71], v[32:47]
    v_exp_f32 v27, v27
    v_cvt_pk_bf16_f32 v76, v24, v25
    v_exp_f32 v28, v28
    v_exp_f32 v29, v29
    v_cvt_pk_bf16_f32 v77, v26, v27
    v_smfmac_f32_16x16x64_bf16 v[120:123], v[124:127], v[64:71], v162
    s_add_u32 s75, s75, 16384
    s_and_b32 s75, s75, 131071
    s_add_u32 s79, s79, 1
    v_exp_f32 v30, v30
    v_exp_f32 v31, v31
    v_cvt_pk_bf16_f32 v78, v28, v29
    v_cvt_pk_bf16_f32 v79, v30, v31
    v_add_u32 v137, s75, v165
    v_mov_b32 v154, s79
    s_waitcnt lgkmcnt(0)
    v_readfirstlane_b32 s3, v139
    ds_write_b32 v164, v154
    s_cmp_ge_u32 s3, s79
    s_cbranch_scc0 L_hs_slowB0
L_hs_backB0:
    ds_read_b128 v[80:83], v137 offset:0
    ds_read_b128 v[84:87], v137 offset:1024
    ds_read_b128 v[88:91], v137 offset:2048
    ds_read_b128 v[92:95], v137 offset:3072
    ds_read_b128 v[96:99], v137 offset:6144
    ds_read_b128 v[100:103], v137 offset:7168
    s_waitcnt lgkmcnt(4)
    v_mfma_f32_32x32x16_bf16 v[0:15], v[80:83], v[128:131], v[48:63]
    v_mfma_f32_32x32x16_bf16 v[0:15], v[84:87], v[132:135], v[0:15]
    ds_read_b128 v[80:83], v137 offset:4096
    ds_read_b128 v[84:87], v137 offset:5120
    s_nop 7
    s_waitcnt lgkmcnt(0)
    v_mfma_f32_32x32x16_bf16 v[16:31], v[80:83], v[128:131], v[48:63]
    v_exp_f32 v0, v0
    v_exp_f32 v1, v1
    v_exp_f32 v2, v2
    v_cvt_pk_bf16_f32 v64, v0, v1
    v_exp_f32 v3, v3
    v_mfma_f32_32x32x16_bf16 v[16:31], v[84:87], v[132:135], v[16:31]
    ds_read_b128 v[80:83], v137 offset:8192
    v_exp_f32 v4, v4
    v_exp_f32 v5, v5
    v_cvt_pk_bf16_f32 v65, v2, v3
    v_exp_f32 v6, v6
    v_exp_f32 v7, v7
    v_mfma_f32_32x32x16_bf16 v[32:47], v[112:115], v[72:75], v[32:47]
    ds_read_b128 v[84:87], v137 offset:9216
    v_cvt_pk_bf16_f32 v66, v4, v5
    v_exp_f32 v8, v8
    v_cvt_pk_bf16_f32 v67, v6, v7
    v_exp_f32 v9, v9
    v_exp_f32 v10, v10
    v_mfma_f32_32x32x16_bf16 v[32:47], v[116:119], v[76:79], v[32:47]
    ds_read_b128 v[104:107], v137 offset:10240
    v_exp_f32 v11, v11
    v_cvt_pk_bf16_f32 v68, v8, v9
    v_exp_f32 v12, v12
    v_exp_f32 v13, v13
    v_cvt_pk_bf16_f32 v69, v10, v11
    v_smfmac_f32_16x16x64_bf16 v[120:123], v[124:127], v[72:79], v162
    ds_read_b128 v[108:111], v137 offset:11264
    v_exp_f32 v14, v14
    v_exp_f32 v15, v15
    v_cvt_pk_bf16_f32 v70, v12, v13
    v_cvt_pk_bf16_f32 v71, v14, v15
    s_waitcnt lgkmcnt(2)
    v_mfma_f32_32x32x16_bf16 v[0:15], v[80:83], v[128:131], v[48:63]
    ds_read_b32 v139, v163
    v_exp_f32 v16, v16
    v_exp_f32 v17, v17
    v_exp_f32 v18, v18
    v_cvt_pk_bf16_f32 v72, v16, v17
    v_exp_f32 v19, v19
    v_mfma_f32_32x32x16_bf16 v[0:15], v[84:87], v[132:135], v[0:15]
    ds_read_b128 v[80:83], v137 offset:12288
    v_exp_f32 v20, v20
    v_exp_f32 v21, v21
    v_cvt_pk_bf16_f32 v73, v18, v19
    v_exp_f32 v22, v22
    v_exp_f32 v23, v23
    v_mfma_f32_32x32x16_bf16 v[32:47], v[88:91], v[64:67], v[32:47]
    ds_read_b128 v[84:87], v137 offset:13312
    v_cvt_pk_bf16_f32 v74, v20, v21
    v_exp_f32 v24, v24
    v_cvt_pk_bf16_f32 v75, v22, v23
    v_exp_f32 v25, v25
    v_exp_f32 v26, v26
    v_mfma_f32_32x32x16_bf16 v[32:47], v[92:95], v[68:71], v[32:47]
    ds_read_b128 v[112:115], v137 offset:14336
    v_exp_f32 v27, v27
    v_cvt_pk_bf16_f32 v76, v24, v25
    v_exp_f32 v28, v28
    v_exp_f32 v29, v29
    v_cvt_pk_bf16_f32 v77, v26, v27
    v_smfmac_f32_16x16x64_bf16 v[120:123], v[124:127], v[64:71], v162
    ds_read_b128 v[116:119], v137 offset:15360
    s_add_u32 s75, s75, 16384
    s_and_b32 s75, s75, 131071
    s_add_u32 s79, s79, 1
    v_exp_f32 v30, v30
    v_exp_f32 v31, v31
    v_cvt_pk_bf16_f32 v78, v28, v29
    v_cvt_pk_bf16_f32 v79, v30, v31
    v_add_u32 v137, s75, v165
    v_mov_b32 v154, s79
    s_waitcnt lgkmcnt(0)
    v_readfirstlane_b32 s3, v139
    ds_write_b32 v164, v154
    s_cmp_ge_u32 s3, s79
    s_cbranch_scc0 L_hs_slowB1
L_hs_backB1:
.p2align 6
L_attloopB:
    v_mfma_f32_32x32x16_bf16 v[16:31], v[80:83], v[128:131], v[48:63]
    v_exp_f32 v0, v0
    v_exp_f32 v1, v1
    v_exp_f32 v2, v2
    v_cvt_pk_bf16_f32 v64, v0, v1
    v_exp_f32 v3, v3
    v_mfma_f32_32x32x16_bf16 v[16:31], v[84:87], v[132:135], v[16:31]
    ds_read_b128 v[80:83], v137 offset:0
    v_exp_f32 v4, v4
    v_exp_f32 v5, v5
    v_cvt_pk_bf16_f32 v65, v2, v3
    v_exp_f32 v6, v6
    v_exp_f32 v7, v7
    v_mfma_f32_32x32x16_bf16 v[32:47], v[96:99], v[72:75], v[32:47]
    ds_read_b128 v[84:87], v137 offset:1024
    v_cvt_pk_bf16_f32 v66, v4, v5
    v_exp_f32 v8, v8
    v_cvt_pk_bf16_f32 v67, v6, v7
    v_exp_f32 v9, v9
    v_exp_f32 v10, v10
    v_mfma_f32_32x32x16_bf16 v[32:47], v[100:103], v[76:79], v[32:47]
    ds_read_b128 v[88:91], v137 offset:2048
    v_exp_f32 v11, v11
    v_cvt_pk_bf16_f32 v68, v8, v9
    v_exp_f32 v12, v12
    v_exp_f32 v13, v13
    v_cvt_pk_bf16_f32 v69, v10, v11
    v_smfmac_f32_16x16x64_bf16 v[120:123], v[124:127], v[72:79], v162
    ds_read_b128 v[92:95], v137 offset:3072
    v_exp_f32 v14, v14
    v_exp_f32 v15, v15
    v_cvt_pk_bf16_f32 v70, v12, v13
    v_cvt_pk_bf16_f32 v71, v14, v15
    s_waitcnt lgkmcnt(2)
    v_mfma_f32_32x32x16_bf16 v[0:15], v[80:83], v[128:131], v[48:63]
    v_exp_f32 v16, v16
    v_exp_f32 v17, v17
    v_exp_f32 v18, v18
    v_cvt_pk_bf16_f32 v72, v16, v17
    v_exp_f32 v19, v19
    v_mfma_f32_32x32x16_bf16 v[0:15], v[84:87], v[132:135], v[0:15]
    ds_read_b128 v[80:83], v137 offset:4096
    v_exp_f32 v20, v20
    v_exp_f32 v21, v21
    v_cvt_pk_bf16_f32 v73, v18, v19
    v_exp_f32 v22, v22
    v_exp_f32 v23, v23
    v_mfma_f32_32x32x16_bf16 v[32:47], v[104:107], v[64:67], v[32:47]
    ds_read_b128 v[84:87], v137 offset:5120
    v_cvt_pk_bf16_f32 v74, v20, v21
    v_exp_f32 v24, v24
    v_cvt_pk_bf16_f32 v75, v22, v23
    v_exp_f32 v25, v25
    v_exp_f32 v26, v26
    v_mfma_f32_32x32x16_bf16 v[32:47], v[108:111], v[68:71], v[32:47]
    ds_read_b128 v[96:99], v137 offset:6144
    v_exp_f32 v27, v27
    v_cvt_pk_bf16_f32 v76, v24, v25
    v_exp_f32 v28, v28
    v_exp_f32 v29, v29
    v_cvt_pk_bf16_f32 v77, v26, v27
    v_smfmac_f32_16x16x64_bf16 v[120:123], v[124:127], v[64:71], v162
    ds_read_b128 v[100:103], v137 offset:7168
    v_exp_f32 v30, v30
    v_exp_f32 v31, v31
    v_cvt_pk_bf16_f32 v78, v28, v29
    v_cvt_pk_bf16_f32 v79, v30, v31
    s_waitcnt lgkmcnt(2)
    v_mfma_f32_32x32x16_bf16 v[16:31], v[80:83], v[128:131], v[48:63]
    v_exp_f32 v0, v0
    v_exp_f32 v1, v1
    v_exp_f32 v2, v2
    v_cvt_pk_bf16_f32 v64, v0, v1
    v_exp_f32 v3, v3
    v_mfma_f32_32x32x16_bf16 v[16:31], v[84:87], v[132:135], v[16:31]
    ds_read_b128 v[80:83], v137 offset:8192
    v_exp_f32 v4, v4
    v_exp_f32 v5, v5
    v_cvt_pk_bf16_f32 v65, v2, v3
    v_exp_f32 v6, v6
    v_exp_f32 v7, v7
    v_mfma_f32_32x32x16_bf16 v[32:47], v[112:115], v[72:75], v[32:47]
    ds_read_b128 v[84:87], v137 offset:9216
    v_cvt_pk_bf16_f32 v66, v4, v5
    v_exp_f32 v8, v8
    v_cvt_pk_bf16_f32 v67, v6, v7
    v_exp_f32 v9, v9
    v_exp_f32 v10, v10
    v_mfma_f32_32x32x16_bf16 v[32:47], v[116:119], v[76:79], v[32:47]
    ds_read_b128 v[104:107], v137 offset:10240
    v_exp_f32 v11, v11
    v_cvt_pk_bf16_f32 v68, v8, v9
    v_exp_f32 v12, v12
    v_exp_f32 v13, v13
    v_cvt_pk_bf16_f32 v69, v10, v11
    v_smfmac_f32_16x16x64_bf16 v[120:123], v[124:127], v[72:79], v162
    ds_read_b128 v[108:111], v137 offset:11264
    v_exp_f32 v14, v14
    v_exp_f32 v15, v15
    v_cvt_pk_bf16_f32 v70, v12, v13
    v_cvt_pk_bf16_f32 v71, v14, v15
    s_waitcnt lgkmcnt(2)
    v_mfma_f32_32x32x16_bf16 v[0:15], v[80:83], v[128:131], v[48:63]
    ds_read_b32 v139, v163
    v_exp_f32 v16, v16
    v_exp_f32 v17, v17
    v_exp_f32 v18, v18
    v_cvt_pk_bf16_f32 v72, v16, v17
    v_exp_f32 v19, v19
    v_mfma_f32_32x32x16_bf16 v[0:15], v[84:87], v[132:135], v[0:15]
    ds_read_b128 v[80:83], v137 offset:12288
    v_exp_f32 v20, v20
    v_exp_f32 v21, v21
    v_cvt_pk_bf16_f32 v73, v18, v19
    v_exp_f32 v22, v22
    v_exp_f32 v23, v23
    v_mfma_f32_32x32x16_bf16 v[32:47], v[88:91], v[64:67], v[32:47]
    ds_read_b128 v[84:87], v137 offset:13312
    v_cvt_pk_bf16_f32 v74, v20, v21
    v_exp_f32 v24, v24
    v_cvt_pk_bf16_f32 v75, v22, v23
    v_exp_f32 v25, v25
    v_exp_f32 v26, v26
    v_mfma_f32_32x32x16_bf16 v[32:47], v[92:95], v[68:71], v[32:47]
    ds_read_b128 v[112:115], v137 offset:14336
    v_exp_f32 v27, v27
    v_cvt_pk_bf16_f32 v76, v24, v25
    v_exp_f32 v28, v28
    v_exp_f32 v29, v29
    v_cvt_pk_bf16_f32 v77, v26, v27
    v_smfmac_f32_16x16x64_bf16 v[120:123], v[124:127], v[64:71], v162
    ds_read_b128 v[116:119], v137 offset:15360
    s_add_u32 s75, s75, 16384
    s_and_b32 s75, s75, 131071
    s_add_u32 s79, s79, 1
    v_exp_f32 v30, v30
    v_exp_f32 v31, v31
    v_cvt_pk_bf16_f32 v78, v28, v29
    v_cvt_pk_bf16_f32 v79, v30, v31
    v_add_u32 v137, s75, v165
    v_mov_b32 v154, s79
    s_waitcnt lgkmcnt(0)
    v_readfirstlane_b32 s3, v139
    ds_write_b32 v164, v154
    s_cmp_ge_u32 s3, s79
    s_cbranch_scc0 L_hs_slowB2
L_hs_backB2:
    s_cmp_eq_u32 s79, 10
    s_cbranch_scc1 L_opsB
    s_cmp_lt_u32 s79, 16
    s_cbranch_scc1 L_attloopB
    v_mfma_f32_32x32x16_bf16 v[16:31], v[80:83], v[128:131], v[48:63]
    v_exp_f32 v0, v0
    v_exp_f32 v1, v1
    v_exp_f32 v2, v2
    v_cvt_pk_bf16_f32 v64, v0, v1
    v_exp_f32 v3, v3
    v_mfma_f32_32x32x16_bf16 v[16:31], v[84:87], v[132:135], v[16:31]
    v_exp_f32 v4, v4
    v_exp_f32 v5, v5
    v_cvt_pk_bf16_f32 v65, v2, v3
    v_exp_f32 v6, v6
    v_exp_f32 v7, v7
    v_mfma_f32_32x32x16_bf16 v[32:47], v[96:99], v[72:75], v[32:47]
    v_cvt_pk_bf16_f32 v66, v4, v5
    v_exp_f32 v8, v8
    v_cvt_pk_bf16_f32 v67, v6, v7
    v_exp_f32 v9, v9
    v_exp_f32 v10, v10
    v_mfma_f32_32x32x16_bf16 v[32:47], v[100:103], v[76:79], v[32:47]
    v_exp_f32 v11, v11
    v_cvt_pk_bf16_f32 v68, v8, v9
    v_exp_f32 v12, v12
    v_exp_f32 v13, v13
    v_cvt_pk_bf16_f32 v69, v10, v11
    v_smfmac_f32_16x16x64_bf16 v[120:123], v[124:127], v[72:79], v162
    v_exp_f32 v14, v14
    v_exp_f32 v15, v15
    v_cvt_pk_bf16_f32 v70, v12, v13
    v_cvt_pk_bf16_f32 v71, v14, v15
    v_exp_f32 v16, v16
    v_exp_f32 v17, v17
    v_exp_f32 v18, v18
    v_cvt_pk_bf16_f32 v72, v16, v17
    v_exp_f32 v19, v19
    v_exp_f32 v20, v20
    v_exp_f32 v21, v21
    v_cvt_pk_bf16_f32 v73, v18, v19
    v_exp_f32 v22, v22
    v_exp_f32 v23, v23
    v_mfma_f32_32x32x16_bf16 v[32:47], v[104:107], v[64:67], v[32:47]
    v_cvt_pk_bf16_f32 v74, v20, v21
    v_exp_f32 v24, v24
    v_cvt_pk_bf16_f32 v75, v22, v23
    v_exp_f32 v25, v25
    v_exp_f32 v26, v26
    v_mfma_f32_32x32x16_bf16 v[32:47], v[108:111], v[68:71], v[32:47]
    v_exp_f32 v27, v27
    v_cvt_pk_bf16_f32 v76, v24, v25
    v_exp_f32 v28, v28
    v_exp_f32 v29, v29
    v_cvt_pk_bf16_f32 v77, v26, v27
    v_smfmac_f32_16x16x64_bf16 v[120:123], v[124:127], v[64:71], v162
    v_exp_f32 v30, v30
    v_exp_f32 v31, v31
    v_cvt_pk_bf16_f32 v78, v28, v29
    v_cvt_pk_bf16_f32 v79, v30, v31
    s_nop 1
    v_mfma_f32_32x32x16_bf16 v[32:47], v[112:115], v[72:75], v[32:47]
    v_mfma_f32_32x32x16_bf16 v[32:47], v[116:119], v[76:79], v[32:47]
    v_smfmac_f32_16x16x64_bf16 v[120:123], v[124:127], v[72:79], v162
L_att_tail:
    s_setprio 0
    s_lshr_b32 s4, s64, 2
    s_xor_b32 s89, s65, s4
    s_lshl_b32 s3, s89, 2
    s_and_b32 s4, s64, 3
    s_add_u32 s3, s3, s4
    s_lshl_b32 s3, s3, 16
    s_lshl_b32 s4, s66, 1
    s_add_u32 s90, s4, s67
    s_lshl_b32 s4, s90, 11
    s_add_u32 s3, s3, s4
    s_add_u32 s88, s3, 8388608
    v_mov_b32 v118, 155712
    ds_read_b64 v[116:117], v118
    s_waitcnt vmcnt(0)
    s_nop 4
L_att_fin:
    v_add_f32 v120, v120, v121
    v_mov_b32 v156, 0x53800000
    v_cmp_nlt_f32 vcc, v120, v156
    v_rcp_f32 v122, v120
    s_nop 3
    s_cbranch_vccnz L_fallback
L_att_ok:
    v_mul_f32 v32, v122, v32
    v_mul_f32 v33, v122, v33
    v_mul_f32 v34, v122, v34
    v_mul_f32 v35, v122, v35
    v_mul_f32 v36, v122, v36
    v_mul_f32 v37, v122, v37
    v_mul_f32 v38, v122, v38
    v_mul_f32 v39, v122, v39
    v_cvt_pk_bf16_f32 v64, v32, v33
    v_cvt_pk_bf16_f32 v65, v34, v35
    v_cvt_pk_bf16_f32 v66, v36, v37
    v_cvt_pk_bf16_f32 v67, v38, v39
    buffer_store_dwordx4 v[64:67], v165, s[48:51], s88 offen offset:0 sc1
    v_mul_f32 v40, v122, v40
    v_mul_f32 v41, v122, v41
    v_mul_f32 v42, v122, v42
    v_mul_f32 v43, v122, v43
    v_mul_f32 v44, v122, v44
    v_mul_f32 v45, v122, v45
    v_mul_f32 v46, v122, v46
    v_mul_f32 v47, v122, v47
    v_cvt_pk_bf16_f32 v68, v40, v41
    v_cvt_pk_bf16_f32 v69, v42, v43
    v_cvt_pk_bf16_f32 v70, v44, v45
    v_cvt_pk_bf16_f32 v71, v46, v47
    buffer_store_dwordx4 v[68:71], v165, s[48:51], s88 offen offset:1024 sc1
    s_mov_b32 s74, 0
    s_mov_b32 s75, 0
    s_lshr_b32 s76, s85, 1
    s_lshr_b32 s81, s64, 2
    s_lshl_b32 s81, s81, 3
    s_waitcnt lgkmcnt(0)
    v_mov_b32 v120, v116
    v_mov_b32 v121, v117
    s_nop 0
    v_readfirstlane_b32 s3, v120
    v_readfirstlane_b32 s4, v121
    s_nop 1
    s_and_b32 s3, s3, s4
    s_lshr_b32 s3, s3, s81
    s_and_b32 s3, s3, 0xff
    s_or_b32 s74, s74, s3
    s_andn2_b32 s3, s74, s75
    s_mov_b32 s3, 0x7f000000
    s_cbranch_scc0 L_early_145
    s_andn2_b32 s3, s74, s75
    s_lshl_b32 s4, s3, 8
    s_or_b32 s3, s3, s4
    s_lshr_b32 s3, s3, s76
    s_ff1_i32_b32 s3, s3
    s_add_u32 s3, s3, s76
    s_and_b32 s79, s3, 7
    s_bitset1_b32 s75, s79
    s_lshl_b32 s3, s79, 12
    s_add_u32 s3, s3, s86
L_early_145:
    buffer_load_dwordx4 v[32:35], v165, s[48:51], s3 offen offset:0 sc1
    buffer_load_dwordx4 v[36:39], v165, s[48:51], s3 offen offset:1024 sc1
    buffer_load_dwordx4 v[40:43], v165, s[48:51], s3 offen offset:2048 sc1
    buffer_load_dwordx4 v[44:47], v165, s[48:51], s3 offen offset:3072 sc1
    s_mov_b32 s60, s34
    s_and_b32 s61, s35, 0xffff
    s_mov_b32 s62, 4194304
    s_mov_b32 s63, 0x20000
    v_bfe_u32 v114, v166, 2, 2
    v_lshl_add_u32 v114, v151, 2, v114
    v_lshlrev_b32 v114, 7, v114
    v_and_b32 v115, 3, v166
    v_lshl_add_u32 v114, v115, 3, v114
    v_bfe_u32 v115, v166, 4, 1
    v_lshl_add_u32 v114, v115, 5, v114
    s_lshr_b32 s4, s64, 2
    v_bfe_u32 v115, v166, 3, 1
    v_xor_b32 v115, s4, v115
    v_lshl_add_u32 v112, v115, 6, v114
    s_lshl_b32 s5, s4, 16
    v_add_u32 v112, s5, v112
    v_xor_b32 v113, 64, v112
    s_waitcnt vmcnt(4)
    s_and_b32 s3, s64, 4
    s_add_u32 s3, s3, 155696
    v_mov_b32 v14, s3
    v_mov_b32 v15, 1
    s_mov_b64 exec, 1
    ds_add_rtn_u32 v16, v14, v15
    s_waitcnt lgkmcnt(0)
    s_mov_b64 exec, -1
    v_readfirstlane_b32 s3, v16
    s_nop 1
    s_cmp_lg_u32 s3, 3
    s_cbranch_scc1 L_last_146
    s_lshl_b32 s3, s89, 5
    s_add_u32 s3, s3, s90
    s_lshl_b32 s3, s3, 2
    s_add_u32 s3, s3, 12978176
    v_mov_b32 v14, 0
    v_mov_b32 v15, s15
    s_mov_b64 exec, 1
    buffer_store_dword v15, v14, s[48:51], s3 offen sc1
    s_mov_b64 exec, -1
L_last_146:
L_p3:
    s_cmp_lg_u32 s75, 0
    s_cbranch_scc1 L_haveit_147
    s_mov_b32 s96, 4194304
L_poll_148:
    ds_read_b64 v[120:121], v118
    s_waitcnt lgkmcnt(0)
    v_readfirstlane_b32 s3, v120
    v_readfirstlane_b32 s4, v121
    s_nop 1
    s_and_b32 s3, s3, s4
    s_lshr_b32 s3, s3, s81
    s_and_b32 s3, s3, 0xff
    s_or_b32 s74, s74, s3
    s_andn2_b32 s3, s74, s75
    s_cbranch_scc1 L_polld_149
    s_sub_u32 s96, s96, 1
    s_cmp_eq_u32 s96, 0
    s_cselect_b32 s74, 0xff, s74
    s_cbranch_scc1 L_polld_149
    s_sleep 1
    s_branch L_poll_148
L_polld_149:
    s_andn2_b32 s3, s74, s75
    s_lshl_b32 s4, s3, 8
    s_or_b32 s3, s3, s4
    s_lshr_b32 s3, s3, s76
    s_ff1_i32_b32 s3, s3
    s_add_u32 s3, s3, s76
    s_and_b32 s79, s3, 7
    s_bitset1_b32 s75, s79
    s_lshl_b32 s3, s79, 12
    s_add_u32 s3, s3, s86
    buffer_load_dwordx4 v[32:35], v165, s[48:51], s3 offen offset:0 sc1
    buffer_load_dwordx4 v[36:39], v165, s[48:51], s3 offen offset:1024 sc1
    buffer_load_dwordx4 v[40:43], v165, s[48:51], s3 offen offset:2048 sc1
    buffer_load_dwordx4 v[44:47], v165, s[48:51], s3 offen offset:3072 sc1
L_haveit_147:
    ds_read_b64 v[120:121], v118
    s_waitcnt lgkmcnt(0)
    v_readfirstlane_b32 s3, v120
    v_readfirstlane_b32 s4, v121
    s_nop 1
    s_and_b32 s3, s3, s4
    s_lshr_b32 s3, s3, s81
    s_and_b32 s3, s3, 0xff
    s_or_b32 s74, s74, s3
    s_andn2_b32 s3, s74, s75
    s_cbranch_scc0 L_pb_150
    s_andn2_b32 s3, s74, s75
    s_lshl_b32 s4, s3, 8
    s_or_b32 s3, s3, s4
    s_lshr_b32 s3, s3, s76
    s_ff1_i32_b32 s3, s3
    s_add_u32 s3, s3, s76
    s_and_b32 s80, s3, 7
    s_bitset1_b32 s75, s80
    s_lshl_b32 s3, s80, 12
    s_add_u32 s3, s3, s86
    buffer_load_dwordx4 v[48:51], v165, s[48:51], s3 offen offset:0 sc1
    buffer_load_dwordx4 v[52:55], v165, s[48:51], s3 offen offset:1024 sc1
    buffer_load_dwordx4 v[56:59], v165, s[48:51], s3 offen offset:2048 sc1
    buffer_load_dwordx4 v[60:63], v165, s[48:51], s3 offen offset:3072 sc1
    s_lshl_b32 s3, s79, 13
    v_add_u32 v116, s3, v112
    v_add_u32 v117, s3, v113
    ds_read_b64_tr_b16 v[64:65], v116 offset:0
    ds_read_b64_tr_b16 v[66:67], v116 offset:1024
    ds_read_b64_tr_b16 v[68:69], v117 offset:0
    ds_read_b64_tr_b16 v[70:71], v117 offset:1024
    ds_read_b64_tr_b16 v[72:73], v116 offset:2048
    ds_read_b64_tr_b16 v[74:75], v116 offset:3072
    ds_read_b64_tr_b16 v[76:77], v117 offset:2048
    ds_read_b64_tr_b16 v[78:79], v117 offset:3072
    s_waitcnt vmcnt(7) lgkmcnt(4)
    v_mfma_f32_32x32x16_bf16 v[0:15], v[64:67], v[32:35], 0
    v_mfma_f32_32x32x16_bf16 v[16:31], v[68:71], v[32:35], 0
    ds_read_b64_tr_b16 v[64:65], v116 offset:4096
    ds_read_b64_tr_b16 v[66:67], v116 offset:5120
    ds_read_b64_tr_b16 v[68:69], v117 offset:4096
    ds_read_b64_tr_b16 v[70:71], v117 offset:5120
    s_waitcnt vmcnt(6) lgkmcnt(4)
    v_mfma_f32_32x32x16_bf16 v[0:15], v[72:75], v[36:39], v[0:15]
    v_mfma_f32_32x32x16_bf16 v[16:31], v[76:79], v[36:39], v[16:31]
    ds_read_b64 v[120:121], v118
    ds_read_b64_tr_b16 v[72:73], v116 offset:6144
    ds_read_b64_tr_b16 v[74:75], v116 offset:7168
    ds_read_b64_tr_b16 v[76:77], v117 offset:6144
    ds_read_b64_tr_b16 v[78:79], v117 offset:7168
    s_waitcnt vmcnt(5) lgkmcnt(4)
    v_mfma_f32_32x32x16_bf16 v[0:15], v[64:67], v[40:43], v[0:15]
    v_mfma_f32_32x32x16_bf16 v[16:31], v[68:71], v[40:43], v[16:31]
    s_waitcnt vmcnt(4) lgkmcnt(0)
    v_mfma_f32_32x32x16_bf16 v[0:15], v[72:75], v[44:47], v[0:15]
    v_mfma_f32_32x32x16_bf16 v[16:31], v[76:79], v[44:47], v[16:31]
    v_mov_b32 v119, 155676
    ds_read_b32 v119, v119
    s_waitcnt lgkmcnt(0)
    v_readfirstlane_b32 s71, v119
    v_permlane32_swap_b32 v140, v142
    v_permlane32_swap_b32 v141, v143
    v_permlane32_swap_b32 v144, v146
    v_permlane32_swap_b32 v145, v147
    s_and_b32 s3, s71, 2047
    s_sub_u32 s70, 2047, s3
    v_sub_f32 v115, 1.0, v148
    v_cvt_pk_bf16_f32 v115, v115, v115
    v_lshlrev_b32 v115, 16, v115
    v_lshlrev_b32 v80, 16, v140
    v_and_b32 v81, 0xffff0000, v140
    v_lshlrev_b32 v82, 16, v141
    v_and_b32 v83, 0xffff0000, v141
    v_lshlrev_b32 v84, 16, v142
    v_and_b32 v85, 0xffff0000, v142
    v_lshlrev_b32 v86, 16, v143
    v_and_b32 v87, 0xffff0000, v143
    v_lshlrev_b32 v88, 16, v144
    v_and_b32 v89, 0xffff0000, v144
    v_lshlrev_b32 v90, 16, v145
    v_and_b32 v91, 0xffff0000, v145
    v_lshlrev_b32 v92, 16, v146
    v_and_b32 v93, 0xffff0000, v146
    v_lshlrev_b32 v94, 16, v147
    v_and_b32 v95, 0xffff0000, v147
    s_lshr_b32 s3, s70, 5
    s_cmp_lg_u32 s3, s87
    s_cbranch_scc1 L_nomoe_152
    v_and_b32 v152, 31, v166
    v_lshlrev_b32 v152, 3, v152
    v_lshl_add_u32 v152, v151, 16, v152
    s_lshr_b32 s4, s64, 2
    s_lshl_b32 s4, s4, 8
    s_lshl_b32 s5, s85, 9
    s_add_u32 s4, s4, s5
    s_add_u32 s6, s4, 12845056
    s_mov_b32 s96, 65536
L_poll_153:
    s_mov_b32 s4, s6
    buffer_load_dwordx2 v[96:97], v152, s[48:51], s4 offen sc1
    s_add_u32 s4, s4, 8192
    buffer_load_dwordx2 v[98:99], v152, s[48:51], s4 offen sc1
    s_add_u32 s4, s4, 8192
    buffer_load_dwordx2 v[100:101], v152, s[48:51], s4 offen sc1
    s_add_u32 s4, s4, 8192
    buffer_load_dwordx2 v[102:103], v152, s[48:51], s4 offen sc1
    s_add_u32 s4, s4, 8192
    buffer_load_dwordx2 v[104:105], v152, s[48:51], s4 offen sc1
    s_add_u32 s4, s4, 8192
    buffer_load_dwordx2 v[106:107], v152, s[48:51], s4 offen sc1
    s_add_u32 s4, s4, 8192
    buffer_load_dwordx2 v[108:109], v152, s[48:51], s4 offen sc1
    s_add_u32 s4, s4, 8192
    buffer_load_dwordx2 v[110:111], v152, s[48:51], s4 offen sc1
    s_add_u32 s4, s4, 8192
    s_waitcnt vmcnt(0)
    v_xor_b32 v153, s15, v97
    v_xor_b32 v154, s15, v99
    v_or_b32 v153, v153, v154
    v_xor_b32 v154, s15, v101
    v_or_b32 v153, v153, v154
    v_xor_b32 v154, s15, v103
    v_or_b32 v153, v153, v154
    v_xor_b32 v154, s15, v105
    v_or_b32 v153, v153, v154
    v_xor_b32 v154, s15, v107
    v_or_b32 v153, v153, v154
    v_xor_b32 v154, s15, v109
    v_or_b32 v153, v153, v154
    v_xor_b32 v154, s15, v111
    v_or_b32 v153, v153, v154
    v_cmp_ne_u32 vcc, 0, v153
    s_sub_u32 s96, s96, 1
    s_cmp_eq_u32 s96, 0
    s_cbranch_scc1 L_polld_154
    s_nop 2
    s_cbranch_vccz L_polld_154
    s_sleep 4
    s_branch L_poll_153
L_polld_154:
    s_and_b32 s3, s71, 0xffff0000
    s_bitcmp1_b32 s3, 31
    s_mov_b32 s4, 0xffff0000
    s_cselect_b32 s4, 0x80000000, s4
    s_xor_b32 s3, s3, s4
    v_mov_b32 v158, 0xbfb8aa3b
    v_mul_f32 v158, s3, v158
    v_exp_f32 v158, v158
    s_nop 0
    v_add_f32 v158, 1.0, v158
    v_rcp_f32 v158, v158
    s_nop 0
    v_cvt_pk_bf16_f32 v158, v158, v158
    v_lshlrev_b32 v158, 16, v158
    v_add_f32 v156, v96, v98
    v_add_f32 v156, v156, v100
    v_add_f32 v156, v156, v102
    v_add_f32 v156, v156, v104
    v_add_f32 v156, v156, v106
    v_add_f32 v156, v156, v108
    v_add_f32 v156, v156, v110
    v_mov_b32 v157, v156
    s_nop 1
    v_permlane32_swap_b32 v156, v157
    s_nop 1
    v_add_f32 v156, v156, v157
    v_cvt_pk_bf16_f32 v156, v156, v156
    v_lshlrev_b32 v156, 16, v156
    v_mul_f32 v156, v156, v158
    v_cvt_pk_bf16_f32 v156, v156, v156
    v_lshlrev_b32 v156, 16, v156
    v_lshlrev_b32 v157, 4, v151
    ds_bpermute_b32 v122, v157, v156 offset:0
    ds_bpermute_b32 v123, v157, v156 offset:4
    ds_bpermute_b32 v124, v157, v156 offset:8
    ds_bpermute_b32 v125, v157, v156 offset:12
    ds_bpermute_b32 v126, v157, v156 offset:32
    ds_bpermute_b32 v127, v157, v156 offset:36
    ds_bpermute_b32 v128, v157, v156 offset:40
    ds_bpermute_b32 v129, v157, v156 offset:44
    s_waitcnt lgkmcnt(0)
    ds_bpermute_b32 v130, v157, v156 offset:64
    ds_bpermute_b32 v131, v157, v156 offset:68
    ds_bpermute_b32 v132, v157, v156 offset:72
    ds_bpermute_b32 v133, v157, v156 offset:76
    ds_bpermute_b32 v134, v157, v156 offset:96
    ds_bpermute_b32 v135, v157, v156 offset:100
    ds_bpermute_b32 v136, v157, v156 offset:104
    ds_bpermute_b32 v137, v157, v156 offset:108
    v_cmp_eq_u32 vcc, s70, v150
    s_waitcnt lgkmcnt(0)
    s_nop 0
    v_cndmask_b32 v122, 0, v122, vcc
    v_cndmask_b32 v123, 0, v123, vcc
    v_cndmask_b32 v124, 0, v124, vcc
    v_cndmask_b32 v125, 0, v125, vcc
    v_cndmask_b32 v126, 0, v126, vcc
    v_cndmask_b32 v127, 0, v127, vcc
    v_cndmask_b32 v128, 0, v128, vcc
    v_cndmask_b32 v129, 0, v129, vcc
    v_cndmask_b32 v130, 0, v130, vcc
    v_cndmask_b32 v131, 0, v131, vcc
    v_cndmask_b32 v132, 0, v132, vcc
    v_cndmask_b32 v133, 0, v133, vcc
    v_cndmask_b32 v134, 0, v134, vcc
    v_cndmask_b32 v135, 0, v135, vcc
    v_cndmask_b32 v136, 0, v136, vcc
    v_cndmask_b32 v137, 0, v137, vcc
    v_add_f32 v80, v80, v122
    v_add_f32 v81, v81, v123
    v_add_f32 v82, v82, v124
    v_add_f32 v83, v83, v125
    v_add_f32 v84, v84, v126
    v_add_f32 v85, v85, v127
    v_add_f32 v86, v86, v128
    v_add_f32 v87, v87, v129
    v_add_f32 v88, v88, v130
    v_add_f32 v89, v89, v131
    v_add_f32 v90, v90, v132
    v_add_f32 v91, v91, v133
    v_add_f32 v92, v92, v134
    v_add_f32 v93, v93, v135
    v_add_f32 v94, v94, v136
    v_add_f32 v95, v95, v137
L_nomoe_152:
    v_mul_f32 v80, v115, v80
    v_mul_f32 v81, v115, v81
    v_mul_f32 v82, v115, v82
    v_mul_f32 v83, v115, v83
    v_mul_f32 v84, v115, v84
    v_mul_f32 v85, v115, v85
    v_mul_f32 v86, v115, v86
    v_mul_f32 v87, v115, v87
    v_mul_f32 v88, v115, v88
    v_mul_f32 v89, v115, v89
    v_mul_f32 v90, v115, v90
    v_mul_f32 v91, v115, v91
    v_mul_f32 v92, v115, v92
    v_mul_f32 v93, v115, v93
    v_mul_f32 v94, v115, v94
    v_mul_f32 v95, v115, v95
    s_branch L_pj_151
L_pb_150:
    s_lshl_b32 s3, s79, 13
    v_add_u32 v116, s3, v112
    v_add_u32 v117, s3, v113
    ds_read_b64_tr_b16 v[64:65], v116 offset:0
    ds_read_b64_tr_b16 v[66:67], v116 offset:1024
    ds_read_b64_tr_b16 v[68:69], v117 offset:0
    ds_read_b64_tr_b16 v[70:71], v117 offset:1024
    ds_read_b64_tr_b16 v[72:73], v116 offset:2048
    ds_read_b64_tr_b16 v[74:75], v116 offset:3072
    ds_read_b64_tr_b16 v[76:77], v117 offset:2048
    ds_read_b64_tr_b16 v[78:79], v117 offset:3072
    s_waitcnt vmcnt(3) lgkmcnt(4)
    v_mfma_f32_32x32x16_bf16 v[0:15], v[64:67], v[32:35], 0
    v_mfma_f32_32x32x16_bf16 v[16:31], v[68:71], v[32:35], 0
    ds_read_b64_tr_b16 v[64:65], v116 offset:4096
    ds_read_b64_tr_b16 v[66:67], v116 offset:5120
    ds_read_b64_tr_b16 v[68:69], v117 offset:4096
    ds_read_b64_tr_b16 v[70:71], v117 offset:5120
    s_waitcnt vmcnt(2) lgkmcnt(4)
    v_mfma_f32_32x32x16_bf16 v[0:15], v[72:75], v[36:39], v[0:15]
    v_mfma_f32_32x32x16_bf16 v[16:31], v[76:79], v[36:39], v[16:31]
    ds_read_b64 v[120:121], v118
    ds_read_b64_tr_b16 v[72:73], v116 offset:6144
    ds_read_b64_tr_b16 v[74:75], v116 offset:7168
    ds_read_b64_tr_b16 v[76:77], v117 offset:6144
    ds_read_b64_tr_b16 v[78:79], v117 offset:7168
    s_waitcnt vmcnt(1) lgkmcnt(4)
    v_mfma_f32_32x32x16_bf16 v[0:15], v[64:67], v[40:43], v[0:15]
    v_mfma_f32_32x32x16_bf16 v[16:31], v[68:71], v[40:43], v[16:31]
    s_waitcnt vmcnt(0) lgkmcnt(0)
    v_mfma_f32_32x32x16_bf16 v[0:15], v[72:75], v[44:47], v[0:15]
    v_mfma_f32_32x32x16_bf16 v[16:31], v[76:79], v[44:47], v[16:31]
    v_mov_b32 v119, 155676
    ds_read_b32 v119, v119
    s_waitcnt lgkmcnt(0)
    v_readfirstlane_b32 s71, v119
    v_permlane32_swap_b32 v140, v142
    v_permlane32_swap_b32 v141, v143
    v_permlane32_swap_b32 v144, v146
    v_permlane32_swap_b32 v145, v147
    s_and_b32 s3, s71, 2047
    s_sub_u32 s70, 2047, s3
    v_sub_f32 v115, 1.0, v148
    v_cvt_pk_bf16_f32 v115, v115, v115
    v_lshlrev_b32 v115, 16, v115
    v_lshlrev_b32 v80, 16, v140
    v_and_b32 v81, 0xffff0000, v140
    v_lshlrev_b32 v82, 16, v141
    v_and_b32 v83, 0xffff0000, v141
    v_lshlrev_b32 v84, 16, v142
    v_and_b32 v85, 0xffff0000, v142
    v_lshlrev_b32 v86, 16, v143
    v_and_b32 v87, 0xffff0000, v143
    v_lshlrev_b32 v88, 16, v144
    v_and_b32 v89, 0xffff0000, v144
    v_lshlrev_b32 v90, 16, v145
    v_and_b32 v91, 0xffff0000, v145
    v_lshlrev_b32 v92, 16, v146
    v_and_b32 v93, 0xffff0000, v146
    v_lshlrev_b32 v94, 16, v147
    v_and_b32 v95, 0xffff0000, v147
    s_lshr_b32 s3, s70, 5
    s_cmp_lg_u32 s3, s87
    s_cbranch_scc1 L_nomoe_155
    v_and_b32 v152, 31, v166
    v_lshlrev_b32 v152, 3, v152
    v_lshl_add_u32 v152, v151, 16, v152
    s_lshr_b32 s4, s64, 2
    s_lshl_b32 s4, s4, 8
    s_lshl_b32 s5, s85, 9
    s_add_u32 s4, s4, s5
    s_add_u32 s6, s4, 12845056
    s_mov_b32 s96, 65536
L_poll_156:
    s_mov_b32 s4, s6
    buffer_load_dwordx2 v[96:97], v152, s[48:51], s4 offen sc1
    s_add_u32 s4, s4, 8192
    buffer_load_dwordx2 v[98:99], v152, s[48:51], s4 offen sc1
    s_add_u32 s4, s4, 8192
    buffer_load_dwordx2 v[100:101], v152, s[48:51], s4 offen sc1
    s_add_u32 s4, s4, 8192
    buffer_load_dwordx2 v[102:103], v152, s[48:51], s4 offen sc1
    s_add_u32 s4, s4, 8192
    buffer_load_dwordx2 v[104:105], v152, s[48:51], s4 offen sc1
    s_add_u32 s4, s4, 8192
    buffer_load_dwordx2 v[106:107], v152, s[48:51], s4 offen sc1
    s_add_u32 s4, s4, 8192
    buffer_load_dwordx2 v[108:109], v152, s[48:51], s4 offen sc1
    s_add_u32 s4, s4, 8192
    buffer_load_dwordx2 v[110:111], v152, s[48:51], s4 offen sc1
    s_add_u32 s4, s4, 8192
    s_waitcnt vmcnt(0)
    v_xor_b32 v153, s15, v97
    v_xor_b32 v154, s15, v99
    v_or_b32 v153, v153, v154
    v_xor_b32 v154, s15, v101
    v_or_b32 v153, v153, v154
    v_xor_b32 v154, s15, v103
    v_or_b32 v153, v153, v154
    v_xor_b32 v154, s15, v105
    v_or_b32 v153, v153, v154
    v_xor_b32 v154, s15, v107
    v_or_b32 v153, v153, v154
    v_xor_b32 v154, s15, v109
    v_or_b32 v153, v153, v154
    v_xor_b32 v154, s15, v111
    v_or_b32 v153, v153, v154
    v_cmp_ne_u32 vcc, 0, v153
    s_sub_u32 s96, s96, 1
    s_cmp_eq_u32 s96, 0
    s_cbranch_scc1 L_polld_157
    s_nop 2
    s_cbranch_vccz L_polld_157
    s_sleep 4
    s_branch L_poll_156
L_polld_157:
    s_and_b32 s3, s71, 0xffff0000
    s_bitcmp1_b32 s3, 31
    s_mov_b32 s4, 0xffff0000
    s_cselect_b32 s4, 0x80000000, s4
    s_xor_b32 s3, s3, s4
    v_mov_b32 v158, 0xbfb8aa3b
    v_mul_f32 v158, s3, v158
    v_exp_f32 v158, v158
    s_nop 0
    v_add_f32 v158, 1.0, v158
    v_rcp_f32 v158, v158
    s_nop 0
    v_cvt_pk_bf16_f32 v158, v158, v158
    v_lshlrev_b32 v158, 16, v158
    v_add_f32 v156, v96, v98
    v_add_f32 v156, v156, v100
    v_add_f32 v156, v156, v102
    v_add_f32 v156, v156, v104
    v_add_f32 v156, v156, v106
    v_add_f32 v156, v156, v108
    v_add_f32 v156, v156, v110
    v_mov_b32 v157, v156
    s_nop 1
    v_permlane32_swap_b32 v156, v157
    s_nop 1
    v_add_f32 v156, v156, v157
    v_cvt_pk_bf16_f32 v156, v156, v156
    v_lshlrev_b32 v156, 16, v156
    v_mul_f32 v156, v156, v158
    v_cvt_pk_bf16_f32 v156, v156, v156
    v_lshlrev_b32 v156, 16, v156
    v_lshlrev_b32 v157, 4, v151
    ds_bpermute_b32 v122, v157, v156 offset:0
    ds_bpermute_b32 v123, v157, v156 offset:4
    ds_bpermute_b32 v124, v157, v156 offset:8
    ds_bpermute_b32 v125, v157, v156 offset:12
    ds_bpermute_b32 v126, v157, v156 offset:32
    ds_bpermute_b32 v127, v157, v156 offset:36
    ds_bpermute_b32 v128, v157, v156 offset:40
    ds_bpermute_b32 v129, v157, v156 offset:44
    s_waitcnt lgkmcnt(0)
    ds_bpermute_b32 v130, v157, v156 offset:64
    ds_bpermute_b32 v131, v157, v156 offset:68
    ds_bpermute_b32 v132, v157, v156 offset:72
    ds_bpermute_b32 v133, v157, v156 offset:76
    ds_bpermute_b32 v134, v157, v156 offset:96
    ds_bpermute_b32 v135, v157, v156 offset:100
    ds_bpermute_b32 v136, v157, v156 offset:104
    ds_bpermute_b32 v137, v157, v156 offset:108
    v_cmp_eq_u32 vcc, s70, v150
    s_waitcnt lgkmcnt(0)
    s_nop 0
    v_cndmask_b32 v122, 0, v122, vcc
    v_cndmask_b32 v123, 0, v123, vcc
    v_cndmask_b32 v124, 0, v124, vcc
    v_cndmask_b32 v125, 0, v125, vcc
    v_cndmask_b32 v126, 0, v126, vcc
    v_cndmask_b32 v127, 0, v127, vcc
    v_cndmask_b32 v128, 0, v128, vcc
    v_cndmask_b32 v129, 0, v129, vcc
    v_cndmask_b32 v130, 0, v130, vcc
    v_cndmask_b32 v131, 0, v131, vcc
    v_cndmask_b32 v132, 0, v132, vcc
    v_cndmask_b32 v133, 0, v133, vcc
    v_cndmask_b32 v134, 0, v134, vcc
    v_cndmask_b32 v135, 0, v135, vcc
    v_cndmask_b32 v136, 0, v136, vcc
    v_cndmask_b32 v137, 0, v137, vcc
    v_add_f32 v80, v80, v122
    v_add_f32 v81, v81, v123
    v_add_f32 v82, v82, v124
    v_add_f32 v83, v83, v125
    v_add_f32 v84, v84, v126
    v_add_f32 v85, v85, v127
    v_add_f32 v86, v86, v128
    v_add_f32 v87, v87, v129
    v_add_f32 v88, v88, v130
    v_add_f32 v89, v89, v131
    v_add_f32 v90, v90, v132
    v_add_f32 v91, v91, v133
    v_add_f32 v92, v92, v134
    v_add_f32 v93, v93, v135
    v_add_f32 v94, v94, v136
    v_add_f32 v95, v95, v137
L_nomoe_155:
    v_mul_f32 v80, v115, v80
    v_mul_f32 v81, v115, v81
    v_mul_f32 v82, v115, v82
    v_mul_f32 v83, v115, v83
    v_mul_f32 v84, v115, v84
    v_mul_f32 v85, v115, v85
    v_mul_f32 v86, v115, v86
    v_mul_f32 v87, v115, v87
    v_mul_f32 v88, v115, v88
    v_mul_f32 v89, v115, v89
    v_mul_f32 v90, v115, v90
    v_mul_f32 v91, v115, v91
    v_mul_f32 v92, v115, v92
    v_mul_f32 v93, v115, v93
    v_mul_f32 v94, v115, v94
    v_mul_f32 v95, v115, v95
    s_mov_b32 s96, 4194304
L_poll_158:
    ds_read_b64 v[120:121], v118
    s_waitcnt lgkmcnt(0)
    v_readfirstlane_b32 s3, v120
    v_readfirstlane_b32 s4, v121
    s_nop 1
    s_and_b32 s3, s3, s4
    s_lshr_b32 s3, s3, s81
    s_and_b32 s3, s3, 0xff
    s_or_b32 s74, s74, s3
    s_andn2_b32 s3, s74, s75
    s_cbranch_scc1 L_polld_159
    s_sub_u32 s96, s96, 1
    s_cmp_eq_u32 s96, 0
    s_cselect_b32 s74, 0xff, s74
    s_cbranch_scc1 L_polld_159
    s_sleep 1
    s_branch L_poll_158
L_polld_159:
    s_andn2_b32 s3, s74, s75
    s_lshl_b32 s4, s3, 8
    s_or_b32 s3, s3, s4
    s_lshr_b32 s3, s3, s76
    s_ff1_i32_b32 s3, s3
    s_add_u32 s3, s3, s76
    s_and_b32 s80, s3, 7
    s_bitset1_b32 s75, s80
    s_lshl_b32 s3, s80, 12
    s_add_u32 s3, s3, s86
    buffer_load_dwordx4 v[48:51], v165, s[48:51], s3 offen offset:0 sc1
    buffer_load_dwordx4 v[52:55], v165, s[48:51], s3 offen offset:1024 sc1
    buffer_load_dwordx4 v[56:59], v165, s[48:51], s3 offen offset:2048 sc1
    buffer_load_dwordx4 v[60:63], v165, s[48:51], s3 offen offset:3072 sc1
L_pj_151:
    s_mov_b32 s77, 3
.p2align 6
L_p3loop:
    v_readfirstlane_b32 s3, v120
    v_readfirstlane_b32 s4, v121
    s_nop 1
    s_and_b32 s3, s3, s4
    s_lshr_b32 s3, s3, s81
    s_and_b32 s3, s3, 0xff
    s_or_b32 s74, s74, s3
    s_andn2_b32 s3, s74, s75
    s_cbranch_scc0 L_pb_160
    s_andn2_b32 s3, s74, s75
    s_lshl_b32 s4, s3, 8
    s_or_b32 s3, s3, s4
    s_lshr_b32 s3, s3, s76
    s_ff1_i32_b32 s3, s3
    s_add_u32 s3, s3, s76
    s_and_b32 s79, s3, 7
    s_bitset1_b32 s75, s79
    s_lshl_b32 s3, s79, 12
    s_add_u32 s3, s3, s86
    buffer_load_dwordx4 v[32:35], v165, s[48:51], s3 offen offset:0 sc1
    buffer_load_dwordx4 v[36:39], v165, s[48:51], s3 offen offset:1024 sc1
    buffer_load_dwordx4 v[40:43], v165, s[48:51], s3 offen offset:2048 sc1
    buffer_load_dwordx4 v[44:47], v165, s[48:51], s3 offen offset:3072 sc1
    s_lshl_b32 s3, s80, 13
    v_add_u32 v116, s3, v112
    v_add_u32 v117, s3, v113
    ds_read_b64_tr_b16 v[64:65], v116 offset:0
    ds_read_b64_tr_b16 v[66:67], v116 offset:1024
    ds_read_b64_tr_b16 v[68:69], v117 offset:0
    ds_read_b64_tr_b16 v[70:71], v117 offset:1024
    ds_read_b64_tr_b16 v[72:73], v116 offset:2048
    ds_read_b64_tr_b16 v[74:75], v116 offset:3072
    ds_read_b64_tr_b16 v[76:77], v117 offset:2048
    ds_read_b64_tr_b16 v[78:79], v117 offset:3072
    s_waitcnt vmcnt(7) lgkmcnt(4)
    v_mfma_f32_32x32x16_bf16 v[0:15], v[64:67], v[48:51], v[0:15]
    v_mfma_f32_32x32x16_bf16 v[16:31], v[68:71], v[48:51], v[16:31]
    ds_read_b64_tr_b16 v[64:65], v116 offset:4096
    ds_read_b64_tr_b16 v[66:67], v116 offset:5120
    ds_read_b64_tr_b16 v[68:69], v117 offset:4096
    ds_read_b64_tr_b16 v[70:71], v117 offset:5120
    s_waitcnt vmcnt(6) lgkmcnt(4)
    v_mfma_f32_32x32x16_bf16 v[0:15], v[72:75], v[52:55], v[0:15]
    v_mfma_f32_32x32x16_bf16 v[16:31], v[76:79], v[52:55], v[16:31]
    ds_read_b64 v[120:121], v118
    ds_read_b64_tr_b16 v[72:73], v116 offset:6144
    ds_read_b64_tr_b16 v[74:75], v116 offset:7168
    ds_read_b64_tr_b16 v[76:77], v117 offset:6144
    ds_read_b64_tr_b16 v[78:79], v117 offset:7168
    s_waitcnt vmcnt(5) lgkmcnt(4)
    v_mfma_f32_32x32x16_bf16 v[0:15], v[64:67], v[56:59], v[0:15]
    v_mfma_f32_32x32x16_bf16 v[16:31], v[68:71], v[56:59], v[16:31]
    s_waitcnt vmcnt(4) lgkmcnt(0)
    v_mfma_f32_32x32x16_bf16 v[0:15], v[72:75], v[60:63], v[0:15]
    v_mfma_f32_32x32x16_bf16 v[16:31], v[76:79], v[60:63], v[16:31]
    s_branch L_pj_161
L_pb_160:
    s_lshl_b32 s3, s80, 13
    v_add_u32 v116, s3, v112
    v_add_u32 v117, s3, v113
    ds_read_b64_tr_b16 v[64:65], v116 offset:0
    ds_read_b64_tr_b16 v[66:67], v116 offset:1024
    ds_read_b64_tr_b16 v[68:69], v117 offset:0
    ds_read_b64_tr_b16 v[70:71], v117 offset:1024
    ds_read_b64_tr_b16 v[72:73], v116 offset:2048
    ds_read_b64_tr_b16 v[74:75], v116 offset:3072
    ds_read_b64_tr_b16 v[76:77], v117 offset:2048
    ds_read_b64_tr_b16 v[78:79], v117 offset:3072
    s_waitcnt vmcnt(3) lgkmcnt(4)
    v_mfma_f32_32x32x16_bf16 v[0:15], v[64:67], v[48:51], v[0:15]
    v_mfma_f32_32x32x16_bf16 v[16:31], v[68:71], v[48:51], v[16:31]
    ds_read_b64_tr_b16 v[64:65], v116 offset:4096
    ds_read_b64_tr_b16 v[66:67], v116 offset:5120
    ds_read_b64_tr_b16 v[68:69], v117 offset:4096
    ds_read_b64_tr_b16 v[70:71], v117 offset:5120
    s_waitcnt vmcnt(2) lgkmcnt(4)
    v_mfma_f32_32x32x16_bf16 v[0:15], v[72:75], v[52:55], v[0:15]
    v_mfma_f32_32x32x16_bf16 v[16:31], v[76:79], v[52:55], v[16:31]
    ds_read_b64 v[120:121], v118
    ds_read_b64_tr_b16 v[72:73], v116 offset:6144
    ds_read_b64_tr_b16 v[74:75], v116 offset:7168
    ds_read_b64_tr_b16 v[76:77], v117 offset:6144
    ds_read_b64_tr_b16 v[78:79], v117 offset:7168
    s_waitcnt vmcnt(1) lgkmcnt(4)
    v_mfma_f32_32x32x16_bf16 v[0:15], v[64:67], v[56:59], v[0:15]
    v_mfma_f32_32x32x16_bf16 v[16:31], v[68:71], v[56:59], v[16:31]
    s_waitcnt vmcnt(0) lgkmcnt(0)
    v_mfma_f32_32x32x16_bf16 v[0:15], v[72:75], v[60:63], v[0:15]
    v_mfma_f32_32x32x16_bf16 v[16:31], v[76:79], v[60:63], v[16:31]
    s_mov_b32 s96, 4194304
L_poll_162:
    ds_read_b64 v[120:121], v118
    s_waitcnt lgkmcnt(0)
    v_readfirstlane_b32 s3, v120
    v_readfirstlane_b32 s4, v121
    s_nop 1
    s_and_b32 s3, s3, s4
    s_lshr_b32 s3, s3, s81
    s_and_b32 s3, s3, 0xff
    s_or_b32 s74, s74, s3
    s_andn2_b32 s3, s74, s75
    s_cbranch_scc1 L_polld_163
    s_sub_u32 s96, s96, 1
    s_cmp_eq_u32 s96, 0
    s_cselect_b32 s74, 0xff, s74
    s_cbranch_scc1 L_polld_163
    s_sleep 1
    s_branch L_poll_162
L_polld_163:
    s_andn2_b32 s3, s74, s75
    s_lshl_b32 s4, s3, 8
    s_or_b32 s3, s3, s4
    s_lshr_b32 s3, s3, s76
    s_ff1_i32_b32 s3, s3
    s_add_u32 s3, s3, s76
    s_and_b32 s79, s3, 7
    s_bitset1_b32 s75, s79
    s_lshl_b32 s3, s79, 12
    s_add_u32 s3, s3, s86
    buffer_load_dwordx4 v[32:35], v165, s[48:51], s3 offen offset:0 sc1
    buffer_load_dwordx4 v[36:39], v165, s[48:51], s3 offen offset:1024 sc1
    buffer_load_dwordx4 v[40:43], v165, s[48:51], s3 offen offset:2048 sc1
    buffer_load_dwordx4 v[44:47], v165, s[48:51], s3 offen offset:3072 sc1
L_pj_161:
    v_readfirstlane_b32 s3, v120
    v_readfirstlane_b32 s4, v121
    s_nop 1
    s_and_b32 s3, s3, s4
    s_lshr_b32 s3, s3, s81
    s_and_b32 s3, s3, 0xff
    s_or_b32 s74, s74, s3
    s_andn2_b32 s3, s74, s75
    s_cbranch_scc0 L_pb_164
    s_andn2_b32 s3, s74, s75
    s_lshl_b32 s4, s3, 8
    s_or_b32 s3, s3, s4
    s_lshr_b32 s3, s3, s76
    s_ff1_i32_b32 s3, s3
    s_add_u32 s3, s3, s76
    s_and_b32 s80, s3, 7
    s_bitset1_b32 s75, s80
    s_lshl_b32 s3, s80, 12
    s_add_u32 s3, s3, s86
    buffer_load_dwordx4 v[48:51], v165, s[48:51], s3 offen offset:0 sc1
    buffer_load_dwordx4 v[52:55], v165, s[48:51], s3 offen offset:1024 sc1
    buffer_load_dwordx4 v[56:59], v165, s[48:51], s3 offen offset:2048 sc1
    buffer_load_dwordx4 v[60:63], v165, s[48:51], s3 offen offset:3072 sc1
    s_lshl_b32 s3, s79, 13
    v_add_u32 v116, s3, v112
    v_add_u32 v117, s3, v113
    ds_read_b64_tr_b16 v[64:65], v116 offset:0
    ds_read_b64_tr_b16 v[66:67], v116 offset:1024
    ds_read_b64_tr_b16 v[68:69], v117 offset:0
    ds_read_b64_tr_b16 v[70:71], v117 offset:1024
    ds_read_b64_tr_b16 v[72:73], v116 offset:2048
    ds_read_b64_tr_b16 v[74:75], v116 offset:3072
    ds_read_b64_tr_b16 v[76:77], v117 offset:2048
    ds_read_b64_tr_b16 v[78:79], v117 offset:3072
    s_waitcnt vmcnt(7) lgkmcnt(4)
    v_mfma_f32_32x32x16_bf16 v[0:15], v[64:67], v[32:35], v[0:15]
    v_mfma_f32_32x32x16_bf16 v[16:31], v[68:71], v[32:35], v[16:31]
    ds_read_b64_tr_b16 v[64:65], v116 offset:4096
    ds_read_b64_tr_b16 v[66:67], v116 offset:5120
    ds_read_b64_tr_b16 v[68:69], v117 offset:4096
    ds_read_b64_tr_b16 v[70:71], v117 offset:5120
    s_waitcnt vmcnt(6) lgkmcnt(4)
    v_mfma_f32_32x32x16_bf16 v[0:15], v[72:75], v[36:39], v[0:15]
    v_mfma_f32_32x32x16_bf16 v[16:31], v[76:79], v[36:39], v[16:31]
    ds_read_b64 v[120:121], v118
    ds_read_b64_tr_b16 v[72:73], v116 offset:6144
    ds_read_b64_tr_b16 v[74:75], v116 offset:7168
    ds_read_b64_tr_b16 v[76:77], v117 offset:6144
    ds_read_b64_tr_b16 v[78:79], v117 offset:7168
    s_waitcnt vmcnt(5) lgkmcnt(4)
    v_mfma_f32_32x32x16_bf16 v[0:15], v[64:67], v[40:43], v[0:15]
    v_mfma_f32_32x32x16_bf16 v[16:31], v[68:71], v[40:43], v[16:31]
    s_waitcnt vmcnt(4) lgkmcnt(0)
    v_mfma_f32_32x32x16_bf16 v[0:15], v[72:75], v[44:47], v[0:15]
    v_mfma_f32_32x32x16_bf16 v[16:31], v[76:79], v[44:47], v[16:31]
    s_branch L_pj_165
L_pb_164:
    s_lshl_b32 s3, s79, 13
    v_add_u32 v116, s3, v112
    v_add_u32 v117, s3, v113
    ds_read_b64_tr_b16 v[64:65], v116 offset:0
    ds_read_b64_tr_b16 v[66:67], v116 offset:1024
    ds_read_b64_tr_b16 v[68:69], v117 offset:0
    ds_read_b64_tr_b16 v[70:71], v117 offset:1024
    ds_read_b64_tr_b16 v[72:73], v116 offset:2048
    ds_read_b64_tr_b16 v[74:75], v116 offset:3072
    ds_read_b64_tr_b16 v[76:77], v117 offset:2048
    ds_read_b64_tr_b16 v[78:79], v117 offset:3072
    s_waitcnt vmcnt(3) lgkmcnt(4)
    v_mfma_f32_32x32x16_bf16 v[0:15], v[64:67], v[32:35], v[0:15]
    v_mfma_f32_32x32x16_bf16 v[16:31], v[68:71], v[32:35], v[16:31]
    ds_read_b64_tr_b16 v[64:65], v116 offset:4096
    ds_read_b64_tr_b16 v[66:67], v116 offset:5120
    ds_read_b64_tr_b16 v[68:69], v117 offset:4096
    ds_read_b64_tr_b16 v[70:71], v117 offset:5120
    s_waitcnt vmcnt(2) lgkmcnt(4)
    v_mfma_f32_32x32x16_bf16 v[0:15], v[72:75], v[36:39], v[0:15]
    v_mfma_f32_32x32x16_bf16 v[16:31], v[76:79], v[36:39], v[16:31]
    ds_read_b64 v[120:121], v118
    ds_read_b64_tr_b16 v[72:73], v116 offset:6144
    ds_read_b64_tr_b16 v[74:75], v116 offset:7168
    ds_read_b64_tr_b16 v[76:77], v117 offset:6144
    ds_read_b64_tr_b16 v[78:79], v117 offset:7168
    s_waitcnt vmcnt(1) lgkmcnt(4)
    v_mfma_f32_32x32x16_bf16 v[0:15], v[64:67], v[40:43], v[0:15]
    v_mfma_f32_32x32x16_bf16 v[16:31], v[68:71], v[40:43], v[16:31]
    s_waitcnt vmcnt(0) lgkmcnt(0)
    v_mfma_f32_32x32x16_bf16 v[0:15], v[72:75], v[44:47], v[0:15]
    v_mfma_f32_32x32x16_bf16 v[16:31], v[76:79], v[44:47], v[16:31]
    s_mov_b32 s96, 4194304
L_poll_166:
    ds_read_b64 v[120:121], v118
    s_waitcnt lgkmcnt(0)
    v_readfirstlane_b32 s3, v120
    v_readfirstlane_b32 s4, v121
    s_nop 1
    s_and_b32 s3, s3, s4
    s_lshr_b32 s3, s3, s81
    s_and_b32 s3, s3, 0xff
    s_or_b32 s74, s74, s3
    s_andn2_b32 s3, s74, s75
    s_cbranch_scc1 L_polld_167
    s_sub_u32 s96, s96, 1
    s_cmp_eq_u32 s96, 0
    s_cselect_b32 s74, 0xff, s74
    s_cbranch_scc1 L_polld_167
    s_sleep 1
    s_branch L_poll_166
L_polld_167:
    s_andn2_b32 s3, s74, s75
    s_lshl_b32 s4, s3, 8
    s_or_b32 s3, s3, s4
    s_lshr_b32 s3, s3, s76
    s_ff1_i32_b32 s3, s3
    s_add_u32 s3, s3, s76
    s_and_b32 s80, s3, 7
    s_bitset1_b32 s75, s80
    s_lshl_b32 s3, s80, 12
    s_add_u32 s3, s3, s86
    buffer_load_dwordx4 v[48:51], v165, s[48:51], s3 offen offset:0 sc1
    buffer_load_dwordx4 v[52:55], v165, s[48:51], s3 offen offset:1024 sc1
    buffer_load_dwordx4 v[56:59], v165, s[48:51], s3 offen offset:2048 sc1
    buffer_load_dwordx4 v[60:63], v165, s[48:51], s3 offen offset:3072 sc1
L_pj_165:
    s_sub_u32 s77, s77, 1
    s_cmp_lg_u32 s77, 0
    s_cbranch_scc1 L_p3loop
L_p3last:
    s_lshl_b32 s3, s80, 13
    v_add_u32 v116, s3, v112
    v_add_u32 v117, s3, v113
    ds_read_b64_tr_b16 v[64:65], v116 offset:0
    ds_read_b64_tr_b16 v[66:67], v116 offset:1024
    ds_read_b64_tr_b16 v[68:69], v117 offset:0
    ds_read_b64_tr_b16 v[70:71], v117 offset:1024
    ds_read_b64_tr_b16 v[72:73], v116 offset:2048
    ds_read_b64_tr_b16 v[74:75], v116 offset:3072
    ds_read_b64_tr_b16 v[76:77], v117 offset:2048
    ds_read_b64_tr_b16 v[78:79], v117 offset:3072
    s_waitcnt vmcnt(3) lgkmcnt(4)
    v_mfma_f32_32x32x16_bf16 v[0:15], v[64:67], v[48:51], v[0:15]
    v_mfma_f32_32x32x16_bf16 v[16:31], v[68:71], v[48:51], v[16:31]
    ds_read_b64_tr_b16 v[64:65], v116 offset:4096
    ds_read_b64_tr_b16 v[66:67], v116 offset:5120
    ds_read_b64_tr_b16 v[68:69], v117 offset:4096
    ds_read_b64_tr_b16 v[70:71], v117 offset:5120
    s_waitcnt vmcnt(2) lgkmcnt(4)
    v_mfma_f32_32x32x16_bf16 v[0:15], v[72:75], v[52:55], v[0:15]
    v_mfma_f32_32x32x16_bf16 v[16:31], v[76:79], v[52:55], v[16:31]
    ds_read_b64 v[120:121], v118
    ds_read_b64_tr_b16 v[72:73], v116 offset:6144
    ds_read_b64_tr_b16 v[74:75], v116 offset:7168
    ds_read_b64_tr_b16 v[76:77], v117 offset:6144
    ds_read_b64_tr_b16 v[78:79], v117 offset:7168
    s_waitcnt vmcnt(1) lgkmcnt(4)
    v_mfma_f32_32x32x16_bf16 v[0:15], v[64:67], v[56:59], v[0:15]
    v_mfma_f32_32x32x16_bf16 v[16:31], v[68:71], v[56:59], v[16:31]
    s_waitcnt vmcnt(0) lgkmcnt(0)
    v_mfma_f32_32x32x16_bf16 v[0:15], v[72:75], v[60:63], v[0:15]
    v_mfma_f32_32x32x16_bf16 v[16:31], v[76:79], v[60:63], v[16:31]
    s_lshl_b32 s3, s64, 12
    s_add_u32 s3, s3, 131072
    v_add_u32 v116, s3, v165
    s_xor_b32 s3, s3, 16384
    v_add_u32 v117, s3, v165
    s_barrier
    s_nop 7
    ds_write_b128 v116, v[16:19] offset:0
    ds_write_b128 v116, v[20:23] offset:1024
    ds_write_b128 v116, v[24:27] offset:2048
    ds_write_b128 v116, v[28:31] offset:3072
    s_waitcnt lgkmcnt(0)
    s_barrier
    ds_read_b128 v[16:19], v117 offset:0
    ds_read_b128 v[20:23], v117 offset:1024
    ds_read_b128 v[24:27], v117 offset:2048
    ds_read_b128 v[28:31], v117 offset:3072
    s_waitcnt lgkmcnt(2)
    v_add_f32 v0, v0, v16
    v_add_f32 v1, v1, v17
    v_add_f32 v2, v2, v18
    v_add_f32 v3, v3, v19
    v_add_f32 v4, v4, v20
    v_add_f32 v5, v5, v21
    v_add_f32 v6, v6, v22
    v_add_f32 v7, v7, v23
    v_fma_f32 v0, v148, v0, v80
    v_fma_f32 v1, v148, v1, v81
    v_fma_f32 v2, v148, v2, v82
    v_fma_f32 v3, v148, v3, v83
    v_fma_f32 v4, v148, v4, v84
    v_fma_f32 v5, v148, v5, v85
    v_fma_f32 v6, v148, v6, v86
    v_fma_f32 v7, v148, v7, v87
    v_cvt_pk_bf16_f32 v48, v0, v1
    v_cvt_pk_bf16_f32 v49, v2, v3
    v_cvt_pk_bf16_f32 v50, v4, v5
    v_cvt_pk_bf16_f32 v51, v6, v7
    s_nop 1
    v_permlane32_swap_b32 v48, v50
    v_permlane32_swap_b32 v49, v51
    s_nop 1
    buffer_store_dwordx4 v[48:51], v149, s[60:63], 0 offen offset:0
    s_waitcnt lgkmcnt(0)
    v_add_f32 v8, v8, v24
    v_add_f32 v9, v9, v25
    v_add_f32 v10, v10, v26
    v_add_f32 v11, v11, v27
    v_add_f32 v12, v12, v28
    v_add_f32 v13, v13, v29
    v_add_f32 v14, v14, v30
    v_add_f32 v15, v15, v31
    v_fma_f32 v8, v148, v8, v88
    v_fma_f32 v9, v148, v9, v89
    v_fma_f32 v10, v148, v10, v90
    v_fma_f32 v11, v148, v11, v91
    v_fma_f32 v12, v148, v12, v92
    v_fma_f32 v13, v148, v13, v93
    v_fma_f32 v14, v148, v14, v94
    v_fma_f32 v15, v148, v15, v95
    v_cvt_pk_bf16_f32 v52, v8, v9
    v_cvt_pk_bf16_f32 v53, v10, v11
    v_cvt_pk_bf16_f32 v54, v12, v13
    v_cvt_pk_bf16_f32 v55, v14, v15
    s_nop 1
    v_permlane32_swap_b32 v52, v54
    v_permlane32_swap_b32 v53, v55
    s_nop 1
    buffer_store_dwordx4 v[52:55], v149, s[60:63], 0 offen offset:32
    s_endpgm
L_opsA:
    s_and_b32 s3, s2, 7
    s_lshl_b32 s3, s3, 1
    s_lshr_b32 s4, s2, 7
    s_add_u32 s84, s3, s4
    s_lshr_b32 s3, s2, 3
    s_and_b32 s85, s3, 15
    s_and_b32 s3, s64, 3
    s_lshl_b32 s4, s84, 2
    s_add_u32 s87, s3, s4
    v_and_b32 v150, 31, v166
    s_lshl_b32 s3, s87, 5
    v_add_u32 v150, s3, v150
    v_lshrrev_b32 v151, 5, v166
    s_lshr_b32 s4, s64, 2
    s_lshl_b32 s4, s4, 6
    s_lshl_b32 s5, s85, 7
    s_add_u32 s4, s4, s5
    v_lshlrev_b32 v155, 11, v150
    v_add_u32 v155, s4, v155
    v_lshl_add_u32 v149, v151, 4, v155
    buffer_load_dwordx4 v[140:143], v149, s[40:43], 0 offen offset:0
    buffer_load_dwordx4 v[144:147], v149, s[40:43], 0 offen offset:32
    v_lshlrev_b32 v155, 2, v150
    s_mov_b32 s5, 12582912
    buffer_load_dword v148, v155, s[48:51], s5 offen sc1
    s_lshr_b32 s4, s64, 2
    s_lshl_b32 s86, s87, 16
    s_lshl_b32 s5, s4, 15
    s_add_u32 s86, s86, s5
    s_add_u32 s86, s86, 8388608
    s_branch L_attloopA
L_hs_slowA0:
    s_mov_b32 s96, 1048576
L_hs_spinA0:
    s_sleep 1
    ds_read_b32 v139, v163
    s_waitcnt lgkmcnt(0)
    v_readfirstlane_b32 s3, v139
    s_sub_u32 s96, s96, 1
    s_cmp_eq_u32 s96, 0
    s_cbranch_scc1 L_hs_outA0
    s_cmp_ge_u32 s3, s79
    s_cbranch_scc0 L_hs_spinA0
L_hs_outA0:
    s_branch L_hs_backA0
L_hs_slowA1:
    s_mov_b32 s96, 1048576
L_hs_spinA1:
    s_sleep 1
    ds_read_b32 v139, v163
    s_waitcnt lgkmcnt(0)
    v_readfirstlane_b32 s3, v139
    s_sub_u32 s96, s96, 1
    s_cmp_eq_u32 s96, 0
    s_cbranch_scc1 L_hs_outA1
    s_cmp_ge_u32 s3, s79
    s_cbranch_scc0 L_hs_spinA1
L_hs_outA1:
    s_branch L_hs_backA1
L_hs_slowA2:
    s_mov_b32 s96, 1048576
L_hs_spinA2:
    s_sleep 1
    ds_read_b32 v139, v163
    s_waitcnt lgkmcnt(0)
    v_readfirstlane_b32 s3, v139
    s_sub_u32 s96, s96, 1
    s_cmp_eq_u32 s96, 0
    s_cbranch_scc1 L_hs_outA2
    s_cmp_ge_u32 s3, s79
    s_cbranch_scc0 L_hs_spinA2
L_hs_outA2:
    s_branch L_hs_backA2
L_opsB:
    s_and_b32 s3, s2, 7
    s_lshl_b32 s3, s3, 1
    s_lshr_b32 s4, s2, 7
    s_add_u32 s84, s3, s4
    s_lshr_b32 s3, s2, 3
    s_and_b32 s85, s3, 15
    s_and_b32 s3, s64, 3
    s_lshl_b32 s4, s84, 2
    s_add_u32 s87, s3, s4
    v_and_b32 v150, 31, v166
    s_lshl_b32 s3, s87, 5
    v_add_u32 v150, s3, v150
    v_lshrrev_b32 v151, 5, v166
    s_lshr_b32 s4, s64, 2
    s_lshl_b32 s4, s4, 6
    s_lshl_b32 s5, s85, 7
    s_add_u32 s4, s4, s5
    v_lshlrev_b32 v155, 11, v150
    v_add_u32 v155, s4, v155
    v_lshl_add_u32 v149, v151, 4, v155
    buffer_load_dwordx4 v[140:143], v149, s[40:43], 0 offen offset:0
    buffer_load_dwordx4 v[144:147], v149, s[40:43], 0 offen offset:32
    v_lshlrev_b32 v155, 2, v150
    s_mov_b32 s5, 12582912
    buffer_load_dword v148, v155, s[48:51], s5 offen sc1
    s_lshr_b32 s4, s64, 2
    s_lshl_b32 s86, s87, 16
    s_lshl_b32 s5, s4, 15
    s_add_u32 s86, s86, s5
    s_add_u32 s86, s86, 8388608
    s_branch L_attloopB
L_hs_slowB0:
    s_mov_b32 s96, 1048576
L_hs_spinB0:
    s_sleep 1
    ds_read_b32 v139, v163
    s_waitcnt lgkmcnt(0)
    v_readfirstlane_b32 s3, v139
    s_sub_u32 s96, s96, 1
    s_cmp_eq_u32 s96, 0
    s_cbranch_scc1 L_hs_outB0
    s_cmp_ge_u32 s3, s79
    s_cbranch_scc0 L_hs_spinB0
L_hs_outB0:
    s_branch L_hs_backB0
L_hs_slowB1:
    s_mov_b32 s96, 1048576
L_hs_spinB1:
    s_sleep 1
    ds_read_b32 v139, v163
    s_waitcnt lgkmcnt(0)
    v_readfirstlane_b32 s3, v139
    s_sub_u32 s96, s96, 1
    s_cmp_eq_u32 s96, 0
    s_cbranch_scc1 L_hs_outB1
    s_cmp_ge_u32 s3, s79
    s_cbranch_scc0 L_hs_spinB1
L_hs_outB1:
    s_branch L_hs_backB1
L_hs_slowB2:
    s_mov_b32 s96, 1048576
L_hs_spinB2:
    s_sleep 1
    ds_read_b32 v139, v163
    s_waitcnt lgkmcnt(0)
    v_readfirstlane_b32 s3, v139
    s_sub_u32 s96, s96, 1
    s_cmp_eq_u32 s96, 0
    s_cbranch_scc1 L_hs_outB2
    s_cmp_ge_u32 s3, s79
    s_cbranch_scc0 L_hs_spinB2
L_hs_outB2:
    s_branch L_hs_backB2
L_fallback:
    s_cmp_eq_u32 s94, 1
    s_cbranch_scc1 L_att_ok
    s_mov_b32 s94, 1
    s_lshl_b32 s5, s66, 6
    s_add_u32 s5, s5, 12976128
    v_lshlrev_b32 v156, 2, v166
    s_mov_b32 s96, 65536
    s_mov_b32 s97, s15
    s_mov_b64 exec, 0xffff
L_poll_168:
    buffer_load_dword v157, v156, s[48:51], s5 offen sc1
    s_waitcnt vmcnt(0)
    v_cmp_ne_u32 vcc, s97, v157
    s_sub_u32 s96, s96, 1
    s_cmp_eq_u32 s96, 0
    s_cbranch_scc1 L_polld_169
    s_nop 2
    s_cbranch_vccz L_polld_169
    s_sleep 1
    s_branch L_poll_168
L_polld_169:
    s_mov_b64 exec, -1
    s_lshl_b32 s76, s66, 19
    s_lshl_b32 s3, s67, 14
    s_add_u32 s76, s76, s3
    v_mov_b32 v159, 0xff800000
    s_mov_b32 s77, 0
L_fb1:
    s_lshr_b32 s3, s77, 2
    s_lshl_b32 s3, s3, 15
    s_and_b32 s4, s77, 3
    s_lshl_b32 s4, s4, 12
    s_add_u32 s3, s3, s4
    s_add_u32 s78, s3, s76
    buffer_load_dwordx4 v[80:83], v165, s[48:51], s78 offen sc1
    buffer_load_dwordx4 v[84:87], v165, s[48:51], s78 offen offset:1024 sc1
    s_waitcnt vmcnt(0)
    v_mfma_f32_32x32x16_bf16 v[0:15], v[80:83], v[128:131], 0
    v_mfma_f32_32x32x16_bf16 v[0:15], v[84:87], v[132:135], v[0:15]
    s_nop 7
    s_nop 7
    v_max3_f32 v159, v159, v0, v1
    v_max3_f32 v159, v159, v2, v3
    v_max3_f32 v159, v159, v4, v5
    v_max3_f32 v159, v159, v6, v7
    v_max3_f32 v159, v159, v8, v9
    v_max3_f32 v159, v159, v10, v11
    v_max3_f32 v159, v159, v12, v13
    v_max3_f32 v159, v159, v14, v15
    s_add_u32 s77, s77, 1
    s_cmp_lt_u32 s77, 64
    s_cbranch_scc1 L_fb1
    v_mov_b32 v0, v159
    v_mov_b32 v1, v159
    v_mov_b32 v2, v159
    v_mov_b32 v3, v159
    v_mov_b32 v4, v159
    v_mov_b32 v5, v159
    v_mov_b32 v6, v159
    v_mov_b32 v7, v159
    v_mov_b32 v8, v159
    v_mov_b32 v9, v159
    v_mov_b32 v10, v159
    v_mov_b32 v11, v159
    v_mov_b32 v12, v159
    v_mov_b32 v13, v159
    v_mov_b32 v14, v159
    v_mov_b32 v15, v159
    v_max3_f32 v156, v0, v1, v2
    v_max3_f32 v156, v156, v3, v4
    v_max3_f32 v156, v156, v5, v6
    v_max3_f32 v156, v156, v7, v8
    v_max3_f32 v156, v156, v9, v10
    v_max3_f32 v156, v156, v11, v12
    v_max3_f32 v156, v156, v13, v14
    v_max_f32 v156, v156, v15
    v_mov_b32 v157, v156
    s_nop 1
    v_permlane32_swap_b32 v156, v157
    s_nop 1
    v_max_f32 v156, v156, v157
    v_sub_f32 v48, 0, v156
    v_sub_f32 v49, 0, v156
    v_sub_f32 v50, 0, v156
    v_sub_f32 v51, 0, v156
    v_sub_f32 v52, 0, v156
    v_sub_f32 v53, 0, v156
    v_sub_f32 v54, 0, v156
    v_sub_f32 v55, 0, v156
    v_sub_f32 v56, 0, v156
    v_sub_f32 v57, 0, v156
    v_sub_f32 v58, 0, v156
    v_sub_f32 v59, 0, v156
    v_sub_f32 v60, 0, v156
    v_sub_f32 v61, 0, v156
    v_sub_f32 v62, 0, v156
    v_sub_f32 v63, 0, v156
    v_mov_b32 v32, 0
    v_mov_b32 v33, 0
    v_mov_b32 v34, 0
    v_mov_b32 v35, 0
    v_mov_b32 v36, 0
    v_mov_b32 v37, 0
    v_mov_b32 v38, 0
    v_mov_b32 v39, 0
    v_mov_b32 v40, 0
    v_mov_b32 v41, 0
    v_mov_b32 v42, 0
    v_mov_b32 v43, 0
    v_mov_b32 v44, 0
    v_mov_b32 v45, 0
    v_mov_b32 v46, 0
    v_mov_b32 v47, 0
    v_mov_b32 v120, 0
    v_mov_b32 v121, 0
    v_mov_b32 v122, 0
    v_mov_b32 v123, 0
    s_mov_b32 s77, 0
L_fb2:
    s_lshr_b32 s3, s77, 2
    s_lshl_b32 s3, s3, 15
    s_and_b32 s4, s77, 3
    s_lshl_b32 s4, s4, 12
    s_add_u32 s3, s3, s4
    s_add_u32 s78, s3, s76
    buffer_load_dwordx4 v[80:83], v165, s[48:51], s78 offen offset:0 sc1
    buffer_load_dwordx4 v[84:87], v165, s[48:51], s78 offen offset:1024 sc1
    buffer_load_dwordx4 v[88:91], v165, s[48:51], s78 offen offset:2048 sc1
    buffer_load_dwordx4 v[92:95], v165, s[48:51], s78 offen offset:3072 sc1
    s_waitcnt vmcnt(0)
    v_mfma_f32_32x32x16_bf16 v[0:15], v[80:83], v[128:131], v[48:63]
    v_mfma_f32_32x32x16_bf16 v[0:15], v[84:87], v[132:135], v[0:15]
    s_nop 7
    s_nop 7
    v_exp_f32 v0, v0
    v_exp_f32 v1, v1
    v_exp_f32 v2, v2
    v_exp_f32 v3, v3
    v_exp_f32 v4, v4
    v_exp_f32 v5, v5
    v_exp_f32 v6, v6
    v_exp_f32 v7, v7
    v_exp_f32 v8, v8
    v_exp_f32 v9, v9
    v_exp_f32 v10, v10
    v_exp_f32 v11, v11
    v_exp_f32 v12, v12
    v_exp_f32 v13, v13
    v_exp_f32 v14, v14
    v_exp_f32 v15, v15
    s_nop 0
    v_cvt_pk_bf16_f32 v64, v0, v1
    v_cvt_pk_bf16_f32 v65, v2, v3
    v_cvt_pk_bf16_f32 v66, v4, v5
    v_cvt_pk_bf16_f32 v67, v6, v7
    v_cvt_pk_bf16_f32 v68, v8, v9
    v_cvt_pk_bf16_f32 v69, v10, v11
    v_cvt_pk_bf16_f32 v70, v12, v13
    v_cvt_pk_bf16_f32 v71, v14, v15
    s_nop 1
    v_mfma_f32_32x32x16_bf16 v[32:47], v[88:91], v[64:67], v[32:47]
    v_mfma_f32_32x32x16_bf16 v[32:47], v[92:95], v[68:71], v[32:47]
    v_smfmac_f32_16x16x64_bf16 v[120:123], v[124:127], v[64:71], v162
    s_add_u32 s77, s77, 1
    s_cmp_lt_u32 s77, 64
    s_nop 7
    s_nop 7
    s_cbranch_scc1 L_fb2
    s_branch L_att_fin
L_end:
    s_endpgm
L_code1:
.section .rodata,"a"
.p2align 6
.amdhsa_kernel gated_mix__softmax_full_mha__moe_arch_mod__prompt_kernel
  .amdhsa_next_free_vgpr 168
  .amdhsa_next_free_sgpr 102
  .amdhsa_accum_offset 168
  .amdhsa_group_segment_fixed_size 0
  .amdhsa_kernarg_size 96
  .amdhsa_user_sgpr_count 2
  .amdhsa_user_sgpr_kernarg_segment_ptr 1
  .amdhsa_system_sgpr_workgroup_id_x 1
.end_amdhsa_kernel
```
